```python
import torch

def _softmax(x, axis=-1):
    return torch.softmax(x, dim=axis)
def _gelu(x):
    return torch.nn.functional.gelu(x, approximate="tanh")
def _silu(x):
    return torch.nn.functional.silu(x)
def _sigmoid(x):
    return torch.sigmoid(x)
def _layernorm(x, axis=-1, eps=1e-5):
    m = x.mean(dim=axis, keepdim=True)
    v = x.var(dim=axis, keepdim=True, unbiased=False)
    return (x - m) / torch.sqrt(v + eps)
def _scatter_add(tgt, idx, src, axis=0):
    return tgt.clone().index_add_(axis, idx, src)
def _segment_sum(src, seg, n):
    out = torch.zeros((n,) + src.shape[1:], dtype=src.dtype)
    return out.index_add_(0, seg, src)
def _pad(x, pw):
    flat = tuple(v for pair in reversed(pw) for v in pair)
    return torch.nn.functional.pad(x, flat)

kernel_name = 'sequential_preLN__ssm_conv_s4d__mixer_s_mlp__prompt'

def setup_inputs():

    _w = (lambda a: (lambda t: t.to(torch.bfloat16) if t.is_floating_point() else t)(torch.as_tensor(a)))
    def _A_setup():
        Bsz, L, D, N = 1, 2048, 640, 128
        return {
            "u": _w((lambda *s: torch.randn(*s, dtype=torch.bfloat16) * 0.05)(Bsz, L, D)),
            "log_A_real": _w((lambda *s: torch.randn(*s, dtype=torch.bfloat16) * 6.4)(D, N) * 0.5),
            "A_imag": _w((lambda *s: torch.randn(*s, dtype=torch.bfloat16) * 0.05)(D, N) * 3.14),
            "C_real": _w((lambda *s: torch.randn(*s, dtype=torch.bfloat16) * 0.05)(D, N) / N ** 0.5),
            "C_imag": _w((lambda *s: torch.randn(*s, dtype=torch.bfloat16) * 0.05)(D, N) / N ** 0.5),
            "log_dt": _w((lambda *s: torch.randn(*s, dtype=torch.bfloat16) * 0.05)(D) * 0.5 - 4.0),
            "D_skip": _w((lambda *s: torch.randn(*s, dtype=torch.bfloat16) * 0.05)(D)),
        }
    _A_in = _A_setup()

    def _B_setup():
        B, S, D, F = 1, 2048, 640, 1728
        return {
            "x":  _w((lambda *s: torch.randn(*s, dtype=torch.bfloat16) * 0.05)(B, S, D)),
            "w1": _w((lambda *s: torch.randn(*s, dtype=torch.bfloat16) * 6.4)(D, D) * (D ** -0.5)),
            "w2": _w((lambda *s: torch.randn(*s, dtype=torch.bfloat16) * 6.4)(D, D) * (D ** -0.5)),
            "w3": _w((lambda *s: torch.randn(*s, dtype=torch.bfloat16) * 6.4)(D, F) * (D ** -0.5)),
            "w4": _w((lambda *s: torch.randn(*s, dtype=torch.bfloat16) * 6.4)(F, D) * (F ** -0.5)),
        }
    _B_in = _B_setup()

    return {
        "A_u": _A_in["u"],
        "A_log_A_real": _A_in["log_A_real"],
        "A_A_imag": _A_in["A_imag"],
        "A_C_real": _A_in["C_real"],
        "A_C_imag": _A_in["C_imag"],
        "A_log_dt": _A_in["log_dt"],
        "A_D_skip": _A_in["D_skip"],
        "B_x": _B_in["x"],
        "B_w1": _B_in["w1"],
        "B_w2": _B_in["w2"],
        "B_w3": _B_in["w3"],
        "B_w4": _B_in["w4"],
    }

def reference(A_u, A_log_A_real, A_A_imag, A_C_real, A_C_imag, A_log_dt, A_D_skip, B_x, B_w1, B_w2, B_w3, B_w4):
    def _A_ref(u, log_A_real, A_imag, C_real, C_imag, log_dt, D_skip):
        L = u.shape[1]
        dt = torch.exp(log_dt)
        A = -torch.exp(log_A_real) + 1j * A_imag
        C = (C_real + 1j * C_imag) * dt[:, None]
        pos = (lambda x, dt: x.to(dt))(torch.arange(L), log_dt.dtype)
        P = torch.exp((A * dt[:, None])[:, :, None] * pos[None, None, :])
        K = 2.0 * torch.einsum("dn,dnl->dl", C, P).real
        L2 = 2 * L
        u_t = (lambda x, *d: x.permute(*d))(u, 0, 2, 1)
        Kf = (lambda x, *a, **k: torch.fft.rfft(x.float(), *a, **k))(K, L2)
        Uf = (lambda x, *a, **k: torch.fft.rfft(x.float(), *a, **k))(u_t, L2)
        y = (lambda x, *a, **k: torch.fft.irfft(x, *a, **k).to(torch.bfloat16))(Uf * Kf[None, :, :], L2)[:, :, :L]
        y = (lambda x, *d: x.permute(*d))(y, 0, 2, 1)
        return y + u * D_skip[None, None, :]

    def _B_ref(x, w1, w2, w3, w4):
        B, S, D = x.shape
        h = _gelu(_layernorm(x, axis=-1) @ w1)
        c = D // 4
        g0 = _pad(h[:, :, 0*c:1*c], ((0, 0), (1, 0), (0, 0)))[:, :S, :]
        g1 = _pad(h[:, :, 1*c:2*c], ((0, 0), (0, 1), (0, 0)))[:, 1:, :]
        g2 = _pad(h[:, :, 2*c:3*c], ((0, 0), (2, 0), (0, 0)))[:, :S, :]
        g3 = _pad(h[:, :, 3*c:   ], ((0, 0), (0, 2), (0, 0)))[:, 2:, :]
        hs = torch.concatenate([g0, g1, g2, g3], axis=-1) @ w2
        x1 = x + hs
        h2 = _gelu(_layernorm(x1, axis=-1) @ w3) @ w4
        return x1 + h2

    x = A_u
    h = x + _A_ref(_layernorm(x, axis=-1), A_log_A_real, A_A_imag, A_C_real, A_C_imag, A_log_dt, A_D_skip)
    h2 = h + _B_ref(_layernorm(h, axis=-1), B_w1, B_w2, B_w3, B_w4)
    return h2
```

```asm
; @launch kernel=mk_kernel grid=(256,1,1) block=(256,1,1) lds=163840
.amdgcn_target "amdgcn-amd-amdhsa--gfx950"
.text
.globl mk_kernel
.p2align 8
.type mk_kernel,@function
mk_kernel:
    s_cmp_ge_u32 s2, 256
    s_cbranch_scc1 mk_exit
    s_load_dwordx16 s[36:51], s[0:1], 0
    s_load_dwordx8 s[52:59], s[0:1], 64
    s_load_dwordx2 s[4:5], s[0:1], 112
    s_load_dwordx4 s[8:11], s[0:1], 96
    v_mov_b32 v1, v0
    v_lshrrev_b32 v4, 6, v0
    v_and_b32 v0, 63, v0
    v_readfirstlane_b32 s3, v4
    v_lshlrev_b32 v3, 4, v0
    v_and_b32 v6, 15, v0
    v_lshrrev_b32 v7, 4, v0
    s_mov_b32 s88, 0
    s_and_b32 s60, s2, 7
    s_lshr_b32 s61, s2, 3
    s_lshr_b32 s63, s61, 4
    s_mov_b32 s65, s63
    s_mul_i32 s62, s60, 80
    s_mul_i32 s28, s61, 3
    s_lshl_b32 s29, s61, 1
    s_add_u32 s29, s29, 15
    s_bitcmp1_b32 s60, 1
    s_cselect_b32 s30, 32, 0
    s_cselect_b32 s31, 48, 0
    s_add_u32 s28, s28, s30
    s_sub_u32 s29, s29, s31
    s_cmp_lg_u32 s63, 0
    s_cselect_b32 s28, s29, s28
    s_add_u32 s62, s62, s28
    s_and_b32 s64, s61, 15
    s_lshl_b32 s64, s64, 3
    s_add_u32 s64, s64, s60
    v_and_b32 v4, 31, v0
    v_lshlrev_b32 v4, 1, v4
    s_lshl_b32 s28, s62, 8
    s_lshl_b32 s29, s3, 6
    s_add_u32 s28, s28, s29
    v_add_u32 v4, s28, v4
    s_lshl_b32 s28, s62, 1
    v_mov_b32 v5, s28
    s_getpc_b64 s[72:73]
mk_pc:
    s_add_u32 s26, s72, mk_tbl@rel32@lo+4-94208
    s_addc_u32 s27, s73, mk_tbl@rel32@hi+12-94208
    s_mov_b32 s74, mk_exit - mk_pc
    s_mov_b32 s75, 0x00020000
    s_lshl_b32 s28, s61, 2
    s_add_u32 s28, s28, s3
    s_lshl_b32 s28, s28, 10
    s_cmp_lt_u32 s28, 94208
    s_cselect_b32 s72, s72, s26
    s_cselect_b32 s73, s73, s27
    s_cselect_b32 s74, s74, 0x20000
    buffer_load_dwordx4 a[252:255], v3, s[72:75], s28 offen
    s_lshl_b32 s16, s64, 4
    s_lshl_b32 s17, s3, 2
    s_add_u32 s18, s16, s17
    v_add_u32 v182, s18, v7
    v_mul_u32_u24 v182, 1280, v182
    v_lshl_add_u32 v182, v6, 4, v182
    s_cmp_eq_u32 s63, 0
    s_waitcnt lgkmcnt(0)
    s_cbranch_scc1 mk_lr1
    global_load_dwordx4 v[8:11], v182, s[36:37] offset:0
    global_load_dwordx4 v[12:15], v182, s[36:37] offset:256
    global_load_dwordx4 v[16:19], v182, s[36:37] offset:512
    global_load_dwordx4 v[20:23], v182, s[36:37] offset:768
    global_load_dwordx4 v[24:27], v182, s[36:37] offset:1024
mk_lr1:
    global_load_ushort v164, v4, s[38:39] offset:0
    global_load_ushort v165, v4, s[40:41] offset:0
    global_load_ushort v166, v4, s[42:43] offset:0
    global_load_ushort v167, v4, s[44:45] offset:0
    global_load_ushort v168, v5, s[46:47] offset:0
    global_load_ushort v169, v4, s[38:39] offset:256
    global_load_ushort v170, v4, s[40:41] offset:256
    global_load_ushort v171, v4, s[42:43] offset:256
    global_load_ushort v172, v4, s[44:45] offset:256
    global_load_ushort v173, v5, s[46:47] offset:2
    global_load_ushort v174, v4, s[38:39] offset:512
    global_load_ushort v175, v4, s[40:41] offset:512
    global_load_ushort v176, v4, s[42:43] offset:512
    global_load_ushort v177, v4, s[44:45] offset:512
    global_load_ushort v178, v5, s[46:47] offset:4
    global_load_ushort v224, v5, s[48:49] offset:0
    global_load_ushort v225, v5, s[48:49] offset:2
    global_load_ushort v226, v5, s[48:49] offset:4
    s_mov_b32 s6, s8
    s_mov_b32 s7, s9
    s_mov_b32 s12, s10
    s_mov_b32 s13, s11
    s_mov_b32 s14, 0x100
    s_mov_b32 s15, 0x00020000
    s_add_u32 s84, s4, 0xa80000
    s_addc_u32 s85, s5, 0
    s_mov_b32 s86, 0x5c8000
    s_mov_b32 s87, 0x00020000
    s_add_u32 s92, s4, 0x213b000
    s_addc_u32 s93, s5, 0
    s_mov_b32 s94, 0x18000
    s_mov_b32 s95, 0x00020000
    s_add_u32 s28, s4, 34885568
    s_addc_u32 s29, s5, 0
    s_load_dword s88, s[28:29], 0
    s_lshl_b32 s66, s64, 2
    s_add_u32 s66, s66, s3
    v_lshrrev_b32 v4, 3, v0
    v_and_b32 v5, 7, v0
    s_cmp_eq_u32 s63, 0
    s_cbranch_scc1 mk_p35
    s_mov_b32 s46, 2211840
    s_cmp_lt_u32 s66, 428
    s_cbranch_scc1 mk_ppx_7
    s_mov_b32 s44, s58
    s_mov_b32 s45, s59
    s_sub_u32 s65, s66, 428
    s_mov_b32 s69, 3850240
    s_movk_i32 s67, 1280
    s_movk_i32 s68, 54
    s_mul_i32 s70, s65, 205
    s_lshr_b32 s70, s70, 11
    s_mul_i32 s71, s70, 10
    s_branch mk_ppgo8
mk_ppx_7:
    s_mov_b32 s44, s56
    s_mov_b32 s45, s57
    s_add_u32 s65, s66, 112
    s_mov_b32 s69, 1638400
    s_movk_i32 s67, 3456
    s_movk_i32 s68, 20
    s_mul_i32 s70, s65, 1214
    s_lshr_b32 s70, s70, 15
    s_mul_i32 s71, s70, 27
mk_ppgo8:
    s_mov_b32 s47, 0x00020000
    s_sub_u32 s71, s65, s71
    s_lshl_b32 s72, s70, 5
    s_mul_i32 s72, s72, s67
    s_lshl_b32 s75, s71, 7
    s_add_u32 s72, s72, s75
    s_lshl_b32 s75, s71, 2
    s_mul_i32 s75, s75, s68
    s_add_u32 s75, s75, s70
    s_lshl_b32 s75, s75, 10
    s_add_u32 s37, s75, s69
    v_mul_lo_u32 v182, v4, s67
    v_lshl_add_u32 v182, v5, 4, v182
    s_lshl_b32 s38, s68, 10
    s_mov_b32 s48, s72
    s_lshl_b32 s49, s67, 3
    s_mov_b32 s40, s58
    s_mov_b32 s41, s59
    s_mov_b32 s42, 2211840
    s_add_u32 s65, s66, 84
    s_cmp_lt_u32 s65, 540
    s_cselect_b32 s69, 3850240, 1073741824
    s_movk_i32 s67, 1280
    s_movk_i32 s68, 54
    s_mul_i32 s70, s65, 205
    s_lshr_b32 s70, s70, 11
    s_mul_i32 s71, s70, 10
    s_mov_b32 s43, 0x00020000
    s_sub_u32 s71, s65, s71
    s_lshl_b32 s72, s70, 5
    s_mul_i32 s72, s72, s67
    s_lshl_b32 s75, s71, 7
    s_add_u32 s72, s72, s75
    s_lshl_b32 s75, s71, 2
    s_mul_i32 s75, s75, s68
    s_add_u32 s75, s75, s70
    s_lshl_b32 s75, s75, 10
    s_add_u32 s39, s75, s69
    v_mul_lo_u32 v183, v4, s67
    v_lshl_add_u32 v183, v5, 4, v183
    s_mov_b32 s50, s72
    s_branch mk_p3e6
mk_p35:
    s_cmp_lt_u32 s66, 400
    s_cbranch_scc0 mk_ppx_11
    s_cmp_lt_u32 s66, 200
    s_cselect_b32 s52, s52, s54
    s_cselect_b32 s53, s53, s55
    s_cselect_b32 s69, 0, 819200
    s_cselect_b32 s70, 0, 200
    s_sub_u32 s65, s66, s70
    s_mov_b32 s54, 819200
    s_movk_i32 s67, 1280
    s_movk_i32 s68, 20
    s_mul_i32 s70, s65, 205
    s_lshr_b32 s70, s70, 11
    s_mul_i32 s71, s70, 10
    s_branch mk_ppgo12
mk_ppx_11:
    s_mov_b32 s52, s56
    s_mov_b32 s53, s57
    s_mov_b32 s54, 2211840
    s_sub_u32 s65, s66, 400
    s_mov_b32 s69, 1638400
    s_movk_i32 s67, 3456
    s_movk_i32 s68, 20
    s_mul_i32 s70, s65, 1214
    s_lshr_b32 s70, s70, 15
    s_mul_i32 s71, s70, 27
mk_ppgo12:
    s_mov_b32 s55, 0x00020000
    s_sub_u32 s71, s65, s71
    s_lshl_b32 s72, s70, 5
    s_mul_i32 s72, s72, s67
    s_lshl_b32 s75, s71, 7
    s_add_u32 s72, s72, s75
    s_lshl_b32 s75, s71, 2
    s_mul_i32 s75, s75, s68
    s_add_u32 s75, s75, s70
    s_lshl_b32 s75, s75, 10
    s_add_u32 s51, s75, s69
    v_mul_lo_u32 v184, v4, s67
    v_lshl_add_u32 v184, v5, 4, v184
    s_lshl_b32 s36, s68, 10
    s_lshl_b32 s65, s67, 3
    buffer_load_dwordx4 a[0:3], v184, s[52:55], s72 offen
    s_add_u32 s72, s72, s65
    buffer_load_dwordx4 a[4:7], v184, s[52:55], s72 offen
    s_add_u32 s72, s72, s65
    buffer_load_dwordx4 a[8:11], v184, s[52:55], s72 offen
    s_add_u32 s72, s72, s65
    buffer_load_dwordx4 a[12:15], v184, s[52:55], s72 offen
    s_mov_b32 s39, 0x40000000
mk_p3e6:
    s_lshl_b32 s28, s3, 12
    s_add_u32 s28, s28, 93504
    v_bfe_u32 v4, v0, 4, 1
    v_lshlrev_b32 v4, 2, v4
    v_xor_b32 v4, v4, v5
    v_lshlrev_b32 v4, 4, v4
    v_lshrrev_b32 v5, 3, v0
    v_lshl_add_u32 v4, v5, 7, v4
    v_add_u32 v250, s28, v4
    v_xor_b32 v251, 32, v250
    v_bfe_u32 v4, v0, 2, 2
    v_lshl_add_u32 v4, v7, 3, v4
    v_lshlrev_b32 v4, 7, v4
    v_and_b32 v5, 3, v0
    v_lshl_add_u32 v4, v5, 3, v4
    v_add_u32 v4, s28, v4
    v_bfe_u32 v5, v0, 3, 1
    v_lshlrev_b32 v5, 1, v5
    v_and_b32 v98, 1, v7
    v_or_b32 v5, v5, v98
    v_xor_b32 v98, 0, v5
    v_lshl_add_u32 v252, v98, 5, v4
    v_xor_b32 v98, 1, v5
    v_lshl_add_u32 v253, v98, 5, v4
    v_xor_b32 v98, 2, v5
    v_lshl_add_u32 v254, v98, 5, v4
    v_xor_b32 v98, 3, v5
    v_lshl_add_u32 v255, v98, 5, v4
    v_add_u32 v246, s17, v7
    v_mul_u32_u24 v246, 288, v246
    v_lshl_add_u32 v246, v6, 4, v246
    s_lshr_b32 s19, s3, 1
    s_lshl_b32 s19, s19, 7
    s_add_u32 s19, s19, 69824
    v_add_u32 v246, s19, v246
    v_lshrrev_b32 v247, 2, v6
    v_mul_u32_u24 v247, 288, v247
    v_and_b32 v4, 3, v6
    v_lshl_add_u32 v247, v4, 3, v247
    v_and_b32 v4, 1, v7
    v_mul_u32_u24 v5, 2432, v4
    v_add_u32 v247, v247, v5
    v_lshrrev_b32 v5, 1, v7
    v_lshl_add_u32 v247, v5, 5, v247
    s_lshl_b32 s19, s3, 6
    s_add_u32 s19, s19, 69824
    v_add_u32 v247, s19, v247
    v_lshlrev_b32 v248, 5, v6
    v_lshl_add_u32 v248, v4, 4, v248
    v_lshl_add_u32 v248, v5, 9, v248
    s_mul_i32 s27, s64, 20480
    s_lshl_b32 s19, s3, 10
    s_add_u32 s27, s27, s19
    s_add_u32 s27, s27, 16384
    v_lshrrev_b32 v249, 1, v1
    v_mul_u32_u24 v249, 20480, v249
    v_and_b32 v4, 1, v1
    v_lshl_add_u32 v249, v4, 4, v249
    s_lshl_b32 s34, s62, 5
    s_add_u32 s34, s34, 16384
    s_lshl_b32 s76, s18, 3
    v_lshlrev_b32 v185, 3, v7
    s_and_b32 s20, s2, 7
    s_lshr_b32 s21, s2, 3
    s_lshr_b32 s22, s21, 3
    s_lshl_b32 s20, s20, 2
    s_add_u32 s22, s22, s20
    s_and_b32 s23, s21, 7
    s_add_u32 s30, s3, 0
    s_and_b32 s30, s30, 3
    s_add_u32 s31, s3, 1
    s_and_b32 s31, s31, 3
    s_add_u32 s32, s3, 2
    s_and_b32 s32, s32, 3
    s_add_u32 s33, s3, 3
    s_and_b32 s33, s33, 3
    s_mov_b32 s90, 0xbdd2d3e8
    s_mul_i32 s24, s23, 5
    s_mul_i32 s80, s24, 20480
    s_mul_i32 s26, s3, 5120
    s_add_u32 s80, s80, s26
    s_mul_i32 s74, s23, 13
    s_min_u32 s25, s23, 4
    s_add_u32 s74, s74, s25
    s_lshl_b32 s25, s3, 2
    s_min_u32 s25, s25, 11
    s_add_u32 s74, s74, s25
    s_mul_i32 s81, s74, 20480
    s_add_u32 s81, s81, 1638400
    s_mul_i32 s25, s3, 13
    s_min_u32 s26, s3, 2
    s_add_u32 s73, s25, s26
    s_lshl_b32 s25, s73, 10
    s_mul_i32 s82, s24, 55296
    s_add_u32 s82, s82, s25
    s_add_u32 s82, s82, 3850240
    s_cmp_lt_u32 s3, 2
    s_cselect_b32 s77, 0, 0x40000000
    s_mov_b32 s79, s77
    s_cmp_eq_u32 s3, 3
    s_cselect_b32 s78, 4, 100
    s_cmp_ge_u32 s23, s78
    s_cselect_b32 s78, 0x40000000, 0
    s_lshl_b32 s25, s23, 2
    s_add_u32 s25, s25, s3
    s_mul_i32 s81, s25, 40960
    s_add_u32 s81, s81, 1638400
    s_mul_i32 s78, s23, 3
    s_add_u32 s78, s78, s3
    s_cmp_eq_u32 s3, 3
    s_cselect_b32 s78, 31, s78
    s_cselect_b32 s26, 1, 0
    s_cmp_ge_u32 s78, 22
    s_cselect_b32 s78, 31, s78
    s_mul_i32 s74, s78, 40960
    s_add_u32 s74, s74, 2949120
    s_cmp_eq_u32 s78, 31
    s_cselect_b32 s74, 0x40000000, s74
    s_mul_i32 s79, s3, 6
    s_sub_u32 s79, s79, s26
    s_mul_i32 s82, s24, 55296
    s_add_u32 s82, s82, 3850240
    s_lshl_b32 s25, s79, 10
    s_add_u32 s73, s82, s25
    s_add_u32 s73, s73, 32768
    s_lshl_b32 s25, s3, 13
    s_add_u32 s82, s82, s25
    s_mov_b32 s16, s4
    s_mov_b32 s17, s5
    s_mov_b32 s18, 0x780000
    s_mov_b32 s19, 0x00020000
    v_min_u32 v210, 12, v6
    v_and_b32 v4, 1, v7
    v_mul_u32_u24 v4, 800, v4
    v_lshl_add_u32 v210, v210, 4, v4
    s_mul_i32 s28, s3, 200
    s_add_u32 s28, s28, 2048
    v_add_u32 v210, s28, v210
    s_waitcnt lgkmcnt(0)
    s_add_u32 s88, s88, 2654435769
    v_mov_b32 v245, s88
    s_cmp_eq_u32 s63, 0
    s_cbranch_scc1 mk_kgb4
    s_waitcnt vmcnt(18)
    ds_write_b128 v246, v[8:11] offset:0
    ds_write_b128 v246, v[12:15] offset:4736
    ds_write_b128 v246, v[16:19] offset:9472
    ds_write_b128 v246, v[20:23] offset:14208
    ds_write_b128 v246, v[24:27] offset:18944
    v_lshlrev_b32 v48, 16, v8
    v_and_b32 v49, 0xffff0000, v8
    v_lshlrev_b32 v50, 16, v9
    v_and_b32 v51, 0xffff0000, v9
    v_lshlrev_b32 v52, 16, v10
    v_and_b32 v53, 0xffff0000, v10
    v_lshlrev_b32 v54, 16, v11
    v_and_b32 v55, 0xffff0000, v11
    v_lshlrev_b32 v56, 16, v12
    v_and_b32 v57, 0xffff0000, v12
    v_lshlrev_b32 v58, 16, v13
    v_and_b32 v59, 0xffff0000, v13
    v_lshlrev_b32 v60, 16, v14
    v_and_b32 v61, 0xffff0000, v14
    v_lshlrev_b32 v62, 16, v15
    v_and_b32 v63, 0xffff0000, v15
    v_lshlrev_b32 v64, 16, v16
    v_and_b32 v65, 0xffff0000, v16
    v_lshlrev_b32 v66, 16, v17
    v_and_b32 v67, 0xffff0000, v17
    s_waitcnt lgkmcnt(0)
    s_barrier
    ds_read_b64_tr_b16 v[100:101], v247 offset:0
    ds_read_b64_tr_b16 v[102:103], v247 offset:1152
    ds_read_b64_tr_b16 v[104:105], v247 offset:4736
    ds_read_b64_tr_b16 v[106:107], v247 offset:5888
    ds_read_b64_tr_b16 v[108:109], v247 offset:9472
    ds_read_b64_tr_b16 v[110:111], v247 offset:10624
    ds_read_b64_tr_b16 v[112:113], v247 offset:14208
    ds_read_b64_tr_b16 v[114:115], v247 offset:15360
    ds_read_b64_tr_b16 v[116:117], v247 offset:18944
    ds_read_b64_tr_b16 v[118:119], v247 offset:20096
    v_lshlrev_b32 v68, 16, v18
    v_and_b32 v69, 0xffff0000, v18
    v_lshlrev_b32 v70, 16, v19
    v_and_b32 v71, 0xffff0000, v19
    v_lshlrev_b32 v72, 16, v20
    v_and_b32 v73, 0xffff0000, v20
    v_lshlrev_b32 v74, 16, v21
    v_and_b32 v75, 0xffff0000, v21
    v_lshlrev_b32 v76, 16, v22
    v_and_b32 v77, 0xffff0000, v22
    v_lshlrev_b32 v78, 16, v23
    v_and_b32 v79, 0xffff0000, v23
    v_lshlrev_b32 v80, 16, v24
    v_and_b32 v81, 0xffff0000, v24
    v_lshlrev_b32 v82, 16, v25
    v_and_b32 v83, 0xffff0000, v25
    v_lshlrev_b32 v84, 16, v26
    v_and_b32 v85, 0xffff0000, v26
    v_lshlrev_b32 v86, 16, v27
    v_and_b32 v87, 0xffff0000, v27
    v_pk_add_f32 v[92:93], v[48:49], v[50:51]
    v_pk_add_f32 v[88:89], v[52:53], v[54:55]
    v_pk_add_f32 v[92:93], v[92:93], v[56:57]
    v_pk_add_f32 v[88:89], v[88:89], v[58:59]
    v_pk_add_f32 v[92:93], v[92:93], v[60:61]
    v_pk_add_f32 v[88:89], v[88:89], v[62:63]
    v_pk_add_f32 v[92:93], v[92:93], v[64:65]
    v_pk_add_f32 v[88:89], v[88:89], v[66:67]
    v_pk_add_f32 v[92:93], v[92:93], v[68:69]
    v_pk_add_f32 v[88:89], v[88:89], v[70:71]
    s_waitcnt lgkmcnt(8)
    buffer_store_dwordx4 v[100:103], v248, s[16:19], s27 offen sc1
    s_add_u32 s27, s27, 4096
    v_pk_add_f32 v[92:93], v[92:93], v[72:73]
    v_pk_add_f32 v[88:89], v[88:89], v[74:75]
    v_pk_add_f32 v[92:93], v[92:93], v[76:77]
    v_pk_add_f32 v[88:89], v[88:89], v[78:79]
    v_pk_add_f32 v[92:93], v[92:93], v[80:81]
    v_pk_add_f32 v[88:89], v[88:89], v[82:83]
    v_pk_add_f32 v[92:93], v[92:93], v[84:85]
    v_pk_add_f32 v[88:89], v[88:89], v[86:87]
    v_pk_add_f32 v[92:93], v[92:93], v[88:89]
    v_add_f32 v94, v92, v93
    s_waitcnt lgkmcnt(6)
    buffer_store_dwordx4 v[104:107], v248, s[16:19], s27 offen sc1
    s_add_u32 s27, s27, 4096
    v_add_f32_dpp v94, v94, v94 row_ror:8 row_mask:0xf bank_mask:0xf
    s_nop 1
    v_add_f32_dpp v94, v94, v94 row_ror:4 row_mask:0xf bank_mask:0xf
    s_nop 1
    v_add_f32_dpp v94, v94, v94 row_ror:2 row_mask:0xf bank_mask:0xf
    s_nop 1
    v_add_f32_dpp v94, v94, v94 row_ror:1 row_mask:0xf bank_mask:0xf
    v_mul_f32 v90, 0x3acccccd, v94
    v_pk_add_f32 v[96:97], v[48:49], v[90:91] op_sel_hi:[1,0] neg_lo:[0,1] neg_hi:[0,1]
    v_pk_mul_f32 v[92:93], v[96:97], v[96:97]
    v_pk_add_f32 v[88:89], v[50:51], v[90:91] op_sel_hi:[1,0] neg_lo:[0,1] neg_hi:[0,1]
    v_pk_fma_f32 v[92:93], v[88:89], v[88:89], v[92:93]
    v_pk_add_f32 v[96:97], v[52:53], v[90:91] op_sel_hi:[1,0] neg_lo:[0,1] neg_hi:[0,1]
    s_waitcnt lgkmcnt(4)
    buffer_store_dwordx4 v[108:111], v248, s[16:19], s27 offen sc1
    s_add_u32 s27, s27, 4096
    v_pk_fma_f32 v[92:93], v[96:97], v[96:97], v[92:93]
    v_pk_add_f32 v[88:89], v[54:55], v[90:91] op_sel_hi:[1,0] neg_lo:[0,1] neg_hi:[0,1]
    v_pk_fma_f32 v[92:93], v[88:89], v[88:89], v[92:93]
    v_pk_add_f32 v[96:97], v[56:57], v[90:91] op_sel_hi:[1,0] neg_lo:[0,1] neg_hi:[0,1]
    v_pk_fma_f32 v[92:93], v[96:97], v[96:97], v[92:93]
    v_pk_add_f32 v[88:89], v[58:59], v[90:91] op_sel_hi:[1,0] neg_lo:[0,1] neg_hi:[0,1]
    v_pk_fma_f32 v[92:93], v[88:89], v[88:89], v[92:93]
    v_pk_add_f32 v[96:97], v[60:61], v[90:91] op_sel_hi:[1,0] neg_lo:[0,1] neg_hi:[0,1]
    v_pk_fma_f32 v[92:93], v[96:97], v[96:97], v[92:93]
    v_pk_add_f32 v[88:89], v[62:63], v[90:91] op_sel_hi:[1,0] neg_lo:[0,1] neg_hi:[0,1]
    s_waitcnt lgkmcnt(2)
    buffer_store_dwordx4 v[112:115], v248, s[16:19], s27 offen sc1
    s_add_u32 s27, s27, 4096
    v_pk_fma_f32 v[92:93], v[88:89], v[88:89], v[92:93]
    v_pk_add_f32 v[96:97], v[64:65], v[90:91] op_sel_hi:[1,0] neg_lo:[0,1] neg_hi:[0,1]
    v_pk_fma_f32 v[92:93], v[96:97], v[96:97], v[92:93]
    v_pk_add_f32 v[88:89], v[66:67], v[90:91] op_sel_hi:[1,0] neg_lo:[0,1] neg_hi:[0,1]
    v_pk_fma_f32 v[92:93], v[88:89], v[88:89], v[92:93]
    v_pk_add_f32 v[96:97], v[68:69], v[90:91] op_sel_hi:[1,0] neg_lo:[0,1] neg_hi:[0,1]
    v_pk_fma_f32 v[92:93], v[96:97], v[96:97], v[92:93]
    v_pk_add_f32 v[88:89], v[70:71], v[90:91] op_sel_hi:[1,0] neg_lo:[0,1] neg_hi:[0,1]
    v_pk_fma_f32 v[92:93], v[88:89], v[88:89], v[92:93]
    v_pk_add_f32 v[96:97], v[72:73], v[90:91] op_sel_hi:[1,0] neg_lo:[0,1] neg_hi:[0,1]
    s_waitcnt lgkmcnt(0)
    buffer_store_dwordx4 v[116:119], v248, s[16:19], s27 offen sc1
    v_pk_fma_f32 v[92:93], v[96:97], v[96:97], v[92:93]
    v_pk_add_f32 v[88:89], v[74:75], v[90:91] op_sel_hi:[1,0] neg_lo:[0,1] neg_hi:[0,1]
    v_pk_fma_f32 v[92:93], v[88:89], v[88:89], v[92:93]
    v_pk_add_f32 v[96:97], v[76:77], v[90:91] op_sel_hi:[1,0] neg_lo:[0,1] neg_hi:[0,1]
    v_pk_fma_f32 v[92:93], v[96:97], v[96:97], v[92:93]
    v_pk_add_f32 v[88:89], v[78:79], v[90:91] op_sel_hi:[1,0] neg_lo:[0,1] neg_hi:[0,1]
    v_pk_fma_f32 v[92:93], v[88:89], v[88:89], v[92:93]
    v_pk_add_f32 v[96:97], v[80:81], v[90:91] op_sel_hi:[1,0] neg_lo:[0,1] neg_hi:[0,1]
    v_pk_fma_f32 v[92:93], v[96:97], v[96:97], v[92:93]
    v_pk_add_f32 v[88:89], v[82:83], v[90:91] op_sel_hi:[1,0] neg_lo:[0,1] neg_hi:[0,1]
    buffer_load_dwordx4 a[16:19], v182, s[44:47], s48 offen
    s_add_u32 s48, s48, s49
    v_pk_fma_f32 v[92:93], v[88:89], v[88:89], v[92:93]
    v_pk_add_f32 v[96:97], v[84:85], v[90:91] op_sel_hi:[1,0] neg_lo:[0,1] neg_hi:[0,1]
    v_pk_fma_f32 v[92:93], v[96:97], v[96:97], v[92:93]
    v_pk_add_f32 v[88:89], v[86:87], v[90:91] op_sel_hi:[1,0] neg_lo:[0,1] neg_hi:[0,1]
    v_pk_fma_f32 v[92:93], v[88:89], v[88:89], v[92:93]
    v_add_f32 v94, v92, v93
    s_nop 1
    v_add_f32_dpp v94, v94, v94 row_ror:8 row_mask:0xf bank_mask:0xf
    s_nop 1
    v_add_f32_dpp v94, v94, v94 row_ror:4 row_mask:0xf bank_mask:0xf
    s_nop 1
    v_add_f32_dpp v94, v94, v94 row_ror:2 row_mask:0xf bank_mask:0xf
    s_nop 1
    v_add_f32_dpp v94, v94, v94 row_ror:1 row_mask:0xf bank_mask:0xf
    buffer_load_dwordx4 a[20:23], v182, s[44:47], s48 offen
    s_add_u32 s48, s48, s49
    v_mul_f32 v94, 0x3acccccd, v94
    v_cvt_pk_bf16_f32 v94, v94, v94
    v_lshlrev_b32 v94, 16, v94
    v_add_f32 v94, 0x3727c5ac, v94
    v_cvt_pk_bf16_f32 v94, v94, v94
    v_lshlrev_b32 v94, 16, v94
    v_sqrt_f32 v94, v94
    buffer_load_dwordx4 a[24:27], v182, s[44:47], s48 offen
    s_add_u32 s48, s48, s49
    v_cvt_pk_bf16_f32 v244, v90, v94
    buffer_load_dwordx4 a[28:31], v182, s[44:47], s48 offen
    buffer_load_dwordx4 a[0:3], v183, s[40:43], s50 offen
    s_add_u32 s50, s50, 10240
    buffer_load_dwordx4 a[4:7], v183, s[40:43], s50 offen
    s_add_u32 s50, s50, 10240
    buffer_load_dwordx4 a[8:11], v183, s[40:43], s50 offen
    s_add_u32 s50, s50, 10240
    buffer_load_dwordx4 a[12:15], v183, s[40:43], s50 offen
    s_mov_b32 exec_lo, 0x00010001
    s_mov_b32 exec_hi, 0x00010001
    buffer_store_dwordx2 v[244:245], v185, s[16:19], s76 offen sc1
    s_mov_b64 exec, -1
    s_waitcnt vmcnt(14)
    s_branch mk_kg3
mk_kgb4:
    v_mov_b32 v8, 0
    v_mov_b32 v9, 0
    v_mov_b32 v10, 0
    v_mov_b32 v11, 0
    s_mul_i32 s28, s3, 5632
    s_cmp_eq_u32 s3, 3
    s_cselect_b32 s28, 29792, s28
    v_add_u32 v16, s28, v3
    s_mul_i32 s28, s3, 3744
    s_add_u32 s28, s28, 16896
    v_add_u32 v17, s28, v3
    v_min_u32 v24, 2, v0
    v_mul_u32_u24 v24, 11264, v24
    v_add_u32 v24, 115680, v24
    s_waitcnt vmcnt(4)
mk_kg3:
    s_mul_i32 s28, s3, 528
    s_add_u32 s28, s28, 138528
    v_and_b32 v4, 31, v0
    v_lshl_add_u32 v4, v4, 4, s28
    v_mov_b32 v5, s28
    v_lshlrev_b32 v32, 16, v164
    v_lshlrev_b32 v33, 16, v165
    v_lshlrev_b32 v34, 16, v166
    v_lshlrev_b32 v35, 16, v167
    v_lshlrev_b32 v36, 16, v168
    v_mul_f32 v32, 0x3fb8aa3b, v32
    v_mul_f32 v36, 0x3fb8aa3b, v36
    v_lshlrev_b32 v40, 16, v169
    v_lshlrev_b32 v41, 16, v170
    v_lshlrev_b32 v42, 16, v171
    v_lshlrev_b32 v43, 16, v172
    v_lshlrev_b32 v44, 16, v173
    v_mul_f32 v40, 0x3fb8aa3b, v40
    v_mul_f32 v44, 0x3fb8aa3b, v44
    v_lshlrev_b32 v48, 16, v174
    v_lshlrev_b32 v49, 16, v175
    v_lshlrev_b32 v50, 16, v176
    v_lshlrev_b32 v51, 16, v177
    v_lshlrev_b32 v52, 16, v178
    v_mul_f32 v48, 0x3fb8aa3b, v48
    v_mul_f32 v52, 0x3fb8aa3b, v52
    v_exp_f32 v32, v32
    v_exp_f32 v36, v36
    v_max_f32 v37, |v34|, |v35|
    v_exp_f32 v40, v40
    v_exp_f32 v44, v44
    v_max_f32 v45, |v42|, |v43|
    v_exp_f32 v48, v48
    v_exp_f32 v52, v52
    v_max_f32 v53, |v50|, |v51|
    v_max_f32_dpp v37, v37, v37 row_ror:8 row_mask:0xf bank_mask:0xf
    v_max_f32_dpp v45, v45, v45 row_ror:8 row_mask:0xf bank_mask:0xf
    v_max_f32_dpp v53, v53, v53 row_ror:8 row_mask:0xf bank_mask:0xf
    v_max_f32_dpp v37, v37, v37 row_ror:4 row_mask:0xf bank_mask:0xf
    v_max_f32_dpp v45, v45, v45 row_ror:4 row_mask:0xf bank_mask:0xf
    v_max_f32_dpp v53, v53, v53 row_ror:4 row_mask:0xf bank_mask:0xf
    v_max_f32_dpp v37, v37, v37 row_ror:2 row_mask:0xf bank_mask:0xf
    v_max_f32_dpp v45, v45, v45 row_ror:2 row_mask:0xf bank_mask:0xf
    v_max_f32_dpp v53, v53, v53 row_ror:2 row_mask:0xf bank_mask:0xf
    v_max_f32_dpp v37, v37, v37 row_ror:1 row_mask:0xf bank_mask:0xf
    v_max_f32_dpp v45, v45, v45 row_ror:1 row_mask:0xf bank_mask:0xf
    v_max_f32_dpp v53, v53, v53 row_ror:1 row_mask:0xf bank_mask:0xf
    v_cvt_pk_bf16_f32 v38, v32, v36
    v_lshlrev_b32 v32, 16, v38
    v_and_b32 v36, 0xffff0000, v38
    v_cvt_pk_bf16_f32 v46, v40, v44
    v_lshlrev_b32 v40, 16, v46
    v_and_b32 v44, 0xffff0000, v46
    v_cvt_pk_bf16_f32 v54, v48, v52
    v_lshlrev_b32 v48, 16, v54
    v_and_b32 v52, 0xffff0000, v54
    v_readlane_b32 s66, v37, 0
    v_readlane_b32 s67, v37, 16
    v_readlane_b32 s68, v45, 0
    v_readlane_b32 s69, v45, 16
    v_readlane_b32 s70, v53, 0
    v_readlane_b32 s71, v53, 16
    v_mul_f32 v32, v32, v36
    v_mul_f32 v33, v33, v36
    v_mul_f32 v32, 0xbfb8aa3b, v32
    v_mul_f32 v33, 0x3e22f983, v33
    v_mul_f32 v40, v40, v44
    v_mul_f32 v41, v41, v44
    v_mul_f32 v40, 0xbfb8aa3b, v40
    v_mul_f32 v41, 0x3e22f983, v41
    v_mul_f32 v48, v48, v52
    v_mul_f32 v49, v49, v52
    v_mul_f32 v48, 0xbfb8aa3b, v48
    v_mul_f32 v49, 0x3e22f983, v49
    s_max_u32 s66, s66, s67
    s_lshr_b32 s66, s66, 23
    s_max_u32 s66, s66, 13
    s_min_u32 s66, s66, 254
    s_sub_u32 s67, 267, s66
    s_lshl_b32 s67, s67, 23
    s_sub_u32 s66, s66, 12
    s_lshl_b32 s66, s66, 23
    v_mul_f32 v34, s67, v34
    v_mul_f32 v35, s67, v35
    v_mul_f32 v38, s66, v36
    ds_write_b128 v4, v[32:35] offset:0
    ds_write_b32 v5, v38 offset:512
    s_max_u32 s68, s68, s69
    s_lshr_b32 s68, s68, 23
    s_max_u32 s68, s68, 13
    s_min_u32 s68, s68, 254
    s_sub_u32 s69, 267, s68
    s_lshl_b32 s69, s69, 23
    s_sub_u32 s68, s68, 12
    s_lshl_b32 s68, s68, 23
    v_mul_f32 v42, s69, v42
    v_mul_f32 v43, s69, v43
    v_mul_f32 v46, s68, v44
    ds_write_b128 v4, v[40:43] offset:2112
    ds_write_b32 v5, v46 offset:2624
    s_max_u32 s70, s70, s71
    s_lshr_b32 s70, s70, 23
    s_max_u32 s70, s70, 13
    s_min_u32 s70, s70, 254
    s_sub_u32 s71, 267, s70
    s_lshl_b32 s71, s71, 23
    s_sub_u32 s70, s70, 12
    s_lshl_b32 s70, s70, 23
    v_mul_f32 v50, s71, v50
    v_mul_f32 v51, s71, v51
    v_mul_f32 v54, s70, v52
    ds_write_b128 v4, v[48:51] offset:4224
    ds_write_b32 v5, v54 offset:4736
    s_cmp_eq_u32 s63, 0
    s_cbranch_scc1 mk_lno13
    s_lshl_b32 s29, s64, 4
    s_lshl_b32 s28, s3, 2
    s_add_u32 s28, s28, s29
    s_add_u32 s28, s28, 0
    s_waitcnt vmcnt(9)
    s_mov_b64 exec, 1
    buffer_store_dword v245, off, s[92:95], s28 sc1
    s_mov_b64 exec, -1
mk_lno13:
    v_cvt_f32_u32 v173, v6
    s_mul_i32 s28, s3, 528
    s_add_u32 s28, s28, 138528
    v_mov_b32 v5, s28
    v_lshl_add_u32 v174, v7, 7, s28
    s_mul_i32 s28, s3, 2816
    s_add_u32 s28, s28, 104736
    v_mul_u32_u24 v175, 68, v7
    v_add_u32 v175, v175, v6
    v_add_u32 v4, s3, v7
    v_and_b32 v4, 3, v4
    v_lshl_add_u32 v175, v175, 2, v4
    v_lshlrev_b32 v175, 2, v175
    v_add_u32 v175, 104736, v175
    s_cmp_lg_u32 s63, 0
    s_waitcnt lgkmcnt(0)
    s_cbranch_scc0 mk_kg015
    v_mov_b32 v8, 0
    v_mov_b32 v9, 0
    v_mov_b32 v10, 0
    v_mov_b32 v11, 0
    s_mul_i32 s28, s3, 5632
    s_cmp_eq_u32 s3, 3
    s_cselect_b32 s28, 29792, s28
    v_add_u32 v16, s28, v3
    s_mul_i32 s28, s3, 3744
    s_add_u32 s28, s28, 16896
    v_add_u32 v17, s28, v3
    v_min_u32 v24, 2, v0
    v_mul_u32_u24 v24, 11264, v24
    v_add_u32 v24, 115680, v24
    s_branch mk_kg114
mk_kg015:
    ds_read_b128 v[32:35], v174 offset:0
    ds_read_b128 v[36:39], v174 offset:16
    ds_read_b128 v[40:43], v174 offset:32
    ds_read_b128 v[44:47], v174 offset:48
    ds_read_b128 v[48:51], v174 offset:64
    ds_read_b128 v[52:55], v174 offset:80
    ds_read_b128 v[56:59], v174 offset:96
    ds_read_b128 v[60:63], v174 offset:112
    ds_read_b32 v172, v5 offset:512
    s_waitcnt lgkmcnt(8)
    v_pk_mul_f32 v[80:81], v[32:33], v[172:173] op_sel:[0,1] op_sel_hi:[1,1]
    v_fract_f32 v81, v81
    s_waitcnt lgkmcnt(7)
    v_pk_mul_f32 v[82:83], v[36:37], v[172:173] op_sel:[0,1] op_sel_hi:[1,1]
    v_fract_f32 v83, v83
    s_waitcnt lgkmcnt(6)
    v_pk_mul_f32 v[84:85], v[40:41], v[172:173] op_sel:[0,1] op_sel_hi:[1,1]
    v_fract_f32 v85, v85
    s_waitcnt lgkmcnt(5)
    v_pk_mul_f32 v[86:87], v[44:45], v[172:173] op_sel:[0,1] op_sel_hi:[1,1]
    v_fract_f32 v87, v87
    s_waitcnt lgkmcnt(4)
    v_pk_mul_f32 v[88:89], v[48:49], v[172:173] op_sel:[0,1] op_sel_hi:[1,1]
    v_fract_f32 v89, v89
    s_waitcnt lgkmcnt(3)
    v_pk_mul_f32 v[90:91], v[52:53], v[172:173] op_sel:[0,1] op_sel_hi:[1,1]
    v_fract_f32 v91, v91
    s_waitcnt lgkmcnt(2)
    v_pk_mul_f32 v[92:93], v[56:57], v[172:173] op_sel:[0,1] op_sel_hi:[1,1]
    v_fract_f32 v93, v93
    s_waitcnt lgkmcnt(1)
    v_pk_mul_f32 v[94:95], v[60:61], v[172:173] op_sel:[0,1] op_sel_hi:[1,1]
    v_fract_f32 v95, v95
    v_exp_f32 v80, v80
    v_cos_f32 v64, v81
    v_sin_f32 v65, v81
    v_add_u32 v18, 69824, v16
    ds_write_b128 v18, v[8:11]
    v_exp_f32 v82, v82
    v_cos_f32 v66, v83
    v_sin_f32 v67, v83
    v_add_u32 v19, 69824, v17
    ds_write_b128 v19, v[8:11]
    v_exp_f32 v84, v84
    v_cos_f32 v68, v85
    v_sin_f32 v69, v85
    ds_write_b128 v19, v[8:11] offset:1024
    v_exp_f32 v86, v86
    v_cos_f32 v70, v87
    v_sin_f32 v71, v87
    v_exp_f32 v88, v88
    v_cos_f32 v72, v89
    v_sin_f32 v73, v89
    v_exp_f32 v90, v90
    v_cos_f32 v74, v91
    v_sin_f32 v75, v91
    v_exp_f32 v92, v92
    v_cos_f32 v76, v93
    v_sin_f32 v77, v93
    v_exp_f32 v94, v94
    v_cos_f32 v78, v95
    v_sin_f32 v79, v95
    v_pk_mul_f32 v[64:65], v[64:65], v[80:81] op_sel_hi:[1,0]
    v_pk_mul_f32 v[66:67], v[66:67], v[82:83] op_sel_hi:[1,0]
    v_pk_mul_f32 v[68:69], v[68:69], v[84:85] op_sel_hi:[1,0]
    v_pk_mul_f32 v[70:71], v[70:71], v[86:87] op_sel_hi:[1,0]
    v_pk_mul_f32 v[72:73], v[72:73], v[88:89] op_sel_hi:[1,0]
    v_pk_mul_f32 v[74:75], v[74:75], v[90:91] op_sel_hi:[1,0]
    v_pk_mul_f32 v[76:77], v[76:77], v[92:93] op_sel_hi:[1,0]
    v_pk_mul_f32 v[78:79], v[78:79], v[94:95] op_sel_hi:[1,0]
    v_cvt_pk_f16_f32 v96, v64, -v65
    v_cvt_pk_f16_f32 v97, v66, -v67
    v_cvt_pk_f16_f32 v98, v68, -v69
    v_cvt_pk_f16_f32 v99, v70, -v71
    v_cvt_pk_f16_f32 v100, v72, -v73
    v_cvt_pk_f16_f32 v101, v74, -v75
    v_cvt_pk_f16_f32 v102, v76, -v77
    v_cvt_pk_f16_f32 v103, v78, -v79
    v_pk_mul_f32 v[80:81], v[64:65], v[64:65] op_sel:[1,1] op_sel_hi:[0,1]
    v_pk_mul_f32 v[82:83], v[66:67], v[66:67] op_sel:[1,1] op_sel_hi:[0,1]
    v_pk_mul_f32 v[84:85], v[68:69], v[68:69] op_sel:[1,1] op_sel_hi:[0,1]
    v_pk_mul_f32 v[86:87], v[70:71], v[70:71] op_sel:[1,1] op_sel_hi:[0,1]
    v_pk_mul_f32 v[88:89], v[72:73], v[72:73] op_sel:[1,1] op_sel_hi:[0,1]
    v_pk_mul_f32 v[90:91], v[74:75], v[74:75] op_sel:[1,1] op_sel_hi:[0,1]
    v_pk_mul_f32 v[92:93], v[76:77], v[76:77] op_sel:[1,1] op_sel_hi:[0,1]
    v_pk_mul_f32 v[94:95], v[78:79], v[78:79] op_sel:[1,1] op_sel_hi:[0,1]
    v_pk_fma_f32 v[64:65], v[64:65], v[64:65], v[80:81] op_sel_hi:[0,1,1] neg_lo:[0,0,1]
    v_pk_fma_f32 v[66:67], v[66:67], v[66:67], v[82:83] op_sel_hi:[0,1,1] neg_lo:[0,0,1]
    v_pk_fma_f32 v[68:69], v[68:69], v[68:69], v[84:85] op_sel_hi:[0,1,1] neg_lo:[0,0,1]
    v_pk_fma_f32 v[70:71], v[70:71], v[70:71], v[86:87] op_sel_hi:[0,1,1] neg_lo:[0,0,1]
    v_pk_fma_f32 v[72:73], v[72:73], v[72:73], v[88:89] op_sel_hi:[0,1,1] neg_lo:[0,0,1]
    v_pk_fma_f32 v[74:75], v[74:75], v[74:75], v[90:91] op_sel_hi:[0,1,1] neg_lo:[0,0,1]
    v_pk_fma_f32 v[76:77], v[76:77], v[76:77], v[92:93] op_sel_hi:[0,1,1] neg_lo:[0,0,1]
    v_pk_fma_f32 v[78:79], v[78:79], v[78:79], v[94:95] op_sel_hi:[0,1,1] neg_lo:[0,0,1]
    v_cvt_pk_f16_f32 v104, v64, -v65
    v_cvt_pk_f16_f32 v105, v66, -v67
    v_cvt_pk_f16_f32 v106, v68, -v69
    v_cvt_pk_f16_f32 v107, v70, -v71
    v_cvt_pk_f16_f32 v108, v72, -v73
    v_cvt_pk_f16_f32 v109, v74, -v75
    v_cvt_pk_f16_f32 v110, v76, -v77
    v_cvt_pk_f16_f32 v111, v78, -v79
    v_pk_mul_f32 v[80:81], v[64:65], v[64:65] op_sel:[1,1] op_sel_hi:[0,1]
    v_pk_mul_f32 v[82:83], v[66:67], v[66:67] op_sel:[1,1] op_sel_hi:[0,1]
    v_pk_mul_f32 v[84:85], v[68:69], v[68:69] op_sel:[1,1] op_sel_hi:[0,1]
    v_pk_mul_f32 v[86:87], v[70:71], v[70:71] op_sel:[1,1] op_sel_hi:[0,1]
    v_pk_mul_f32 v[88:89], v[72:73], v[72:73] op_sel:[1,1] op_sel_hi:[0,1]
    v_pk_mul_f32 v[90:91], v[74:75], v[74:75] op_sel:[1,1] op_sel_hi:[0,1]
    v_pk_mul_f32 v[92:93], v[76:77], v[76:77] op_sel:[1,1] op_sel_hi:[0,1]
    v_pk_mul_f32 v[94:95], v[78:79], v[78:79] op_sel:[1,1] op_sel_hi:[0,1]
    v_pk_fma_f32 v[64:65], v[64:65], v[64:65], v[80:81] op_sel_hi:[0,1,1] neg_lo:[0,0,1]
    v_pk_fma_f32 v[66:67], v[66:67], v[66:67], v[82:83] op_sel_hi:[0,1,1] neg_lo:[0,0,1]
    v_pk_fma_f32 v[68:69], v[68:69], v[68:69], v[84:85] op_sel_hi:[0,1,1] neg_lo:[0,0,1]
    v_pk_fma_f32 v[70:71], v[70:71], v[70:71], v[86:87] op_sel_hi:[0,1,1] neg_lo:[0,0,1]
    v_pk_fma_f32 v[72:73], v[72:73], v[72:73], v[88:89] op_sel_hi:[0,1,1] neg_lo:[0,0,1]
    v_pk_fma_f32 v[74:75], v[74:75], v[74:75], v[90:91] op_sel_hi:[0,1,1] neg_lo:[0,0,1]
    v_pk_fma_f32 v[76:77], v[76:77], v[76:77], v[92:93] op_sel_hi:[0,1,1] neg_lo:[0,0,1]
    v_pk_fma_f32 v[78:79], v[78:79], v[78:79], v[94:95] op_sel_hi:[0,1,1] neg_lo:[0,0,1]
    v_cvt_pk_f16_f32 v112, v64, -v65
    v_cvt_pk_f16_f32 v113, v66, -v67
    v_cvt_pk_f16_f32 v114, v68, -v69
    v_cvt_pk_f16_f32 v115, v70, -v71
    v_cvt_pk_f16_f32 v116, v72, -v73
    v_cvt_pk_f16_f32 v117, v74, -v75
    v_cvt_pk_f16_f32 v118, v76, -v77
    v_cvt_pk_f16_f32 v119, v78, -v79
    v_pk_mul_f32 v[80:81], v[64:65], v[64:65] op_sel:[1,1] op_sel_hi:[0,1]
    v_pk_mul_f32 v[82:83], v[66:67], v[66:67] op_sel:[1,1] op_sel_hi:[0,1]
    v_pk_mul_f32 v[84:85], v[68:69], v[68:69] op_sel:[1,1] op_sel_hi:[0,1]
    v_pk_mul_f32 v[86:87], v[70:71], v[70:71] op_sel:[1,1] op_sel_hi:[0,1]
    v_pk_mul_f32 v[88:89], v[72:73], v[72:73] op_sel:[1,1] op_sel_hi:[0,1]
    v_pk_mul_f32 v[90:91], v[74:75], v[74:75] op_sel:[1,1] op_sel_hi:[0,1]
    v_pk_mul_f32 v[92:93], v[76:77], v[76:77] op_sel:[1,1] op_sel_hi:[0,1]
    v_pk_mul_f32 v[94:95], v[78:79], v[78:79] op_sel:[1,1] op_sel_hi:[0,1]
    v_pk_fma_f32 v[64:65], v[64:65], v[64:65], v[80:81] op_sel_hi:[0,1,1] neg_lo:[0,0,1]
    v_pk_fma_f32 v[66:67], v[66:67], v[66:67], v[82:83] op_sel_hi:[0,1,1] neg_lo:[0,0,1]
    v_pk_fma_f32 v[68:69], v[68:69], v[68:69], v[84:85] op_sel_hi:[0,1,1] neg_lo:[0,0,1]
    v_pk_fma_f32 v[70:71], v[70:71], v[70:71], v[86:87] op_sel_hi:[0,1,1] neg_lo:[0,0,1]
    v_pk_fma_f32 v[72:73], v[72:73], v[72:73], v[88:89] op_sel_hi:[0,1,1] neg_lo:[0,0,1]
    v_pk_fma_f32 v[74:75], v[74:75], v[74:75], v[90:91] op_sel_hi:[0,1,1] neg_lo:[0,0,1]
    v_pk_fma_f32 v[76:77], v[76:77], v[76:77], v[92:93] op_sel_hi:[0,1,1] neg_lo:[0,0,1]
    v_pk_fma_f32 v[78:79], v[78:79], v[78:79], v[94:95] op_sel_hi:[0,1,1] neg_lo:[0,0,1]
    v_cvt_pk_f16_f32 v120, v64, -v65
    v_cvt_pk_f16_f32 v121, v66, -v67
    v_cvt_pk_f16_f32 v122, v68, -v69
    v_cvt_pk_f16_f32 v123, v70, -v71
    v_cvt_pk_f16_f32 v124, v72, -v73
    v_cvt_pk_f16_f32 v125, v74, -v75
    v_cvt_pk_f16_f32 v126, v76, -v77
    v_cvt_pk_f16_f32 v127, v78, -v79
    v_pk_mul_f32 v[80:81], v[64:65], v[64:65] op_sel:[1,1] op_sel_hi:[0,1]
    v_pk_mul_f32 v[82:83], v[66:67], v[66:67] op_sel:[1,1] op_sel_hi:[0,1]
    v_pk_mul_f32 v[84:85], v[68:69], v[68:69] op_sel:[1,1] op_sel_hi:[0,1]
    v_pk_mul_f32 v[86:87], v[70:71], v[70:71] op_sel:[1,1] op_sel_hi:[0,1]
    v_pk_mul_f32 v[88:89], v[72:73], v[72:73] op_sel:[1,1] op_sel_hi:[0,1]
    v_pk_mul_f32 v[90:91], v[74:75], v[74:75] op_sel:[1,1] op_sel_hi:[0,1]
    v_pk_mul_f32 v[92:93], v[76:77], v[76:77] op_sel:[1,1] op_sel_hi:[0,1]
    v_pk_mul_f32 v[94:95], v[78:79], v[78:79] op_sel:[1,1] op_sel_hi:[0,1]
    v_pk_fma_f32 v[64:65], v[64:65], v[64:65], v[80:81] op_sel_hi:[0,1,1] neg_lo:[0,0,1]
    v_pk_fma_f32 v[66:67], v[66:67], v[66:67], v[82:83] op_sel_hi:[0,1,1] neg_lo:[0,0,1]
    v_pk_fma_f32 v[68:69], v[68:69], v[68:69], v[84:85] op_sel_hi:[0,1,1] neg_lo:[0,0,1]
    v_pk_fma_f32 v[70:71], v[70:71], v[70:71], v[86:87] op_sel_hi:[0,1,1] neg_lo:[0,0,1]
    v_pk_fma_f32 v[72:73], v[72:73], v[72:73], v[88:89] op_sel_hi:[0,1,1] neg_lo:[0,0,1]
    v_pk_fma_f32 v[74:75], v[74:75], v[74:75], v[90:91] op_sel_hi:[0,1,1] neg_lo:[0,0,1]
    v_pk_fma_f32 v[76:77], v[76:77], v[76:77], v[92:93] op_sel_hi:[0,1,1] neg_lo:[0,0,1]
    v_pk_fma_f32 v[78:79], v[78:79], v[78:79], v[94:95] op_sel_hi:[0,1,1] neg_lo:[0,0,1]
    s_waitcnt vmcnt(0)
    ds_write_b128 v250, a[0:3] offset:51360
    ds_write_b128 v251, a[4:7] offset:52384
    ds_write_b128 v250, a[8:11] offset:53408
    ds_write_b128 v251, a[12:15] offset:54432
    s_waitcnt lgkmcnt(0)
    ds_read_b64_tr_b16 a[0:1], v252 offset:51360
    ds_read_b64_tr_b16 a[2:3], v252 offset:51872
    ds_read_b64_tr_b16 a[4:5], v253 offset:51360
    ds_read_b64_tr_b16 a[6:7], v253 offset:51872
    ds_read_b64_tr_b16 a[8:9], v254 offset:51360
    ds_read_b64_tr_b16 a[10:11], v254 offset:51872
    ds_read_b64_tr_b16 a[12:13], v255 offset:51360
    ds_read_b64_tr_b16 a[14:15], v255 offset:51872
    v_pk_mul_f32 v[136:137], v[34:35], v[64:65] op_sel:[1,1] op_sel_hi:[1,0]
    v_pk_mul_f32 v[138:139], v[38:39], v[66:67] op_sel:[1,1] op_sel_hi:[1,0]
    v_pk_mul_f32 v[140:141], v[42:43], v[68:69] op_sel:[1,1] op_sel_hi:[1,0]
    v_pk_mul_f32 v[142:143], v[46:47], v[70:71] op_sel:[1,1] op_sel_hi:[1,0]
    v_pk_mul_f32 v[144:145], v[50:51], v[72:73] op_sel:[1,1] op_sel_hi:[1,0]
    v_pk_mul_f32 v[146:147], v[54:55], v[74:75] op_sel:[1,1] op_sel_hi:[1,0]
    v_pk_mul_f32 v[148:149], v[58:59], v[76:77] op_sel:[1,1] op_sel_hi:[1,0]
    v_pk_mul_f32 v[150:151], v[62:63], v[78:79] op_sel:[1,1] op_sel_hi:[1,0]
    v_pk_fma_f32 v[136:137], v[34:35], v[64:65], v[136:137] op_sel_hi:[0,1,1] neg_lo:[0,0,1]
    v_pk_fma_f32 v[138:139], v[38:39], v[66:67], v[138:139] op_sel_hi:[0,1,1] neg_lo:[0,0,1]
    v_pk_fma_f32 v[140:141], v[42:43], v[68:69], v[140:141] op_sel_hi:[0,1,1] neg_lo:[0,0,1]
    v_pk_fma_f32 v[142:143], v[46:47], v[70:71], v[142:143] op_sel_hi:[0,1,1] neg_lo:[0,0,1]
    v_pk_fma_f32 v[144:145], v[50:51], v[72:73], v[144:145] op_sel_hi:[0,1,1] neg_lo:[0,0,1]
    v_pk_fma_f32 v[146:147], v[54:55], v[74:75], v[146:147] op_sel_hi:[0,1,1] neg_lo:[0,0,1]
    v_pk_fma_f32 v[148:149], v[58:59], v[76:77], v[148:149] op_sel_hi:[0,1,1] neg_lo:[0,0,1]
    v_pk_fma_f32 v[150:151], v[62:63], v[78:79], v[150:151] op_sel_hi:[0,1,1] neg_lo:[0,0,1]
    v_cvt_pk_f16_f32 v128, v136, v137
    v_cvt_pk_f16_f32 v129, v138, v139
    v_cvt_pk_f16_f32 v130, v140, v141
    v_cvt_pk_f16_f32 v131, v142, v143
    v_cvt_pk_f16_f32 v132, v144, v145
    v_cvt_pk_f16_f32 v133, v146, v147
    v_cvt_pk_f16_f32 v134, v148, v149
    v_cvt_pk_f16_f32 v135, v150, v151
    v_mfma_f32_16x16x32_f16 v[152:155], v[128:131], v[96:99], 0
    s_nop 0
    v_mfma_f32_16x16x32_f16 v[152:155], v[132:135], v[100:103], v[152:155]
    v_pk_mul_f32 v[80:81], v[64:65], v[64:65] op_sel:[1,1] op_sel_hi:[0,1]
    v_pk_mul_f32 v[82:83], v[66:67], v[66:67] op_sel:[1,1] op_sel_hi:[0,1]
    v_pk_mul_f32 v[84:85], v[68:69], v[68:69] op_sel:[1,1] op_sel_hi:[0,1]
    v_pk_mul_f32 v[86:87], v[70:71], v[70:71] op_sel:[1,1] op_sel_hi:[0,1]
    v_pk_mul_f32 v[88:89], v[72:73], v[72:73] op_sel:[1,1] op_sel_hi:[0,1]
    v_pk_mul_f32 v[90:91], v[74:75], v[74:75] op_sel:[1,1] op_sel_hi:[0,1]
    v_pk_mul_f32 v[92:93], v[76:77], v[76:77] op_sel:[1,1] op_sel_hi:[0,1]
    v_pk_mul_f32 v[94:95], v[78:79], v[78:79] op_sel:[1,1] op_sel_hi:[0,1]
    v_pk_fma_f32 v[64:65], v[64:65], v[64:65], v[80:81] op_sel_hi:[0,1,1] neg_lo:[0,0,1]
    v_pk_fma_f32 v[66:67], v[66:67], v[66:67], v[82:83] op_sel_hi:[0,1,1] neg_lo:[0,0,1]
    v_pk_fma_f32 v[68:69], v[68:69], v[68:69], v[84:85] op_sel_hi:[0,1,1] neg_lo:[0,0,1]
    v_pk_fma_f32 v[70:71], v[70:71], v[70:71], v[86:87] op_sel_hi:[0,1,1] neg_lo:[0,0,1]
    v_pk_fma_f32 v[72:73], v[72:73], v[72:73], v[88:89] op_sel_hi:[0,1,1] neg_lo:[0,0,1]
    v_pk_fma_f32 v[74:75], v[74:75], v[74:75], v[90:91] op_sel_hi:[0,1,1] neg_lo:[0,0,1]
    v_pk_fma_f32 v[76:77], v[76:77], v[76:77], v[92:93] op_sel_hi:[0,1,1] neg_lo:[0,0,1]
    v_pk_fma_f32 v[78:79], v[78:79], v[78:79], v[94:95] op_sel_hi:[0,1,1] neg_lo:[0,0,1]
    s_waitcnt lgkmcnt(0)
    buffer_store_dwordx4 a[0:3], v3, s[84:87], s51 offen sc1
    s_add_u32 s51, s51, s36
    buffer_store_dwordx4 a[4:7], v3, s[84:87], s51 offen sc1
    s_add_u32 s51, s51, s36
    v_pk_mul_f32 v[136:137], v[34:35], v[64:65] op_sel:[1,1] op_sel_hi:[1,0]
    v_pk_mul_f32 v[138:139], v[38:39], v[66:67] op_sel:[1,1] op_sel_hi:[1,0]
    v_pk_mul_f32 v[140:141], v[42:43], v[68:69] op_sel:[1,1] op_sel_hi:[1,0]
    v_pk_mul_f32 v[142:143], v[46:47], v[70:71] op_sel:[1,1] op_sel_hi:[1,0]
    v_pk_mul_f32 v[144:145], v[50:51], v[72:73] op_sel:[1,1] op_sel_hi:[1,0]
    v_pk_mul_f32 v[146:147], v[54:55], v[74:75] op_sel:[1,1] op_sel_hi:[1,0]
    v_pk_mul_f32 v[148:149], v[58:59], v[76:77] op_sel:[1,1] op_sel_hi:[1,0]
    v_pk_mul_f32 v[150:151], v[62:63], v[78:79] op_sel:[1,1] op_sel_hi:[1,0]
    v_pk_fma_f32 v[136:137], v[34:35], v[64:65], v[136:137] op_sel_hi:[0,1,1] neg_lo:[0,0,1]
    v_pk_fma_f32 v[138:139], v[38:39], v[66:67], v[138:139] op_sel_hi:[0,1,1] neg_lo:[0,0,1]
    v_pk_fma_f32 v[140:141], v[42:43], v[68:69], v[140:141] op_sel_hi:[0,1,1] neg_lo:[0,0,1]
    v_pk_fma_f32 v[142:143], v[46:47], v[70:71], v[142:143] op_sel_hi:[0,1,1] neg_lo:[0,0,1]
    v_pk_fma_f32 v[144:145], v[50:51], v[72:73], v[144:145] op_sel_hi:[0,1,1] neg_lo:[0,0,1]
    v_pk_fma_f32 v[146:147], v[54:55], v[74:75], v[146:147] op_sel_hi:[0,1,1] neg_lo:[0,0,1]
    v_pk_fma_f32 v[148:149], v[58:59], v[76:77], v[148:149] op_sel_hi:[0,1,1] neg_lo:[0,0,1]
    v_pk_fma_f32 v[150:151], v[62:63], v[78:79], v[150:151] op_sel_hi:[0,1,1] neg_lo:[0,0,1]
    v_cvt_pk_f16_f32 v128, v136, v137
    v_cvt_pk_f16_f32 v129, v138, v139
    v_cvt_pk_f16_f32 v130, v140, v141
    v_cvt_pk_f16_f32 v131, v142, v143
    v_cvt_pk_f16_f32 v132, v144, v145
    v_cvt_pk_f16_f32 v133, v146, v147
    v_cvt_pk_f16_f32 v134, v148, v149
    v_cvt_pk_f16_f32 v135, v150, v151
    v_mfma_f32_16x16x32_f16 v[156:159], v[128:131], v[104:107], 0
    s_nop 0
    v_mfma_f32_16x16x32_f16 v[156:159], v[132:135], v[108:111], v[156:159]
    v_pk_mul_f32 v[80:81], v[64:65], v[64:65] op_sel:[1,1] op_sel_hi:[0,1]
    v_pk_mul_f32 v[82:83], v[66:67], v[66:67] op_sel:[1,1] op_sel_hi:[0,1]
    v_pk_mul_f32 v[84:85], v[68:69], v[68:69] op_sel:[1,1] op_sel_hi:[0,1]
    v_pk_mul_f32 v[86:87], v[70:71], v[70:71] op_sel:[1,1] op_sel_hi:[0,1]
    v_pk_mul_f32 v[88:89], v[72:73], v[72:73] op_sel:[1,1] op_sel_hi:[0,1]
    v_pk_mul_f32 v[90:91], v[74:75], v[74:75] op_sel:[1,1] op_sel_hi:[0,1]
    v_pk_mul_f32 v[92:93], v[76:77], v[76:77] op_sel:[1,1] op_sel_hi:[0,1]
    v_pk_mul_f32 v[94:95], v[78:79], v[78:79] op_sel:[1,1] op_sel_hi:[0,1]
    v_pk_fma_f32 v[64:65], v[64:65], v[64:65], v[80:81] op_sel_hi:[0,1,1] neg_lo:[0,0,1]
    v_pk_fma_f32 v[66:67], v[66:67], v[66:67], v[82:83] op_sel_hi:[0,1,1] neg_lo:[0,0,1]
    v_pk_fma_f32 v[68:69], v[68:69], v[68:69], v[84:85] op_sel_hi:[0,1,1] neg_lo:[0,0,1]
    v_pk_fma_f32 v[70:71], v[70:71], v[70:71], v[86:87] op_sel_hi:[0,1,1] neg_lo:[0,0,1]
    v_pk_fma_f32 v[72:73], v[72:73], v[72:73], v[88:89] op_sel_hi:[0,1,1] neg_lo:[0,0,1]
    v_pk_fma_f32 v[74:75], v[74:75], v[74:75], v[90:91] op_sel_hi:[0,1,1] neg_lo:[0,0,1]
    v_pk_fma_f32 v[76:77], v[76:77], v[76:77], v[92:93] op_sel_hi:[0,1,1] neg_lo:[0,0,1]
    v_pk_fma_f32 v[78:79], v[78:79], v[78:79], v[94:95] op_sel_hi:[0,1,1] neg_lo:[0,0,1]
    buffer_store_dwordx4 a[8:11], v3, s[84:87], s51 offen sc1
    s_add_u32 s51, s51, s36
    buffer_store_dwordx4 a[12:15], v3, s[84:87], s51 offen sc1
    v_pk_mul_f32 v[136:137], v[34:35], v[64:65] op_sel:[1,1] op_sel_hi:[1,0]
    v_pk_mul_f32 v[138:139], v[38:39], v[66:67] op_sel:[1,1] op_sel_hi:[1,0]
    v_pk_mul_f32 v[140:141], v[42:43], v[68:69] op_sel:[1,1] op_sel_hi:[1,0]
    v_pk_mul_f32 v[142:143], v[46:47], v[70:71] op_sel:[1,1] op_sel_hi:[1,0]
    v_pk_mul_f32 v[144:145], v[50:51], v[72:73] op_sel:[1,1] op_sel_hi:[1,0]
    v_pk_mul_f32 v[146:147], v[54:55], v[74:75] op_sel:[1,1] op_sel_hi:[1,0]
    v_pk_mul_f32 v[148:149], v[58:59], v[76:77] op_sel:[1,1] op_sel_hi:[1,0]
    v_pk_mul_f32 v[150:151], v[62:63], v[78:79] op_sel:[1,1] op_sel_hi:[1,0]
    v_pk_fma_f32 v[136:137], v[34:35], v[64:65], v[136:137] op_sel_hi:[0,1,1] neg_lo:[0,0,1]
    v_pk_fma_f32 v[138:139], v[38:39], v[66:67], v[138:139] op_sel_hi:[0,1,1] neg_lo:[0,0,1]
    v_pk_fma_f32 v[140:141], v[42:43], v[68:69], v[140:141] op_sel_hi:[0,1,1] neg_lo:[0,0,1]
    v_pk_fma_f32 v[142:143], v[46:47], v[70:71], v[142:143] op_sel_hi:[0,1,1] neg_lo:[0,0,1]
    v_pk_fma_f32 v[144:145], v[50:51], v[72:73], v[144:145] op_sel_hi:[0,1,1] neg_lo:[0,0,1]
    v_pk_fma_f32 v[146:147], v[54:55], v[74:75], v[146:147] op_sel_hi:[0,1,1] neg_lo:[0,0,1]
    v_pk_fma_f32 v[148:149], v[58:59], v[76:77], v[148:149] op_sel_hi:[0,1,1] neg_lo:[0,0,1]
    v_pk_fma_f32 v[150:151], v[62:63], v[78:79], v[150:151] op_sel_hi:[0,1,1] neg_lo:[0,0,1]
    v_cvt_pk_f16_f32 v128, v136, v137
    v_cvt_pk_f16_f32 v129, v138, v139
    v_cvt_pk_f16_f32 v130, v140, v141
    v_cvt_pk_f16_f32 v131, v142, v143
    v_cvt_pk_f16_f32 v132, v144, v145
    v_cvt_pk_f16_f32 v133, v146, v147
    v_cvt_pk_f16_f32 v134, v148, v149
    v_cvt_pk_f16_f32 v135, v150, v151
    v_mfma_f32_16x16x32_f16 v[160:163], v[128:131], v[112:115], 0
    s_nop 0
    v_mfma_f32_16x16x32_f16 v[160:163], v[132:135], v[116:119], v[160:163]
    v_pk_mul_f32 v[80:81], v[64:65], v[64:65] op_sel:[1,1] op_sel_hi:[0,1]
    v_pk_mul_f32 v[82:83], v[66:67], v[66:67] op_sel:[1,1] op_sel_hi:[0,1]
    v_pk_mul_f32 v[84:85], v[68:69], v[68:69] op_sel:[1,1] op_sel_hi:[0,1]
    v_pk_mul_f32 v[86:87], v[70:71], v[70:71] op_sel:[1,1] op_sel_hi:[0,1]
    v_pk_mul_f32 v[88:89], v[72:73], v[72:73] op_sel:[1,1] op_sel_hi:[0,1]
    v_pk_mul_f32 v[90:91], v[74:75], v[74:75] op_sel:[1,1] op_sel_hi:[0,1]
    v_pk_mul_f32 v[92:93], v[76:77], v[76:77] op_sel:[1,1] op_sel_hi:[0,1]
    v_pk_mul_f32 v[94:95], v[78:79], v[78:79] op_sel:[1,1] op_sel_hi:[0,1]
    v_pk_fma_f32 v[64:65], v[64:65], v[64:65], v[80:81] op_sel_hi:[0,1,1] neg_lo:[0,0,1]
    v_pk_fma_f32 v[66:67], v[66:67], v[66:67], v[82:83] op_sel_hi:[0,1,1] neg_lo:[0,0,1]
    v_pk_fma_f32 v[68:69], v[68:69], v[68:69], v[84:85] op_sel_hi:[0,1,1] neg_lo:[0,0,1]
    v_pk_fma_f32 v[70:71], v[70:71], v[70:71], v[86:87] op_sel_hi:[0,1,1] neg_lo:[0,0,1]
    v_pk_fma_f32 v[72:73], v[72:73], v[72:73], v[88:89] op_sel_hi:[0,1,1] neg_lo:[0,0,1]
    v_pk_fma_f32 v[74:75], v[74:75], v[74:75], v[90:91] op_sel_hi:[0,1,1] neg_lo:[0,0,1]
    v_pk_fma_f32 v[76:77], v[76:77], v[76:77], v[92:93] op_sel_hi:[0,1,1] neg_lo:[0,0,1]
    v_pk_fma_f32 v[78:79], v[78:79], v[78:79], v[94:95] op_sel_hi:[0,1,1] neg_lo:[0,0,1]
    v_pk_mul_f32 v[136:137], v[34:35], v[64:65] op_sel:[1,1] op_sel_hi:[1,0]
    v_pk_mul_f32 v[138:139], v[38:39], v[66:67] op_sel:[1,1] op_sel_hi:[1,0]
    v_pk_mul_f32 v[140:141], v[42:43], v[68:69] op_sel:[1,1] op_sel_hi:[1,0]
    v_pk_mul_f32 v[142:143], v[46:47], v[70:71] op_sel:[1,1] op_sel_hi:[1,0]
    v_pk_mul_f32 v[144:145], v[50:51], v[72:73] op_sel:[1,1] op_sel_hi:[1,0]
    v_pk_mul_f32 v[146:147], v[54:55], v[74:75] op_sel:[1,1] op_sel_hi:[1,0]
    v_pk_mul_f32 v[148:149], v[58:59], v[76:77] op_sel:[1,1] op_sel_hi:[1,0]
    v_pk_mul_f32 v[150:151], v[62:63], v[78:79] op_sel:[1,1] op_sel_hi:[1,0]
    v_pk_fma_f32 v[136:137], v[34:35], v[64:65], v[136:137] op_sel_hi:[0,1,1] neg_lo:[0,0,1]
    v_pk_fma_f32 v[138:139], v[38:39], v[66:67], v[138:139] op_sel_hi:[0,1,1] neg_lo:[0,0,1]
    v_pk_fma_f32 v[140:141], v[42:43], v[68:69], v[140:141] op_sel_hi:[0,1,1] neg_lo:[0,0,1]
    v_pk_fma_f32 v[142:143], v[46:47], v[70:71], v[142:143] op_sel_hi:[0,1,1] neg_lo:[0,0,1]
    v_pk_fma_f32 v[144:145], v[50:51], v[72:73], v[144:145] op_sel_hi:[0,1,1] neg_lo:[0,0,1]
    v_pk_fma_f32 v[146:147], v[54:55], v[74:75], v[146:147] op_sel_hi:[0,1,1] neg_lo:[0,0,1]
    v_pk_fma_f32 v[148:149], v[58:59], v[76:77], v[148:149] op_sel_hi:[0,1,1] neg_lo:[0,0,1]
    v_pk_fma_f32 v[150:151], v[62:63], v[78:79], v[150:151] op_sel_hi:[0,1,1] neg_lo:[0,0,1]
    v_cvt_pk_f16_f32 v128, v136, v137
    v_cvt_pk_f16_f32 v129, v138, v139
    v_cvt_pk_f16_f32 v130, v140, v141
    v_cvt_pk_f16_f32 v131, v142, v143
    v_cvt_pk_f16_f32 v132, v144, v145
    v_cvt_pk_f16_f32 v133, v146, v147
    v_cvt_pk_f16_f32 v134, v148, v149
    v_cvt_pk_f16_f32 v135, v150, v151
    v_mfma_f32_16x16x32_f16 v[164:167], v[128:131], v[120:123], 0
    s_nop 0
    v_mfma_f32_16x16x32_f16 v[164:167], v[132:135], v[124:127], v[164:167]
    v_cvt_pk_f16_f32 v96, v64, -v65
    v_cvt_pk_f16_f32 v97, v66, -v67
    v_cvt_pk_f16_f32 v98, v68, -v69
    v_cvt_pk_f16_f32 v99, v70, -v71
    v_cvt_pk_f16_f32 v100, v72, -v73
    v_cvt_pk_f16_f32 v101, v74, -v75
    v_cvt_pk_f16_f32 v102, v76, -v77
    v_cvt_pk_f16_f32 v103, v78, -v79
    v_mfma_f32_16x16x32_f16 v[168:171], v[128:131], v[96:99], 0
    s_nop 0
    v_mfma_f32_16x16x32_f16 v[168:171], v[132:135], v[100:103], v[168:171]
    s_waitcnt lgkmcnt(0)
    v_pk_mul_f32 v[152:153], v[152:153], v[172:173] op_sel_hi:[1,0]
    v_pk_mul_f32 v[154:155], v[154:155], v[172:173] op_sel_hi:[1,0]
    v_pk_mul_f32 v[156:157], v[156:157], v[172:173] op_sel_hi:[1,0]
    v_pk_mul_f32 v[158:159], v[158:159], v[172:173] op_sel_hi:[1,0]
    v_pk_mul_f32 v[160:161], v[160:161], v[172:173] op_sel_hi:[1,0]
    v_pk_mul_f32 v[162:163], v[162:163], v[172:173] op_sel_hi:[1,0]
    v_pk_mul_f32 v[164:165], v[164:165], v[172:173] op_sel_hi:[1,0]
    v_pk_mul_f32 v[166:167], v[166:167], v[172:173] op_sel_hi:[1,0]
    ds_write_b32 v175, v152 offset:0
    ds_write_b32 v175, v153 offset:272
    ds_write_b32 v175, v154 offset:544
    ds_write_b32 v175, v155 offset:816
    v_mul_f32 v168, v168, v172
    s_mov_b32 exec_lo, 0
    ds_write_b32 v175, v156 offset:2176
    ds_write_b32 v175, v157 offset:2448
    ds_write_b32 v175, v158 offset:2720
    ds_write_b32 v175, v159 offset:2992
    ds_write_b32 v175, v160 offset:4352
    ds_write_b32 v175, v161 offset:4624
    ds_write_b32 v175, v162 offset:4896
    ds_write_b32 v175, v163 offset:5168
    ds_write_b32 v175, v164 offset:6528
    ds_write_b32 v175, v165 offset:6800
    ds_write_b32 v175, v166 offset:7072
    ds_write_b32 v175, v167 offset:7344
    s_mov_b32 exec_hi, 0x100
    ds_write_b32 v175, v168 offset:8576
    s_mov_b64 exec, -1
mk_kg114:
    ds_read_b128 v[32:35], v174 offset:2112
    ds_read_b128 v[36:39], v174 offset:2128
    ds_read_b128 v[40:43], v174 offset:2144
    ds_read_b128 v[44:47], v174 offset:2160
    ds_read_b128 v[48:51], v174 offset:2176
    ds_read_b128 v[52:55], v174 offset:2192
    ds_read_b128 v[56:59], v174 offset:2208
    ds_read_b128 v[60:63], v174 offset:2224
    ds_read_b32 v172, v5 offset:2624
    s_waitcnt lgkmcnt(8)
    v_pk_mul_f32 v[80:81], v[32:33], v[172:173] op_sel:[0,1] op_sel_hi:[1,1]
    v_fract_f32 v81, v81
    s_waitcnt lgkmcnt(7)
    v_pk_mul_f32 v[82:83], v[36:37], v[172:173] op_sel:[0,1] op_sel_hi:[1,1]
    v_fract_f32 v83, v83
    s_waitcnt lgkmcnt(6)
    v_pk_mul_f32 v[84:85], v[40:41], v[172:173] op_sel:[0,1] op_sel_hi:[1,1]
    v_fract_f32 v85, v85
    s_waitcnt lgkmcnt(5)
    v_pk_mul_f32 v[86:87], v[44:45], v[172:173] op_sel:[0,1] op_sel_hi:[1,1]
    v_fract_f32 v87, v87
    s_waitcnt lgkmcnt(4)
    v_pk_mul_f32 v[88:89], v[48:49], v[172:173] op_sel:[0,1] op_sel_hi:[1,1]
    v_fract_f32 v89, v89
    s_waitcnt lgkmcnt(3)
    v_pk_mul_f32 v[90:91], v[52:53], v[172:173] op_sel:[0,1] op_sel_hi:[1,1]
    v_fract_f32 v91, v91
    s_waitcnt lgkmcnt(2)
    v_pk_mul_f32 v[92:93], v[56:57], v[172:173] op_sel:[0,1] op_sel_hi:[1,1]
    v_fract_f32 v93, v93
    s_waitcnt lgkmcnt(1)
    v_pk_mul_f32 v[94:95], v[60:61], v[172:173] op_sel:[0,1] op_sel_hi:[1,1]
    v_fract_f32 v95, v95
    s_lshl_b32 s26, s3, 13
    s_add_u32 s26, s26, 4096
    v_add_u32 v4, s26, v3
    v_add_u32 v220, 0x8000, v3
    s_getpc_b64 s[26:27]
    s_add_u32 s26, s26, mk_tbl@rel32@lo+4
    s_addc_u32 s27, s27, mk_tbl@rel32@hi+12
    v_exp_f32 v80, v80
    v_cos_f32 v64, v81
    v_sin_f32 v65, v81
    ds_write_b128 v16, v[8:11] offset:0
    v_exp_f32 v82, v82
    v_cos_f32 v66, v83
    v_sin_f32 v67, v83
    ds_write_b128 v17, v[8:11] offset:0
    v_exp_f32 v84, v84
    v_cos_f32 v68, v85
    v_sin_f32 v69, v85
    ds_write_b128 v17, v[8:11] offset:1024
    v_exp_f32 v86, v86
    v_cos_f32 v70, v87
    v_sin_f32 v71, v87
    ds_write_b128 v16, v[8:11] offset:34912
    v_exp_f32 v88, v88
    v_cos_f32 v72, v89
    v_sin_f32 v73, v89
    ds_write_b128 v17, v[8:11] offset:34912
    v_exp_f32 v90, v90
    v_cos_f32 v74, v91
    v_sin_f32 v75, v91
    ds_write_b128 v17, v[8:11] offset:35936
    v_exp_f32 v92, v92
    v_cos_f32 v76, v93
    v_sin_f32 v77, v93
    ds_write_b128 v24, v[8:11]
    v_exp_f32 v94, v94
    v_cos_f32 v78, v95
    v_sin_f32 v79, v95
    v_pk_mul_f32 v[64:65], v[64:65], v[80:81] op_sel_hi:[1,0]
    v_pk_mul_f32 v[66:67], v[66:67], v[82:83] op_sel_hi:[1,0]
    v_pk_mul_f32 v[68:69], v[68:69], v[84:85] op_sel_hi:[1,0]
    v_pk_mul_f32 v[70:71], v[70:71], v[86:87] op_sel_hi:[1,0]
    v_pk_mul_f32 v[72:73], v[72:73], v[88:89] op_sel_hi:[1,0]
    v_pk_mul_f32 v[74:75], v[74:75], v[90:91] op_sel_hi:[1,0]
    v_pk_mul_f32 v[76:77], v[76:77], v[92:93] op_sel_hi:[1,0]
    v_pk_mul_f32 v[78:79], v[78:79], v[94:95] op_sel_hi:[1,0]
    v_cvt_pk_f16_f32 v96, v64, -v65
    v_cvt_pk_f16_f32 v97, v66, -v67
    v_cvt_pk_f16_f32 v98, v68, -v69
    v_cvt_pk_f16_f32 v99, v70, -v71
    v_cvt_pk_f16_f32 v100, v72, -v73
    v_cvt_pk_f16_f32 v101, v74, -v75
    v_cvt_pk_f16_f32 v102, v76, -v77
    v_cvt_pk_f16_f32 v103, v78, -v79
    v_pk_mul_f32 v[80:81], v[64:65], v[64:65] op_sel:[1,1] op_sel_hi:[0,1]
    v_pk_mul_f32 v[82:83], v[66:67], v[66:67] op_sel:[1,1] op_sel_hi:[0,1]
    v_pk_mul_f32 v[84:85], v[68:69], v[68:69] op_sel:[1,1] op_sel_hi:[0,1]
    v_pk_mul_f32 v[86:87], v[70:71], v[70:71] op_sel:[1,1] op_sel_hi:[0,1]
    v_pk_mul_f32 v[88:89], v[72:73], v[72:73] op_sel:[1,1] op_sel_hi:[0,1]
    v_pk_mul_f32 v[90:91], v[74:75], v[74:75] op_sel:[1,1] op_sel_hi:[0,1]
    v_pk_mul_f32 v[92:93], v[76:77], v[76:77] op_sel:[1,1] op_sel_hi:[0,1]
    v_pk_mul_f32 v[94:95], v[78:79], v[78:79] op_sel:[1,1] op_sel_hi:[0,1]
    v_pk_fma_f32 v[64:65], v[64:65], v[64:65], v[80:81] op_sel_hi:[0,1,1] neg_lo:[0,0,1]
    v_pk_fma_f32 v[66:67], v[66:67], v[66:67], v[82:83] op_sel_hi:[0,1,1] neg_lo:[0,0,1]
    v_pk_fma_f32 v[68:69], v[68:69], v[68:69], v[84:85] op_sel_hi:[0,1,1] neg_lo:[0,0,1]
    v_pk_fma_f32 v[70:71], v[70:71], v[70:71], v[86:87] op_sel_hi:[0,1,1] neg_lo:[0,0,1]
    v_pk_fma_f32 v[72:73], v[72:73], v[72:73], v[88:89] op_sel_hi:[0,1,1] neg_lo:[0,0,1]
    v_pk_fma_f32 v[74:75], v[74:75], v[74:75], v[90:91] op_sel_hi:[0,1,1] neg_lo:[0,0,1]
    v_pk_fma_f32 v[76:77], v[76:77], v[76:77], v[92:93] op_sel_hi:[0,1,1] neg_lo:[0,0,1]
    v_pk_fma_f32 v[78:79], v[78:79], v[78:79], v[94:95] op_sel_hi:[0,1,1] neg_lo:[0,0,1]
    global_load_dwordx4 a[236:239], v220, s[26:27] offset:0
    v_cvt_pk_f16_f32 v104, v64, -v65
    v_cvt_pk_f16_f32 v105, v66, -v67
    v_cvt_pk_f16_f32 v106, v68, -v69
    v_cvt_pk_f16_f32 v107, v70, -v71
    v_cvt_pk_f16_f32 v108, v72, -v73
    v_cvt_pk_f16_f32 v109, v74, -v75
    v_cvt_pk_f16_f32 v110, v76, -v77
    v_cvt_pk_f16_f32 v111, v78, -v79
    v_pk_mul_f32 v[80:81], v[64:65], v[64:65] op_sel:[1,1] op_sel_hi:[0,1]
    v_pk_mul_f32 v[82:83], v[66:67], v[66:67] op_sel:[1,1] op_sel_hi:[0,1]
    v_pk_mul_f32 v[84:85], v[68:69], v[68:69] op_sel:[1,1] op_sel_hi:[0,1]
    v_pk_mul_f32 v[86:87], v[70:71], v[70:71] op_sel:[1,1] op_sel_hi:[0,1]
    v_pk_mul_f32 v[88:89], v[72:73], v[72:73] op_sel:[1,1] op_sel_hi:[0,1]
    v_pk_mul_f32 v[90:91], v[74:75], v[74:75] op_sel:[1,1] op_sel_hi:[0,1]
    v_pk_mul_f32 v[92:93], v[76:77], v[76:77] op_sel:[1,1] op_sel_hi:[0,1]
    v_pk_mul_f32 v[94:95], v[78:79], v[78:79] op_sel:[1,1] op_sel_hi:[0,1]
    v_pk_fma_f32 v[64:65], v[64:65], v[64:65], v[80:81] op_sel_hi:[0,1,1] neg_lo:[0,0,1]
    v_pk_fma_f32 v[66:67], v[66:67], v[66:67], v[82:83] op_sel_hi:[0,1,1] neg_lo:[0,0,1]
    v_pk_fma_f32 v[68:69], v[68:69], v[68:69], v[84:85] op_sel_hi:[0,1,1] neg_lo:[0,0,1]
    v_pk_fma_f32 v[70:71], v[70:71], v[70:71], v[86:87] op_sel_hi:[0,1,1] neg_lo:[0,0,1]
    v_pk_fma_f32 v[72:73], v[72:73], v[72:73], v[88:89] op_sel_hi:[0,1,1] neg_lo:[0,0,1]
    v_pk_fma_f32 v[74:75], v[74:75], v[74:75], v[90:91] op_sel_hi:[0,1,1] neg_lo:[0,0,1]
    v_pk_fma_f32 v[76:77], v[76:77], v[76:77], v[92:93] op_sel_hi:[0,1,1] neg_lo:[0,0,1]
    v_pk_fma_f32 v[78:79], v[78:79], v[78:79], v[94:95] op_sel_hi:[0,1,1] neg_lo:[0,0,1]
    global_load_dwordx4 a[240:243], v220, s[26:27] offset:1024
    v_cvt_pk_f16_f32 v112, v64, -v65
    v_cvt_pk_f16_f32 v113, v66, -v67
    v_cvt_pk_f16_f32 v114, v68, -v69
    v_cvt_pk_f16_f32 v115, v70, -v71
    v_cvt_pk_f16_f32 v116, v72, -v73
    v_cvt_pk_f16_f32 v117, v74, -v75
    v_cvt_pk_f16_f32 v118, v76, -v77
    v_cvt_pk_f16_f32 v119, v78, -v79
    v_pk_mul_f32 v[80:81], v[64:65], v[64:65] op_sel:[1,1] op_sel_hi:[0,1]
    v_pk_mul_f32 v[82:83], v[66:67], v[66:67] op_sel:[1,1] op_sel_hi:[0,1]
    v_pk_mul_f32 v[84:85], v[68:69], v[68:69] op_sel:[1,1] op_sel_hi:[0,1]
    v_pk_mul_f32 v[86:87], v[70:71], v[70:71] op_sel:[1,1] op_sel_hi:[0,1]
    v_pk_mul_f32 v[88:89], v[72:73], v[72:73] op_sel:[1,1] op_sel_hi:[0,1]
    v_pk_mul_f32 v[90:91], v[74:75], v[74:75] op_sel:[1,1] op_sel_hi:[0,1]
    v_pk_mul_f32 v[92:93], v[76:77], v[76:77] op_sel:[1,1] op_sel_hi:[0,1]
    v_pk_mul_f32 v[94:95], v[78:79], v[78:79] op_sel:[1,1] op_sel_hi:[0,1]
    v_pk_fma_f32 v[64:65], v[64:65], v[64:65], v[80:81] op_sel_hi:[0,1,1] neg_lo:[0,0,1]
    v_pk_fma_f32 v[66:67], v[66:67], v[66:67], v[82:83] op_sel_hi:[0,1,1] neg_lo:[0,0,1]
    v_pk_fma_f32 v[68:69], v[68:69], v[68:69], v[84:85] op_sel_hi:[0,1,1] neg_lo:[0,0,1]
    v_pk_fma_f32 v[70:71], v[70:71], v[70:71], v[86:87] op_sel_hi:[0,1,1] neg_lo:[0,0,1]
    v_pk_fma_f32 v[72:73], v[72:73], v[72:73], v[88:89] op_sel_hi:[0,1,1] neg_lo:[0,0,1]
    v_pk_fma_f32 v[74:75], v[74:75], v[74:75], v[90:91] op_sel_hi:[0,1,1] neg_lo:[0,0,1]
    v_pk_fma_f32 v[76:77], v[76:77], v[76:77], v[92:93] op_sel_hi:[0,1,1] neg_lo:[0,0,1]
    v_pk_fma_f32 v[78:79], v[78:79], v[78:79], v[94:95] op_sel_hi:[0,1,1] neg_lo:[0,0,1]
    global_load_dwordx4 a[244:247], v220, s[26:27] offset:2048
    v_cvt_pk_f16_f32 v120, v64, -v65
    v_cvt_pk_f16_f32 v121, v66, -v67
    v_cvt_pk_f16_f32 v122, v68, -v69
    v_cvt_pk_f16_f32 v123, v70, -v71
    v_cvt_pk_f16_f32 v124, v72, -v73
    v_cvt_pk_f16_f32 v125, v74, -v75
    v_cvt_pk_f16_f32 v126, v76, -v77
    v_cvt_pk_f16_f32 v127, v78, -v79
    v_pk_mul_f32 v[80:81], v[64:65], v[64:65] op_sel:[1,1] op_sel_hi:[0,1]
    v_pk_mul_f32 v[82:83], v[66:67], v[66:67] op_sel:[1,1] op_sel_hi:[0,1]
    v_pk_mul_f32 v[84:85], v[68:69], v[68:69] op_sel:[1,1] op_sel_hi:[0,1]
    v_pk_mul_f32 v[86:87], v[70:71], v[70:71] op_sel:[1,1] op_sel_hi:[0,1]
    v_pk_mul_f32 v[88:89], v[72:73], v[72:73] op_sel:[1,1] op_sel_hi:[0,1]
    v_pk_mul_f32 v[90:91], v[74:75], v[74:75] op_sel:[1,1] op_sel_hi:[0,1]
    v_pk_mul_f32 v[92:93], v[76:77], v[76:77] op_sel:[1,1] op_sel_hi:[0,1]
    v_pk_mul_f32 v[94:95], v[78:79], v[78:79] op_sel:[1,1] op_sel_hi:[0,1]
    v_pk_fma_f32 v[64:65], v[64:65], v[64:65], v[80:81] op_sel_hi:[0,1,1] neg_lo:[0,0,1]
    v_pk_fma_f32 v[66:67], v[66:67], v[66:67], v[82:83] op_sel_hi:[0,1,1] neg_lo:[0,0,1]
    v_pk_fma_f32 v[68:69], v[68:69], v[68:69], v[84:85] op_sel_hi:[0,1,1] neg_lo:[0,0,1]
    v_pk_fma_f32 v[70:71], v[70:71], v[70:71], v[86:87] op_sel_hi:[0,1,1] neg_lo:[0,0,1]
    v_pk_fma_f32 v[72:73], v[72:73], v[72:73], v[88:89] op_sel_hi:[0,1,1] neg_lo:[0,0,1]
    v_pk_fma_f32 v[74:75], v[74:75], v[74:75], v[90:91] op_sel_hi:[0,1,1] neg_lo:[0,0,1]
    v_pk_fma_f32 v[76:77], v[76:77], v[76:77], v[92:93] op_sel_hi:[0,1,1] neg_lo:[0,0,1]
    v_pk_fma_f32 v[78:79], v[78:79], v[78:79], v[94:95] op_sel_hi:[0,1,1] neg_lo:[0,0,1]
    global_load_dwordx4 a[248:251], v220, s[26:27] offset:3072
    v_pk_mul_f32 v[136:137], v[34:35], v[64:65] op_sel:[1,1] op_sel_hi:[1,0]
    v_pk_mul_f32 v[138:139], v[38:39], v[66:67] op_sel:[1,1] op_sel_hi:[1,0]
    v_pk_mul_f32 v[140:141], v[42:43], v[68:69] op_sel:[1,1] op_sel_hi:[1,0]
    v_pk_mul_f32 v[142:143], v[46:47], v[70:71] op_sel:[1,1] op_sel_hi:[1,0]
    v_pk_mul_f32 v[144:145], v[50:51], v[72:73] op_sel:[1,1] op_sel_hi:[1,0]
    v_pk_mul_f32 v[146:147], v[54:55], v[74:75] op_sel:[1,1] op_sel_hi:[1,0]
    v_pk_mul_f32 v[148:149], v[58:59], v[76:77] op_sel:[1,1] op_sel_hi:[1,0]
    v_pk_mul_f32 v[150:151], v[62:63], v[78:79] op_sel:[1,1] op_sel_hi:[1,0]
    v_pk_fma_f32 v[136:137], v[34:35], v[64:65], v[136:137] op_sel_hi:[0,1,1] neg_lo:[0,0,1]
    v_pk_fma_f32 v[138:139], v[38:39], v[66:67], v[138:139] op_sel_hi:[0,1,1] neg_lo:[0,0,1]
    v_pk_fma_f32 v[140:141], v[42:43], v[68:69], v[140:141] op_sel_hi:[0,1,1] neg_lo:[0,0,1]
    v_pk_fma_f32 v[142:143], v[46:47], v[70:71], v[142:143] op_sel_hi:[0,1,1] neg_lo:[0,0,1]
    v_pk_fma_f32 v[144:145], v[50:51], v[72:73], v[144:145] op_sel_hi:[0,1,1] neg_lo:[0,0,1]
    v_pk_fma_f32 v[146:147], v[54:55], v[74:75], v[146:147] op_sel_hi:[0,1,1] neg_lo:[0,0,1]
    v_pk_fma_f32 v[148:149], v[58:59], v[76:77], v[148:149] op_sel_hi:[0,1,1] neg_lo:[0,0,1]
    v_pk_fma_f32 v[150:151], v[62:63], v[78:79], v[150:151] op_sel_hi:[0,1,1] neg_lo:[0,0,1]
    v_cvt_pk_f16_f32 v128, v136, v137
    v_cvt_pk_f16_f32 v129, v138, v139
    v_cvt_pk_f16_f32 v130, v140, v141
    v_cvt_pk_f16_f32 v131, v142, v143
    v_cvt_pk_f16_f32 v132, v144, v145
    v_cvt_pk_f16_f32 v133, v146, v147
    v_cvt_pk_f16_f32 v134, v148, v149
    v_cvt_pk_f16_f32 v135, v150, v151
    v_mfma_f32_16x16x32_f16 v[152:155], v[128:131], v[96:99], 0
    s_nop 0
    v_mfma_f32_16x16x32_f16 v[152:155], v[132:135], v[100:103], v[152:155]
    global_load_dwordx4 v[182:185], v4, s[26:27] offset:-4096
    global_load_dwordx4 v[186:189], v4, s[26:27] offset:-3072
    v_pk_mul_f32 v[80:81], v[64:65], v[64:65] op_sel:[1,1] op_sel_hi:[0,1]
    v_pk_mul_f32 v[82:83], v[66:67], v[66:67] op_sel:[1,1] op_sel_hi:[0,1]
    v_pk_mul_f32 v[84:85], v[68:69], v[68:69] op_sel:[1,1] op_sel_hi:[0,1]
    v_pk_mul_f32 v[86:87], v[70:71], v[70:71] op_sel:[1,1] op_sel_hi:[0,1]
    v_pk_mul_f32 v[88:89], v[72:73], v[72:73] op_sel:[1,1] op_sel_hi:[0,1]
    v_pk_mul_f32 v[90:91], v[74:75], v[74:75] op_sel:[1,1] op_sel_hi:[0,1]
    v_pk_mul_f32 v[92:93], v[76:77], v[76:77] op_sel:[1,1] op_sel_hi:[0,1]
    v_pk_mul_f32 v[94:95], v[78:79], v[78:79] op_sel:[1,1] op_sel_hi:[0,1]
    v_pk_fma_f32 v[64:65], v[64:65], v[64:65], v[80:81] op_sel_hi:[0,1,1] neg_lo:[0,0,1]
    v_pk_fma_f32 v[66:67], v[66:67], v[66:67], v[82:83] op_sel_hi:[0,1,1] neg_lo:[0,0,1]
    v_pk_fma_f32 v[68:69], v[68:69], v[68:69], v[84:85] op_sel_hi:[0,1,1] neg_lo:[0,0,1]
    v_pk_fma_f32 v[70:71], v[70:71], v[70:71], v[86:87] op_sel_hi:[0,1,1] neg_lo:[0,0,1]
    v_pk_fma_f32 v[72:73], v[72:73], v[72:73], v[88:89] op_sel_hi:[0,1,1] neg_lo:[0,0,1]
    v_pk_fma_f32 v[74:75], v[74:75], v[74:75], v[90:91] op_sel_hi:[0,1,1] neg_lo:[0,0,1]
    v_pk_fma_f32 v[76:77], v[76:77], v[76:77], v[92:93] op_sel_hi:[0,1,1] neg_lo:[0,0,1]
    v_pk_fma_f32 v[78:79], v[78:79], v[78:79], v[94:95] op_sel_hi:[0,1,1] neg_lo:[0,0,1]
    s_cmp_eq_u32 s63, 0
    s_cbranch_scc0 mk_lno17
    s_lshl_b32 s29, s64, 4
    s_lshl_b32 s28, s3, 2
    s_add_u32 s28, s28, s29
    s_add_u32 s28, s28, 2048
    s_waitcnt vmcnt(6)
    s_mov_b64 exec, 1
    buffer_store_dword v245, off, s[92:95], s28 sc1
    s_mov_b64 exec, -1
mk_lno17:
    v_pk_mul_f32 v[136:137], v[34:35], v[64:65] op_sel:[1,1] op_sel_hi:[1,0]
    v_pk_mul_f32 v[138:139], v[38:39], v[66:67] op_sel:[1,1] op_sel_hi:[1,0]
    v_pk_mul_f32 v[140:141], v[42:43], v[68:69] op_sel:[1,1] op_sel_hi:[1,0]
    v_pk_mul_f32 v[142:143], v[46:47], v[70:71] op_sel:[1,1] op_sel_hi:[1,0]
    v_pk_mul_f32 v[144:145], v[50:51], v[72:73] op_sel:[1,1] op_sel_hi:[1,0]
    v_pk_mul_f32 v[146:147], v[54:55], v[74:75] op_sel:[1,1] op_sel_hi:[1,0]
    v_pk_mul_f32 v[148:149], v[58:59], v[76:77] op_sel:[1,1] op_sel_hi:[1,0]
    v_pk_mul_f32 v[150:151], v[62:63], v[78:79] op_sel:[1,1] op_sel_hi:[1,0]
    v_pk_fma_f32 v[136:137], v[34:35], v[64:65], v[136:137] op_sel_hi:[0,1,1] neg_lo:[0,0,1]
    v_pk_fma_f32 v[138:139], v[38:39], v[66:67], v[138:139] op_sel_hi:[0,1,1] neg_lo:[0,0,1]
    v_pk_fma_f32 v[140:141], v[42:43], v[68:69], v[140:141] op_sel_hi:[0,1,1] neg_lo:[0,0,1]
    v_pk_fma_f32 v[142:143], v[46:47], v[70:71], v[142:143] op_sel_hi:[0,1,1] neg_lo:[0,0,1]
    v_pk_fma_f32 v[144:145], v[50:51], v[72:73], v[144:145] op_sel_hi:[0,1,1] neg_lo:[0,0,1]
    v_pk_fma_f32 v[146:147], v[54:55], v[74:75], v[146:147] op_sel_hi:[0,1,1] neg_lo:[0,0,1]
    v_pk_fma_f32 v[148:149], v[58:59], v[76:77], v[148:149] op_sel_hi:[0,1,1] neg_lo:[0,0,1]
    v_pk_fma_f32 v[150:151], v[62:63], v[78:79], v[150:151] op_sel_hi:[0,1,1] neg_lo:[0,0,1]
    v_cvt_pk_f16_f32 v128, v136, v137
    v_cvt_pk_f16_f32 v129, v138, v139
    v_cvt_pk_f16_f32 v130, v140, v141
    v_cvt_pk_f16_f32 v131, v142, v143
    v_cvt_pk_f16_f32 v132, v144, v145
    v_cvt_pk_f16_f32 v133, v146, v147
    v_cvt_pk_f16_f32 v134, v148, v149
    v_cvt_pk_f16_f32 v135, v150, v151
    v_mfma_f32_16x16x32_f16 v[156:159], v[128:131], v[104:107], 0
    s_nop 0
    v_mfma_f32_16x16x32_f16 v[156:159], v[132:135], v[108:111], v[156:159]
    global_load_dwordx4 v[190:193], v4, s[26:27] offset:-2048
    global_load_dwordx4 v[194:197], v4, s[26:27] offset:-1024
    v_pk_mul_f32 v[80:81], v[64:65], v[64:65] op_sel:[1,1] op_sel_hi:[0,1]
    v_pk_mul_f32 v[82:83], v[66:67], v[66:67] op_sel:[1,1] op_sel_hi:[0,1]
    v_pk_mul_f32 v[84:85], v[68:69], v[68:69] op_sel:[1,1] op_sel_hi:[0,1]
    v_pk_mul_f32 v[86:87], v[70:71], v[70:71] op_sel:[1,1] op_sel_hi:[0,1]
    v_pk_mul_f32 v[88:89], v[72:73], v[72:73] op_sel:[1,1] op_sel_hi:[0,1]
    v_pk_mul_f32 v[90:91], v[74:75], v[74:75] op_sel:[1,1] op_sel_hi:[0,1]
    v_pk_mul_f32 v[92:93], v[76:77], v[76:77] op_sel:[1,1] op_sel_hi:[0,1]
    v_pk_mul_f32 v[94:95], v[78:79], v[78:79] op_sel:[1,1] op_sel_hi:[0,1]
    v_pk_fma_f32 v[64:65], v[64:65], v[64:65], v[80:81] op_sel_hi:[0,1,1] neg_lo:[0,0,1]
    v_pk_fma_f32 v[66:67], v[66:67], v[66:67], v[82:83] op_sel_hi:[0,1,1] neg_lo:[0,0,1]
    v_pk_fma_f32 v[68:69], v[68:69], v[68:69], v[84:85] op_sel_hi:[0,1,1] neg_lo:[0,0,1]
    v_pk_fma_f32 v[70:71], v[70:71], v[70:71], v[86:87] op_sel_hi:[0,1,1] neg_lo:[0,0,1]
    v_pk_fma_f32 v[72:73], v[72:73], v[72:73], v[88:89] op_sel_hi:[0,1,1] neg_lo:[0,0,1]
    v_pk_fma_f32 v[74:75], v[74:75], v[74:75], v[90:91] op_sel_hi:[0,1,1] neg_lo:[0,0,1]
    v_pk_fma_f32 v[76:77], v[76:77], v[76:77], v[92:93] op_sel_hi:[0,1,1] neg_lo:[0,0,1]
    v_pk_fma_f32 v[78:79], v[78:79], v[78:79], v[94:95] op_sel_hi:[0,1,1] neg_lo:[0,0,1]
    v_pk_mul_f32 v[136:137], v[34:35], v[64:65] op_sel:[1,1] op_sel_hi:[1,0]
    v_pk_mul_f32 v[138:139], v[38:39], v[66:67] op_sel:[1,1] op_sel_hi:[1,0]
    v_pk_mul_f32 v[140:141], v[42:43], v[68:69] op_sel:[1,1] op_sel_hi:[1,0]
    v_pk_mul_f32 v[142:143], v[46:47], v[70:71] op_sel:[1,1] op_sel_hi:[1,0]
    v_pk_mul_f32 v[144:145], v[50:51], v[72:73] op_sel:[1,1] op_sel_hi:[1,0]
    v_pk_mul_f32 v[146:147], v[54:55], v[74:75] op_sel:[1,1] op_sel_hi:[1,0]
    v_pk_mul_f32 v[148:149], v[58:59], v[76:77] op_sel:[1,1] op_sel_hi:[1,0]
    v_pk_mul_f32 v[150:151], v[62:63], v[78:79] op_sel:[1,1] op_sel_hi:[1,0]
    v_pk_fma_f32 v[136:137], v[34:35], v[64:65], v[136:137] op_sel_hi:[0,1,1] neg_lo:[0,0,1]
    v_pk_fma_f32 v[138:139], v[38:39], v[66:67], v[138:139] op_sel_hi:[0,1,1] neg_lo:[0,0,1]
    v_pk_fma_f32 v[140:141], v[42:43], v[68:69], v[140:141] op_sel_hi:[0,1,1] neg_lo:[0,0,1]
    v_pk_fma_f32 v[142:143], v[46:47], v[70:71], v[142:143] op_sel_hi:[0,1,1] neg_lo:[0,0,1]
    v_pk_fma_f32 v[144:145], v[50:51], v[72:73], v[144:145] op_sel_hi:[0,1,1] neg_lo:[0,0,1]
    v_pk_fma_f32 v[146:147], v[54:55], v[74:75], v[146:147] op_sel_hi:[0,1,1] neg_lo:[0,0,1]
    v_pk_fma_f32 v[148:149], v[58:59], v[76:77], v[148:149] op_sel_hi:[0,1,1] neg_lo:[0,0,1]
    v_pk_fma_f32 v[150:151], v[62:63], v[78:79], v[150:151] op_sel_hi:[0,1,1] neg_lo:[0,0,1]
    v_cvt_pk_f16_f32 v128, v136, v137
    v_cvt_pk_f16_f32 v129, v138, v139
    v_cvt_pk_f16_f32 v130, v140, v141
    v_cvt_pk_f16_f32 v131, v142, v143
    v_cvt_pk_f16_f32 v132, v144, v145
    v_cvt_pk_f16_f32 v133, v146, v147
    v_cvt_pk_f16_f32 v134, v148, v149
    v_cvt_pk_f16_f32 v135, v150, v151
    v_mfma_f32_16x16x32_f16 v[160:163], v[128:131], v[112:115], 0
    s_nop 0
    v_mfma_f32_16x16x32_f16 v[160:163], v[132:135], v[116:119], v[160:163]
    global_load_dwordx4 v[198:201], v4, s[26:27] offset:0
    global_load_dwordx4 v[202:205], v4, s[26:27] offset:1024
    v_pk_mul_f32 v[80:81], v[64:65], v[64:65] op_sel:[1,1] op_sel_hi:[0,1]
    v_pk_mul_f32 v[82:83], v[66:67], v[66:67] op_sel:[1,1] op_sel_hi:[0,1]
    v_pk_mul_f32 v[84:85], v[68:69], v[68:69] op_sel:[1,1] op_sel_hi:[0,1]
    v_pk_mul_f32 v[86:87], v[70:71], v[70:71] op_sel:[1,1] op_sel_hi:[0,1]
    v_pk_mul_f32 v[88:89], v[72:73], v[72:73] op_sel:[1,1] op_sel_hi:[0,1]
    v_pk_mul_f32 v[90:91], v[74:75], v[74:75] op_sel:[1,1] op_sel_hi:[0,1]
    v_pk_mul_f32 v[92:93], v[76:77], v[76:77] op_sel:[1,1] op_sel_hi:[0,1]
    v_pk_mul_f32 v[94:95], v[78:79], v[78:79] op_sel:[1,1] op_sel_hi:[0,1]
    v_pk_fma_f32 v[64:65], v[64:65], v[64:65], v[80:81] op_sel_hi:[0,1,1] neg_lo:[0,0,1]
    v_pk_fma_f32 v[66:67], v[66:67], v[66:67], v[82:83] op_sel_hi:[0,1,1] neg_lo:[0,0,1]
    v_pk_fma_f32 v[68:69], v[68:69], v[68:69], v[84:85] op_sel_hi:[0,1,1] neg_lo:[0,0,1]
    v_pk_fma_f32 v[70:71], v[70:71], v[70:71], v[86:87] op_sel_hi:[0,1,1] neg_lo:[0,0,1]
    v_pk_fma_f32 v[72:73], v[72:73], v[72:73], v[88:89] op_sel_hi:[0,1,1] neg_lo:[0,0,1]
    v_pk_fma_f32 v[74:75], v[74:75], v[74:75], v[90:91] op_sel_hi:[0,1,1] neg_lo:[0,0,1]
    v_pk_fma_f32 v[76:77], v[76:77], v[76:77], v[92:93] op_sel_hi:[0,1,1] neg_lo:[0,0,1]
    v_pk_fma_f32 v[78:79], v[78:79], v[78:79], v[94:95] op_sel_hi:[0,1,1] neg_lo:[0,0,1]
    v_pk_mul_f32 v[136:137], v[34:35], v[64:65] op_sel:[1,1] op_sel_hi:[1,0]
    v_pk_mul_f32 v[138:139], v[38:39], v[66:67] op_sel:[1,1] op_sel_hi:[1,0]
    v_pk_mul_f32 v[140:141], v[42:43], v[68:69] op_sel:[1,1] op_sel_hi:[1,0]
    v_pk_mul_f32 v[142:143], v[46:47], v[70:71] op_sel:[1,1] op_sel_hi:[1,0]
    v_pk_mul_f32 v[144:145], v[50:51], v[72:73] op_sel:[1,1] op_sel_hi:[1,0]
    v_pk_mul_f32 v[146:147], v[54:55], v[74:75] op_sel:[1,1] op_sel_hi:[1,0]
    v_pk_mul_f32 v[148:149], v[58:59], v[76:77] op_sel:[1,1] op_sel_hi:[1,0]
    v_pk_mul_f32 v[150:151], v[62:63], v[78:79] op_sel:[1,1] op_sel_hi:[1,0]
    v_pk_fma_f32 v[136:137], v[34:35], v[64:65], v[136:137] op_sel_hi:[0,1,1] neg_lo:[0,0,1]
    v_pk_fma_f32 v[138:139], v[38:39], v[66:67], v[138:139] op_sel_hi:[0,1,1] neg_lo:[0,0,1]
    v_pk_fma_f32 v[140:141], v[42:43], v[68:69], v[140:141] op_sel_hi:[0,1,1] neg_lo:[0,0,1]
    v_pk_fma_f32 v[142:143], v[46:47], v[70:71], v[142:143] op_sel_hi:[0,1,1] neg_lo:[0,0,1]
    v_pk_fma_f32 v[144:145], v[50:51], v[72:73], v[144:145] op_sel_hi:[0,1,1] neg_lo:[0,0,1]
    v_pk_fma_f32 v[146:147], v[54:55], v[74:75], v[146:147] op_sel_hi:[0,1,1] neg_lo:[0,0,1]
    v_pk_fma_f32 v[148:149], v[58:59], v[76:77], v[148:149] op_sel_hi:[0,1,1] neg_lo:[0,0,1]
    v_pk_fma_f32 v[150:151], v[62:63], v[78:79], v[150:151] op_sel_hi:[0,1,1] neg_lo:[0,0,1]
    v_cvt_pk_f16_f32 v128, v136, v137
    v_cvt_pk_f16_f32 v129, v138, v139
    v_cvt_pk_f16_f32 v130, v140, v141
    v_cvt_pk_f16_f32 v131, v142, v143
    v_cvt_pk_f16_f32 v132, v144, v145
    v_cvt_pk_f16_f32 v133, v146, v147
    v_cvt_pk_f16_f32 v134, v148, v149
    v_cvt_pk_f16_f32 v135, v150, v151
    v_mfma_f32_16x16x32_f16 v[164:167], v[128:131], v[120:123], 0
    s_nop 0
    v_mfma_f32_16x16x32_f16 v[164:167], v[132:135], v[124:127], v[164:167]
    global_load_dwordx4 v[206:209], v4, s[26:27] offset:2048
    global_load_dwordx4 v[220:223], v4, s[26:27] offset:3072
    v_cvt_pk_f16_f32 v96, v64, -v65
    v_cvt_pk_f16_f32 v97, v66, -v67
    v_cvt_pk_f16_f32 v98, v68, -v69
    v_cvt_pk_f16_f32 v99, v70, -v71
    v_cvt_pk_f16_f32 v100, v72, -v73
    v_cvt_pk_f16_f32 v101, v74, -v75
    v_cvt_pk_f16_f32 v102, v76, -v77
    v_cvt_pk_f16_f32 v103, v78, -v79
    v_mfma_f32_16x16x32_f16 v[168:171], v[128:131], v[96:99], 0
    s_nop 0
    v_mfma_f32_16x16x32_f16 v[168:171], v[132:135], v[100:103], v[168:171]
    s_waitcnt lgkmcnt(0)
    v_pk_mul_f32 v[152:153], v[152:153], v[172:173] op_sel_hi:[1,0]
    v_pk_mul_f32 v[154:155], v[154:155], v[172:173] op_sel_hi:[1,0]
    v_pk_mul_f32 v[156:157], v[156:157], v[172:173] op_sel_hi:[1,0]
    v_pk_mul_f32 v[158:159], v[158:159], v[172:173] op_sel_hi:[1,0]
    v_pk_mul_f32 v[160:161], v[160:161], v[172:173] op_sel_hi:[1,0]
    v_pk_mul_f32 v[162:163], v[162:163], v[172:173] op_sel_hi:[1,0]
    v_pk_mul_f32 v[164:165], v[164:165], v[172:173] op_sel_hi:[1,0]
    v_pk_mul_f32 v[166:167], v[166:167], v[172:173] op_sel_hi:[1,0]
    ds_write_b32 v175, v152 offset:11264
    ds_write_b32 v175, v153 offset:11536
    ds_write_b32 v175, v154 offset:11808
    ds_write_b32 v175, v155 offset:12080
    v_mul_f32 v168, v168, v172
    s_mov_b32 exec_lo, 0
    ds_write_b32 v175, v156 offset:13440
    ds_write_b32 v175, v157 offset:13712
    ds_write_b32 v175, v158 offset:13984
    ds_write_b32 v175, v159 offset:14256
    ds_write_b32 v175, v160 offset:15616
    ds_write_b32 v175, v161 offset:15888
    ds_write_b32 v175, v162 offset:16160
    ds_write_b32 v175, v163 offset:16432
    ds_write_b32 v175, v164 offset:17792
    ds_write_b32 v175, v165 offset:18064
    ds_write_b32 v175, v166 offset:18336
    ds_write_b32 v175, v167 offset:18608
    s_mov_b32 exec_hi, 0x100
    ds_write_b32 v175, v168 offset:19840
    s_mov_b64 exec, -1
    v_lshlrev_b32 v180, 6, v1
    buffer_load_dwordx4 v[228:231], v180, s[16:19], 0 offen offset:0 sc1
    buffer_load_dwordx4 v[232:235], v180, s[16:19], 0 offen offset:16 sc1
    buffer_load_dwordx4 v[236:239], v180, s[16:19], 0 offen offset:32 sc1
    buffer_load_dwordx4 v[240:243], v180, s[16:19], 0 offen offset:48 sc1
    v_and_b32 v181, 31, v0
    s_lshl_b32 s28, s3, 9
    s_add_u32 s28, s28, 0
    v_lshl_add_u32 v181, v181, 4, s28
    buffer_load_dwordx4 v[212:215], v181, s[92:95], 0 offen sc1
    s_cmp_eq_u32 s63, 0
    s_cbranch_scc1 mk_lno18
    s_waitcnt vmcnt(19)
    ds_write_b128 v250, a[16:19] offset:51360
    ds_write_b128 v251, a[20:23] offset:52384
    ds_write_b128 v250, a[24:27] offset:53408
    ds_write_b128 v251, a[28:31] offset:54432
    ds_write_b128 v250, a[0:3] offset:0
    ds_write_b128 v251, a[4:7] offset:1024
    ds_write_b128 v250, a[8:11] offset:2048
    ds_write_b128 v251, a[12:15] offset:3072
mk_lno18:
    ds_read_b128 v[32:35], v174 offset:4224
    ds_read_b128 v[36:39], v174 offset:4240
    ds_read_b128 v[40:43], v174 offset:4256
    ds_read_b128 v[44:47], v174 offset:4272
    ds_read_b128 v[48:51], v174 offset:4288
    ds_read_b128 v[52:55], v174 offset:4304
    ds_read_b128 v[56:59], v174 offset:4320
    ds_read_b128 v[60:63], v174 offset:4336
    ds_read_b32 v172, v5 offset:4736
    s_waitcnt lgkmcnt(8)
    v_pk_mul_f32 v[80:81], v[32:33], v[172:173] op_sel:[0,1] op_sel_hi:[1,1]
    v_fract_f32 v81, v81
    s_waitcnt lgkmcnt(7)
    v_pk_mul_f32 v[82:83], v[36:37], v[172:173] op_sel:[0,1] op_sel_hi:[1,1]
    v_fract_f32 v83, v83
    s_waitcnt lgkmcnt(6)
    v_pk_mul_f32 v[84:85], v[40:41], v[172:173] op_sel:[0,1] op_sel_hi:[1,1]
    v_fract_f32 v85, v85
    s_waitcnt lgkmcnt(5)
    v_pk_mul_f32 v[86:87], v[44:45], v[172:173] op_sel:[0,1] op_sel_hi:[1,1]
    v_fract_f32 v87, v87
    s_waitcnt lgkmcnt(4)
    v_pk_mul_f32 v[88:89], v[48:49], v[172:173] op_sel:[0,1] op_sel_hi:[1,1]
    v_fract_f32 v89, v89
    s_waitcnt lgkmcnt(3)
    v_pk_mul_f32 v[90:91], v[52:53], v[172:173] op_sel:[0,1] op_sel_hi:[1,1]
    v_fract_f32 v91, v91
    s_waitcnt lgkmcnt(2)
    v_pk_mul_f32 v[92:93], v[56:57], v[172:173] op_sel:[0,1] op_sel_hi:[1,1]
    v_fract_f32 v93, v93
    s_waitcnt lgkmcnt(1)
    v_pk_mul_f32 v[94:95], v[60:61], v[172:173] op_sel:[0,1] op_sel_hi:[1,1]
    v_fract_f32 v95, v95
    v_exp_f32 v80, v80
    v_cos_f32 v64, v81
    v_sin_f32 v65, v81
    v_exp_f32 v82, v82
    v_cos_f32 v66, v83
    v_sin_f32 v67, v83
    v_exp_f32 v84, v84
    v_cos_f32 v68, v85
    v_sin_f32 v69, v85
    v_exp_f32 v86, v86
    v_cos_f32 v70, v87
    v_sin_f32 v71, v87
    v_exp_f32 v88, v88
    v_cos_f32 v72, v89
    v_sin_f32 v73, v89
    v_exp_f32 v90, v90
    v_cos_f32 v74, v91
    v_sin_f32 v75, v91
    v_exp_f32 v92, v92
    v_cos_f32 v76, v93
    v_sin_f32 v77, v93
    v_exp_f32 v94, v94
    v_cos_f32 v78, v95
    v_sin_f32 v79, v95
    v_pk_mul_f32 v[64:65], v[64:65], v[80:81] op_sel_hi:[1,0]
    v_pk_mul_f32 v[66:67], v[66:67], v[82:83] op_sel_hi:[1,0]
    v_pk_mul_f32 v[68:69], v[68:69], v[84:85] op_sel_hi:[1,0]
    v_pk_mul_f32 v[70:71], v[70:71], v[86:87] op_sel_hi:[1,0]
    v_pk_mul_f32 v[72:73], v[72:73], v[88:89] op_sel_hi:[1,0]
    v_pk_mul_f32 v[74:75], v[74:75], v[90:91] op_sel_hi:[1,0]
    v_pk_mul_f32 v[76:77], v[76:77], v[92:93] op_sel_hi:[1,0]
    v_pk_mul_f32 v[78:79], v[78:79], v[94:95] op_sel_hi:[1,0]
    s_cmp_eq_u32 s63, 0
    s_cbranch_scc1 mk_lno19
    ds_read_b64_tr_b16 a[16:17], v252 offset:51360
    ds_read_b64_tr_b16 a[18:19], v252 offset:51872
    ds_read_b64_tr_b16 a[20:21], v253 offset:51360
    ds_read_b64_tr_b16 a[22:23], v253 offset:51872
    ds_read_b64_tr_b16 a[24:25], v254 offset:51360
    ds_read_b64_tr_b16 a[26:27], v254 offset:51872
    ds_read_b64_tr_b16 a[28:29], v255 offset:51360
    ds_read_b64_tr_b16 a[30:31], v255 offset:51872
    ds_read_b64_tr_b16 a[0:1], v252 offset:0
    ds_read_b64_tr_b16 a[2:3], v252 offset:512
    ds_read_b64_tr_b16 a[4:5], v253 offset:0
    ds_read_b64_tr_b16 a[6:7], v253 offset:512
    ds_read_b64_tr_b16 a[8:9], v254 offset:0
    ds_read_b64_tr_b16 a[10:11], v254 offset:512
    ds_read_b64_tr_b16 a[12:13], v255 offset:0
    ds_read_b64_tr_b16 a[14:15], v255 offset:512
mk_lno19:
    v_cvt_pk_f16_f32 v96, v64, -v65
    v_cvt_pk_f16_f32 v97, v66, -v67
    v_cvt_pk_f16_f32 v98, v68, -v69
    v_cvt_pk_f16_f32 v99, v70, -v71
    v_cvt_pk_f16_f32 v100, v72, -v73
    v_cvt_pk_f16_f32 v101, v74, -v75
    v_cvt_pk_f16_f32 v102, v76, -v77
    v_cvt_pk_f16_f32 v103, v78, -v79
    v_pk_mul_f32 v[80:81], v[64:65], v[64:65] op_sel:[1,1] op_sel_hi:[0,1]
    v_pk_mul_f32 v[82:83], v[66:67], v[66:67] op_sel:[1,1] op_sel_hi:[0,1]
    v_pk_mul_f32 v[84:85], v[68:69], v[68:69] op_sel:[1,1] op_sel_hi:[0,1]
    v_pk_mul_f32 v[86:87], v[70:71], v[70:71] op_sel:[1,1] op_sel_hi:[0,1]
    v_pk_mul_f32 v[88:89], v[72:73], v[72:73] op_sel:[1,1] op_sel_hi:[0,1]
    v_pk_mul_f32 v[90:91], v[74:75], v[74:75] op_sel:[1,1] op_sel_hi:[0,1]
    v_pk_mul_f32 v[92:93], v[76:77], v[76:77] op_sel:[1,1] op_sel_hi:[0,1]
    v_pk_mul_f32 v[94:95], v[78:79], v[78:79] op_sel:[1,1] op_sel_hi:[0,1]
    v_pk_fma_f32 v[64:65], v[64:65], v[64:65], v[80:81] op_sel_hi:[0,1,1] neg_lo:[0,0,1]
    v_pk_fma_f32 v[66:67], v[66:67], v[66:67], v[82:83] op_sel_hi:[0,1,1] neg_lo:[0,0,1]
    v_pk_fma_f32 v[68:69], v[68:69], v[68:69], v[84:85] op_sel_hi:[0,1,1] neg_lo:[0,0,1]
    v_pk_fma_f32 v[70:71], v[70:71], v[70:71], v[86:87] op_sel_hi:[0,1,1] neg_lo:[0,0,1]
    v_pk_fma_f32 v[72:73], v[72:73], v[72:73], v[88:89] op_sel_hi:[0,1,1] neg_lo:[0,0,1]
    v_pk_fma_f32 v[74:75], v[74:75], v[74:75], v[90:91] op_sel_hi:[0,1,1] neg_lo:[0,0,1]
    v_pk_fma_f32 v[76:77], v[76:77], v[76:77], v[92:93] op_sel_hi:[0,1,1] neg_lo:[0,0,1]
    v_pk_fma_f32 v[78:79], v[78:79], v[78:79], v[94:95] op_sel_hi:[0,1,1] neg_lo:[0,0,1]
    v_cvt_pk_f16_f32 v104, v64, -v65
    v_cvt_pk_f16_f32 v105, v66, -v67
    v_cvt_pk_f16_f32 v106, v68, -v69
    v_cvt_pk_f16_f32 v107, v70, -v71
    v_cvt_pk_f16_f32 v108, v72, -v73
    v_cvt_pk_f16_f32 v109, v74, -v75
    v_cvt_pk_f16_f32 v110, v76, -v77
    v_cvt_pk_f16_f32 v111, v78, -v79
    v_pk_mul_f32 v[80:81], v[64:65], v[64:65] op_sel:[1,1] op_sel_hi:[0,1]
    v_pk_mul_f32 v[82:83], v[66:67], v[66:67] op_sel:[1,1] op_sel_hi:[0,1]
    v_pk_mul_f32 v[84:85], v[68:69], v[68:69] op_sel:[1,1] op_sel_hi:[0,1]
    v_pk_mul_f32 v[86:87], v[70:71], v[70:71] op_sel:[1,1] op_sel_hi:[0,1]
    v_pk_mul_f32 v[88:89], v[72:73], v[72:73] op_sel:[1,1] op_sel_hi:[0,1]
    v_pk_mul_f32 v[90:91], v[74:75], v[74:75] op_sel:[1,1] op_sel_hi:[0,1]
    v_pk_mul_f32 v[92:93], v[76:77], v[76:77] op_sel:[1,1] op_sel_hi:[0,1]
    v_pk_mul_f32 v[94:95], v[78:79], v[78:79] op_sel:[1,1] op_sel_hi:[0,1]
    v_pk_fma_f32 v[64:65], v[64:65], v[64:65], v[80:81] op_sel_hi:[0,1,1] neg_lo:[0,0,1]
    v_pk_fma_f32 v[66:67], v[66:67], v[66:67], v[82:83] op_sel_hi:[0,1,1] neg_lo:[0,0,1]
    v_pk_fma_f32 v[68:69], v[68:69], v[68:69], v[84:85] op_sel_hi:[0,1,1] neg_lo:[0,0,1]
    v_pk_fma_f32 v[70:71], v[70:71], v[70:71], v[86:87] op_sel_hi:[0,1,1] neg_lo:[0,0,1]
    v_pk_fma_f32 v[72:73], v[72:73], v[72:73], v[88:89] op_sel_hi:[0,1,1] neg_lo:[0,0,1]
    v_pk_fma_f32 v[74:75], v[74:75], v[74:75], v[90:91] op_sel_hi:[0,1,1] neg_lo:[0,0,1]
    v_pk_fma_f32 v[76:77], v[76:77], v[76:77], v[92:93] op_sel_hi:[0,1,1] neg_lo:[0,0,1]
    v_pk_fma_f32 v[78:79], v[78:79], v[78:79], v[94:95] op_sel_hi:[0,1,1] neg_lo:[0,0,1]
    v_cvt_pk_f16_f32 v112, v64, -v65
    v_cvt_pk_f16_f32 v113, v66, -v67
    v_cvt_pk_f16_f32 v114, v68, -v69
    v_cvt_pk_f16_f32 v115, v70, -v71
    v_cvt_pk_f16_f32 v116, v72, -v73
    v_cvt_pk_f16_f32 v117, v74, -v75
    v_cvt_pk_f16_f32 v118, v76, -v77
    v_cvt_pk_f16_f32 v119, v78, -v79
    v_pk_mul_f32 v[80:81], v[64:65], v[64:65] op_sel:[1,1] op_sel_hi:[0,1]
    v_pk_mul_f32 v[82:83], v[66:67], v[66:67] op_sel:[1,1] op_sel_hi:[0,1]
    v_pk_mul_f32 v[84:85], v[68:69], v[68:69] op_sel:[1,1] op_sel_hi:[0,1]
    v_pk_mul_f32 v[86:87], v[70:71], v[70:71] op_sel:[1,1] op_sel_hi:[0,1]
    v_pk_mul_f32 v[88:89], v[72:73], v[72:73] op_sel:[1,1] op_sel_hi:[0,1]
    v_pk_mul_f32 v[90:91], v[74:75], v[74:75] op_sel:[1,1] op_sel_hi:[0,1]
    v_pk_mul_f32 v[92:93], v[76:77], v[76:77] op_sel:[1,1] op_sel_hi:[0,1]
    v_pk_mul_f32 v[94:95], v[78:79], v[78:79] op_sel:[1,1] op_sel_hi:[0,1]
    v_pk_fma_f32 v[64:65], v[64:65], v[64:65], v[80:81] op_sel_hi:[0,1,1] neg_lo:[0,0,1]
    v_pk_fma_f32 v[66:67], v[66:67], v[66:67], v[82:83] op_sel_hi:[0,1,1] neg_lo:[0,0,1]
    v_pk_fma_f32 v[68:69], v[68:69], v[68:69], v[84:85] op_sel_hi:[0,1,1] neg_lo:[0,0,1]
    v_pk_fma_f32 v[70:71], v[70:71], v[70:71], v[86:87] op_sel_hi:[0,1,1] neg_lo:[0,0,1]
    v_pk_fma_f32 v[72:73], v[72:73], v[72:73], v[88:89] op_sel_hi:[0,1,1] neg_lo:[0,0,1]
    v_pk_fma_f32 v[74:75], v[74:75], v[74:75], v[90:91] op_sel_hi:[0,1,1] neg_lo:[0,0,1]
    v_pk_fma_f32 v[76:77], v[76:77], v[76:77], v[92:93] op_sel_hi:[0,1,1] neg_lo:[0,0,1]
    v_pk_fma_f32 v[78:79], v[78:79], v[78:79], v[94:95] op_sel_hi:[0,1,1] neg_lo:[0,0,1]
    buffer_load_dwordx4 v[216:219], v210, s[92:95], 0 offen sc1
    v_cvt_pk_f16_f32 v120, v64, -v65
    v_cvt_pk_f16_f32 v121, v66, -v67
    v_cvt_pk_f16_f32 v122, v68, -v69
    v_cvt_pk_f16_f32 v123, v70, -v71
    v_cvt_pk_f16_f32 v124, v72, -v73
    v_cvt_pk_f16_f32 v125, v74, -v75
    v_cvt_pk_f16_f32 v126, v76, -v77
    v_cvt_pk_f16_f32 v127, v78, -v79
    v_pk_mul_f32 v[80:81], v[64:65], v[64:65] op_sel:[1,1] op_sel_hi:[0,1]
    v_pk_mul_f32 v[82:83], v[66:67], v[66:67] op_sel:[1,1] op_sel_hi:[0,1]
    v_pk_mul_f32 v[84:85], v[68:69], v[68:69] op_sel:[1,1] op_sel_hi:[0,1]
    v_pk_mul_f32 v[86:87], v[70:71], v[70:71] op_sel:[1,1] op_sel_hi:[0,1]
    v_pk_mul_f32 v[88:89], v[72:73], v[72:73] op_sel:[1,1] op_sel_hi:[0,1]
    v_pk_mul_f32 v[90:91], v[74:75], v[74:75] op_sel:[1,1] op_sel_hi:[0,1]
    v_pk_mul_f32 v[92:93], v[76:77], v[76:77] op_sel:[1,1] op_sel_hi:[0,1]
    v_pk_mul_f32 v[94:95], v[78:79], v[78:79] op_sel:[1,1] op_sel_hi:[0,1]
    v_pk_fma_f32 v[64:65], v[64:65], v[64:65], v[80:81] op_sel_hi:[0,1,1] neg_lo:[0,0,1]
    v_pk_fma_f32 v[66:67], v[66:67], v[66:67], v[82:83] op_sel_hi:[0,1,1] neg_lo:[0,0,1]
    v_pk_fma_f32 v[68:69], v[68:69], v[68:69], v[84:85] op_sel_hi:[0,1,1] neg_lo:[0,0,1]
    v_pk_fma_f32 v[70:71], v[70:71], v[70:71], v[86:87] op_sel_hi:[0,1,1] neg_lo:[0,0,1]
    v_pk_fma_f32 v[72:73], v[72:73], v[72:73], v[88:89] op_sel_hi:[0,1,1] neg_lo:[0,0,1]
    v_pk_fma_f32 v[74:75], v[74:75], v[74:75], v[90:91] op_sel_hi:[0,1,1] neg_lo:[0,0,1]
    v_pk_fma_f32 v[76:77], v[76:77], v[76:77], v[92:93] op_sel_hi:[0,1,1] neg_lo:[0,0,1]
    v_pk_fma_f32 v[78:79], v[78:79], v[78:79], v[94:95] op_sel_hi:[0,1,1] neg_lo:[0,0,1]
    s_waitcnt vmcnt(1)
    s_mov_b32 s89, 0x40000
mk_fp20:
    v_xor_b32 v212, s88, v212
    v_xor_b32 v213, s88, v213
    v_xor_b32 v214, s88, v214
    v_xor_b32 v215, s88, v215
    v_or3_b32 v212, v212, v213, v214
    v_or_b32 v212, v212, v215
    v_cmp_ne_u32 vcc, 0, v212
    s_cbranch_vccz mk_fpd21
    buffer_load_dwordx4 v[212:215], v181, s[92:95], 0 offen sc1
    s_sub_u32 s89, s89, 1
    s_cmp_lg_u32 s89, 0
    s_waitcnt vmcnt(0)
    s_cbranch_scc1 mk_fp20
mk_fpd21:
    buffer_load_dwordx4 v[28:31], v249, s[16:19], s34 offen offset:64 sc1
    buffer_load_dwordx4 v[20:23], v249, s[16:19], s34 offen offset:32 sc1
    buffer_load_dwordx4 v[12:15], v249, s[16:19], s34 offen offset:0 sc1
    s_cmp_eq_u32 s63, 0
    s_cbranch_scc1 mk_lno22
    s_waitcnt lgkmcnt(0)
    buffer_store_dwordx4 a[16:19], v3, s[84:87], s37 offen sc1
    s_add_u32 s37, s37, s38
    buffer_store_dwordx4 a[20:23], v3, s[84:87], s37 offen sc1
    s_add_u32 s37, s37, s38
mk_lno22:
    v_pk_mul_f32 v[136:137], v[34:35], v[64:65] op_sel:[1,1] op_sel_hi:[1,0]
    v_pk_mul_f32 v[138:139], v[38:39], v[66:67] op_sel:[1,1] op_sel_hi:[1,0]
    v_pk_mul_f32 v[140:141], v[42:43], v[68:69] op_sel:[1,1] op_sel_hi:[1,0]
    v_pk_mul_f32 v[142:143], v[46:47], v[70:71] op_sel:[1,1] op_sel_hi:[1,0]
    v_pk_mul_f32 v[144:145], v[50:51], v[72:73] op_sel:[1,1] op_sel_hi:[1,0]
    v_pk_mul_f32 v[146:147], v[54:55], v[74:75] op_sel:[1,1] op_sel_hi:[1,0]
    v_pk_mul_f32 v[148:149], v[58:59], v[76:77] op_sel:[1,1] op_sel_hi:[1,0]
    v_pk_mul_f32 v[150:151], v[62:63], v[78:79] op_sel:[1,1] op_sel_hi:[1,0]
    v_pk_fma_f32 v[136:137], v[34:35], v[64:65], v[136:137] op_sel_hi:[0,1,1] neg_lo:[0,0,1]
    v_pk_fma_f32 v[138:139], v[38:39], v[66:67], v[138:139] op_sel_hi:[0,1,1] neg_lo:[0,0,1]
    v_pk_fma_f32 v[140:141], v[42:43], v[68:69], v[140:141] op_sel_hi:[0,1,1] neg_lo:[0,0,1]
    v_pk_fma_f32 v[142:143], v[46:47], v[70:71], v[142:143] op_sel_hi:[0,1,1] neg_lo:[0,0,1]
    v_pk_fma_f32 v[144:145], v[50:51], v[72:73], v[144:145] op_sel_hi:[0,1,1] neg_lo:[0,0,1]
    v_pk_fma_f32 v[146:147], v[54:55], v[74:75], v[146:147] op_sel_hi:[0,1,1] neg_lo:[0,0,1]
    v_pk_fma_f32 v[148:149], v[58:59], v[76:77], v[148:149] op_sel_hi:[0,1,1] neg_lo:[0,0,1]
    v_pk_fma_f32 v[150:151], v[62:63], v[78:79], v[150:151] op_sel_hi:[0,1,1] neg_lo:[0,0,1]
    v_cvt_pk_f16_f32 v128, v136, v137
    v_cvt_pk_f16_f32 v129, v138, v139
    v_cvt_pk_f16_f32 v130, v140, v141
    v_cvt_pk_f16_f32 v131, v142, v143
    v_cvt_pk_f16_f32 v132, v144, v145
    v_cvt_pk_f16_f32 v133, v146, v147
    v_cvt_pk_f16_f32 v134, v148, v149
    v_cvt_pk_f16_f32 v135, v150, v151
    v_mfma_f32_16x16x32_f16 v[152:155], v[128:131], v[96:99], 0
    s_nop 0
    v_mfma_f32_16x16x32_f16 v[152:155], v[132:135], v[100:103], v[152:155]
    v_pk_mul_f32 v[80:81], v[64:65], v[64:65] op_sel:[1,1] op_sel_hi:[0,1]
    v_pk_mul_f32 v[82:83], v[66:67], v[66:67] op_sel:[1,1] op_sel_hi:[0,1]
    v_pk_mul_f32 v[84:85], v[68:69], v[68:69] op_sel:[1,1] op_sel_hi:[0,1]
    v_pk_mul_f32 v[86:87], v[70:71], v[70:71] op_sel:[1,1] op_sel_hi:[0,1]
    v_pk_mul_f32 v[88:89], v[72:73], v[72:73] op_sel:[1,1] op_sel_hi:[0,1]
    v_pk_mul_f32 v[90:91], v[74:75], v[74:75] op_sel:[1,1] op_sel_hi:[0,1]
    v_pk_mul_f32 v[92:93], v[76:77], v[76:77] op_sel:[1,1] op_sel_hi:[0,1]
    v_pk_mul_f32 v[94:95], v[78:79], v[78:79] op_sel:[1,1] op_sel_hi:[0,1]
    v_pk_fma_f32 v[64:65], v[64:65], v[64:65], v[80:81] op_sel_hi:[0,1,1] neg_lo:[0,0,1]
    v_pk_fma_f32 v[66:67], v[66:67], v[66:67], v[82:83] op_sel_hi:[0,1,1] neg_lo:[0,0,1]
    v_pk_fma_f32 v[68:69], v[68:69], v[68:69], v[84:85] op_sel_hi:[0,1,1] neg_lo:[0,0,1]
    v_pk_fma_f32 v[70:71], v[70:71], v[70:71], v[86:87] op_sel_hi:[0,1,1] neg_lo:[0,0,1]
    v_pk_fma_f32 v[72:73], v[72:73], v[72:73], v[88:89] op_sel_hi:[0,1,1] neg_lo:[0,0,1]
    v_pk_fma_f32 v[74:75], v[74:75], v[74:75], v[90:91] op_sel_hi:[0,1,1] neg_lo:[0,0,1]
    v_pk_fma_f32 v[76:77], v[76:77], v[76:77], v[92:93] op_sel_hi:[0,1,1] neg_lo:[0,0,1]
    v_pk_fma_f32 v[78:79], v[78:79], v[78:79], v[94:95] op_sel_hi:[0,1,1] neg_lo:[0,0,1]
    s_cmp_eq_u32 s63, 0
    s_cbranch_scc1 mk_lno23
    buffer_store_dwordx4 a[24:27], v3, s[84:87], s37 offen sc1
    s_add_u32 s37, s37, s38
mk_lno23:
    v_pk_mul_f32 v[136:137], v[34:35], v[64:65] op_sel:[1,1] op_sel_hi:[1,0]
    v_pk_mul_f32 v[138:139], v[38:39], v[66:67] op_sel:[1,1] op_sel_hi:[1,0]
    v_pk_mul_f32 v[140:141], v[42:43], v[68:69] op_sel:[1,1] op_sel_hi:[1,0]
    v_pk_mul_f32 v[142:143], v[46:47], v[70:71] op_sel:[1,1] op_sel_hi:[1,0]
    v_pk_mul_f32 v[144:145], v[50:51], v[72:73] op_sel:[1,1] op_sel_hi:[1,0]
    v_pk_mul_f32 v[146:147], v[54:55], v[74:75] op_sel:[1,1] op_sel_hi:[1,0]
    v_pk_mul_f32 v[148:149], v[58:59], v[76:77] op_sel:[1,1] op_sel_hi:[1,0]
    v_pk_mul_f32 v[150:151], v[62:63], v[78:79] op_sel:[1,1] op_sel_hi:[1,0]
    v_pk_fma_f32 v[136:137], v[34:35], v[64:65], v[136:137] op_sel_hi:[0,1,1] neg_lo:[0,0,1]
    v_pk_fma_f32 v[138:139], v[38:39], v[66:67], v[138:139] op_sel_hi:[0,1,1] neg_lo:[0,0,1]
    v_pk_fma_f32 v[140:141], v[42:43], v[68:69], v[140:141] op_sel_hi:[0,1,1] neg_lo:[0,0,1]
    v_pk_fma_f32 v[142:143], v[46:47], v[70:71], v[142:143] op_sel_hi:[0,1,1] neg_lo:[0,0,1]
    v_pk_fma_f32 v[144:145], v[50:51], v[72:73], v[144:145] op_sel_hi:[0,1,1] neg_lo:[0,0,1]
    v_pk_fma_f32 v[146:147], v[54:55], v[74:75], v[146:147] op_sel_hi:[0,1,1] neg_lo:[0,0,1]
    v_pk_fma_f32 v[148:149], v[58:59], v[76:77], v[148:149] op_sel_hi:[0,1,1] neg_lo:[0,0,1]
    v_pk_fma_f32 v[150:151], v[62:63], v[78:79], v[150:151] op_sel_hi:[0,1,1] neg_lo:[0,0,1]
    v_cvt_pk_f16_f32 v128, v136, v137
    v_cvt_pk_f16_f32 v129, v138, v139
    v_cvt_pk_f16_f32 v130, v140, v141
    v_cvt_pk_f16_f32 v131, v142, v143
    v_cvt_pk_f16_f32 v132, v144, v145
    v_cvt_pk_f16_f32 v133, v146, v147
    v_cvt_pk_f16_f32 v134, v148, v149
    v_cvt_pk_f16_f32 v135, v150, v151
    v_mfma_f32_16x16x32_f16 v[156:159], v[128:131], v[104:107], 0
    s_nop 0
    v_mfma_f32_16x16x32_f16 v[156:159], v[132:135], v[108:111], v[156:159]
    v_pk_mul_f32 v[80:81], v[64:65], v[64:65] op_sel:[1,1] op_sel_hi:[0,1]
    v_pk_mul_f32 v[82:83], v[66:67], v[66:67] op_sel:[1,1] op_sel_hi:[0,1]
    v_pk_mul_f32 v[84:85], v[68:69], v[68:69] op_sel:[1,1] op_sel_hi:[0,1]
    v_pk_mul_f32 v[86:87], v[70:71], v[70:71] op_sel:[1,1] op_sel_hi:[0,1]
    v_pk_mul_f32 v[88:89], v[72:73], v[72:73] op_sel:[1,1] op_sel_hi:[0,1]
    v_pk_mul_f32 v[90:91], v[74:75], v[74:75] op_sel:[1,1] op_sel_hi:[0,1]
    v_pk_mul_f32 v[92:93], v[76:77], v[76:77] op_sel:[1,1] op_sel_hi:[0,1]
    v_pk_mul_f32 v[94:95], v[78:79], v[78:79] op_sel:[1,1] op_sel_hi:[0,1]
    v_pk_fma_f32 v[64:65], v[64:65], v[64:65], v[80:81] op_sel_hi:[0,1,1] neg_lo:[0,0,1]
    v_pk_fma_f32 v[66:67], v[66:67], v[66:67], v[82:83] op_sel_hi:[0,1,1] neg_lo:[0,0,1]
    v_pk_fma_f32 v[68:69], v[68:69], v[68:69], v[84:85] op_sel_hi:[0,1,1] neg_lo:[0,0,1]
    v_pk_fma_f32 v[70:71], v[70:71], v[70:71], v[86:87] op_sel_hi:[0,1,1] neg_lo:[0,0,1]
    v_pk_fma_f32 v[72:73], v[72:73], v[72:73], v[88:89] op_sel_hi:[0,1,1] neg_lo:[0,0,1]
    v_pk_fma_f32 v[74:75], v[74:75], v[74:75], v[90:91] op_sel_hi:[0,1,1] neg_lo:[0,0,1]
    v_pk_fma_f32 v[76:77], v[76:77], v[76:77], v[92:93] op_sel_hi:[0,1,1] neg_lo:[0,0,1]
    v_pk_fma_f32 v[78:79], v[78:79], v[78:79], v[94:95] op_sel_hi:[0,1,1] neg_lo:[0,0,1]
    s_cmp_eq_u32 s63, 0
    s_cbranch_scc1 mk_lno24
    buffer_store_dwordx4 a[28:31], v3, s[84:87], s37 offen sc1
mk_lno24:
    s_waitcnt vmcnt(7)
    s_cmp_eq_u32 s63, 0
    s_cbranch_scc0 mk_lno25
    s_waitcnt vmcnt(3)
mk_lno25:
    v_xor_b32 v216, s88, v216
    v_xor_b32 v217, s88, v217
    v_xor_b32 v218, s88, v218
    v_xor_b32 v219, s88, v219
    v_or3_b32 v216, v216, v217, v218
    v_or_b32 v216, v216, v219
    v_cmp_ne_u32 vcc, 0, v216
    s_cmp_eq_u64 vcc, 0
    s_cselect_b32 s26, s80, 1073741824
    v_pk_mul_f32 v[136:137], v[34:35], v[64:65] op_sel:[1,1] op_sel_hi:[1,0]
    s_add_u32 s83, s26, 0
    buffer_load_dwordx4 a[136:139], v3, s[84:87], s83 offen sc1
    v_pk_mul_f32 v[138:139], v[38:39], v[66:67] op_sel:[1,1] op_sel_hi:[1,0]
    v_pk_mul_f32 v[140:141], v[42:43], v[68:69] op_sel:[1,1] op_sel_hi:[1,0]
    v_pk_mul_f32 v[142:143], v[46:47], v[70:71] op_sel:[1,1] op_sel_hi:[1,0]
    v_pk_mul_f32 v[144:145], v[50:51], v[72:73] op_sel:[1,1] op_sel_hi:[1,0]
    v_pk_mul_f32 v[146:147], v[54:55], v[74:75] op_sel:[1,1] op_sel_hi:[1,0]
    v_pk_mul_f32 v[148:149], v[58:59], v[76:77] op_sel:[1,1] op_sel_hi:[1,0]
    v_pk_mul_f32 v[150:151], v[62:63], v[78:79] op_sel:[1,1] op_sel_hi:[1,0]
    v_pk_fma_f32 v[136:137], v[34:35], v[64:65], v[136:137] op_sel_hi:[0,1,1] neg_lo:[0,0,1]
    v_pk_fma_f32 v[138:139], v[38:39], v[66:67], v[138:139] op_sel_hi:[0,1,1] neg_lo:[0,0,1]
    v_pk_fma_f32 v[140:141], v[42:43], v[68:69], v[140:141] op_sel_hi:[0,1,1] neg_lo:[0,0,1]
    v_pk_fma_f32 v[142:143], v[46:47], v[70:71], v[142:143] op_sel_hi:[0,1,1] neg_lo:[0,0,1]
    v_pk_fma_f32 v[144:145], v[50:51], v[72:73], v[144:145] op_sel_hi:[0,1,1] neg_lo:[0,0,1]
    v_pk_fma_f32 v[146:147], v[54:55], v[74:75], v[146:147] op_sel_hi:[0,1,1] neg_lo:[0,0,1]
    v_pk_fma_f32 v[148:149], v[58:59], v[76:77], v[148:149] op_sel_hi:[0,1,1] neg_lo:[0,0,1]
    v_pk_fma_f32 v[150:151], v[62:63], v[78:79], v[150:151] op_sel_hi:[0,1,1] neg_lo:[0,0,1]
    v_cvt_pk_f16_f32 v128, v136, v137
    s_add_u32 s83, s26, 20480
    buffer_load_dwordx4 a[140:143], v3, s[84:87], s83 offen sc1
    v_cvt_pk_f16_f32 v129, v138, v139
    v_cvt_pk_f16_f32 v130, v140, v141
    v_cvt_pk_f16_f32 v131, v142, v143
    v_cvt_pk_f16_f32 v132, v144, v145
    v_cvt_pk_f16_f32 v133, v146, v147
    v_cvt_pk_f16_f32 v134, v148, v149
    v_cvt_pk_f16_f32 v135, v150, v151
    v_mfma_f32_16x16x32_f16 v[160:163], v[128:131], v[112:115], 0
    s_nop 0
    v_mfma_f32_16x16x32_f16 v[160:163], v[132:135], v[116:119], v[160:163]
    v_pk_mul_f32 v[80:81], v[64:65], v[64:65] op_sel:[1,1] op_sel_hi:[0,1]
    s_add_u32 s83, s26, 40960
    buffer_load_dwordx4 a[144:147], v3, s[84:87], s83 offen sc1
    v_pk_mul_f32 v[82:83], v[66:67], v[66:67] op_sel:[1,1] op_sel_hi:[0,1]
    v_pk_mul_f32 v[84:85], v[68:69], v[68:69] op_sel:[1,1] op_sel_hi:[0,1]
    v_pk_mul_f32 v[86:87], v[70:71], v[70:71] op_sel:[1,1] op_sel_hi:[0,1]
    v_pk_mul_f32 v[88:89], v[72:73], v[72:73] op_sel:[1,1] op_sel_hi:[0,1]
    v_pk_mul_f32 v[90:91], v[74:75], v[74:75] op_sel:[1,1] op_sel_hi:[0,1]
    v_pk_mul_f32 v[92:93], v[76:77], v[76:77] op_sel:[1,1] op_sel_hi:[0,1]
    v_pk_mul_f32 v[94:95], v[78:79], v[78:79] op_sel:[1,1] op_sel_hi:[0,1]
    v_pk_fma_f32 v[64:65], v[64:65], v[64:65], v[80:81] op_sel_hi:[0,1,1] neg_lo:[0,0,1]
    v_pk_fma_f32 v[66:67], v[66:67], v[66:67], v[82:83] op_sel_hi:[0,1,1] neg_lo:[0,0,1]
    v_pk_fma_f32 v[68:69], v[68:69], v[68:69], v[84:85] op_sel_hi:[0,1,1] neg_lo:[0,0,1]
    v_pk_fma_f32 v[70:71], v[70:71], v[70:71], v[86:87] op_sel_hi:[0,1,1] neg_lo:[0,0,1]
    v_pk_fma_f32 v[72:73], v[72:73], v[72:73], v[88:89] op_sel_hi:[0,1,1] neg_lo:[0,0,1]
    v_pk_fma_f32 v[74:75], v[74:75], v[74:75], v[90:91] op_sel_hi:[0,1,1] neg_lo:[0,0,1]
    v_pk_fma_f32 v[76:77], v[76:77], v[76:77], v[92:93] op_sel_hi:[0,1,1] neg_lo:[0,0,1]
    v_pk_fma_f32 v[78:79], v[78:79], v[78:79], v[94:95] op_sel_hi:[0,1,1] neg_lo:[0,0,1]
    v_pk_mul_f32 v[136:137], v[34:35], v[64:65] op_sel:[1,1] op_sel_hi:[1,0]
    s_add_u32 s83, s26, 61440
    buffer_load_dwordx4 a[148:151], v3, s[84:87], s83 offen sc1
    v_pk_mul_f32 v[138:139], v[38:39], v[66:67] op_sel:[1,1] op_sel_hi:[1,0]
    v_pk_mul_f32 v[140:141], v[42:43], v[68:69] op_sel:[1,1] op_sel_hi:[1,0]
    v_pk_mul_f32 v[142:143], v[46:47], v[70:71] op_sel:[1,1] op_sel_hi:[1,0]
    v_pk_mul_f32 v[144:145], v[50:51], v[72:73] op_sel:[1,1] op_sel_hi:[1,0]
    v_pk_mul_f32 v[146:147], v[54:55], v[74:75] op_sel:[1,1] op_sel_hi:[1,0]
    v_pk_mul_f32 v[148:149], v[58:59], v[76:77] op_sel:[1,1] op_sel_hi:[1,0]
    v_pk_mul_f32 v[150:151], v[62:63], v[78:79] op_sel:[1,1] op_sel_hi:[1,0]
    v_pk_fma_f32 v[136:137], v[34:35], v[64:65], v[136:137] op_sel_hi:[0,1,1] neg_lo:[0,0,1]
    v_pk_fma_f32 v[138:139], v[38:39], v[66:67], v[138:139] op_sel_hi:[0,1,1] neg_lo:[0,0,1]
    v_pk_fma_f32 v[140:141], v[42:43], v[68:69], v[140:141] op_sel_hi:[0,1,1] neg_lo:[0,0,1]
    v_pk_fma_f32 v[142:143], v[46:47], v[70:71], v[142:143] op_sel_hi:[0,1,1] neg_lo:[0,0,1]
    v_pk_fma_f32 v[144:145], v[50:51], v[72:73], v[144:145] op_sel_hi:[0,1,1] neg_lo:[0,0,1]
    v_pk_fma_f32 v[146:147], v[54:55], v[74:75], v[146:147] op_sel_hi:[0,1,1] neg_lo:[0,0,1]
    v_pk_fma_f32 v[148:149], v[58:59], v[76:77], v[148:149] op_sel_hi:[0,1,1] neg_lo:[0,0,1]
    v_pk_fma_f32 v[150:151], v[62:63], v[78:79], v[150:151] op_sel_hi:[0,1,1] neg_lo:[0,0,1]
    v_cvt_pk_f16_f32 v128, v136, v137
    s_add_u32 s83, s26, 81920
    buffer_load_dwordx4 a[152:155], v3, s[84:87], s83 offen sc1
    v_cvt_pk_f16_f32 v129, v138, v139
    v_cvt_pk_f16_f32 v130, v140, v141
    v_cvt_pk_f16_f32 v131, v142, v143
    v_cvt_pk_f16_f32 v132, v144, v145
    v_cvt_pk_f16_f32 v133, v146, v147
    v_cvt_pk_f16_f32 v134, v148, v149
    v_cvt_pk_f16_f32 v135, v150, v151
    v_mfma_f32_16x16x32_f16 v[164:167], v[128:131], v[120:123], 0
    s_nop 0
    v_mfma_f32_16x16x32_f16 v[164:167], v[132:135], v[124:127], v[164:167]
    v_cvt_pk_f16_f32 v96, v64, -v65
    s_add_u32 s83, s26, 1024
    buffer_load_dwordx4 a[156:159], v3, s[84:87], s83 offen sc1
    v_cvt_pk_f16_f32 v97, v66, -v67
    v_cvt_pk_f16_f32 v98, v68, -v69
    v_cvt_pk_f16_f32 v99, v70, -v71
    v_cvt_pk_f16_f32 v100, v72, -v73
    v_cvt_pk_f16_f32 v101, v74, -v75
    v_cvt_pk_f16_f32 v102, v76, -v77
    v_cvt_pk_f16_f32 v103, v78, -v79
    v_mfma_f32_16x16x32_f16 v[168:171], v[128:131], v[96:99], 0
    s_nop 0
    v_mfma_f32_16x16x32_f16 v[168:171], v[132:135], v[100:103], v[168:171]
    s_waitcnt lgkmcnt(0)
    v_pk_mul_f32 v[152:153], v[152:153], v[172:173] op_sel_hi:[1,0]
    s_add_u32 s83, s26, 21504
    buffer_load_dwordx4 a[160:163], v3, s[84:87], s83 offen sc1
    v_pk_mul_f32 v[154:155], v[154:155], v[172:173] op_sel_hi:[1,0]
    v_pk_mul_f32 v[156:157], v[156:157], v[172:173] op_sel_hi:[1,0]
    v_pk_mul_f32 v[158:159], v[158:159], v[172:173] op_sel_hi:[1,0]
    v_pk_mul_f32 v[160:161], v[160:161], v[172:173] op_sel_hi:[1,0]
    v_pk_mul_f32 v[162:163], v[162:163], v[172:173] op_sel_hi:[1,0]
    v_pk_mul_f32 v[164:165], v[164:165], v[172:173] op_sel_hi:[1,0]
    v_pk_mul_f32 v[166:167], v[166:167], v[172:173] op_sel_hi:[1,0]
    ds_write_b32 v175, v152 offset:22528
    ds_write_b32 v175, v153 offset:22800
    ds_write_b32 v175, v154 offset:23072
    ds_write_b32 v175, v155 offset:23344
    v_mul_f32 v168, v168, v172
    s_add_u32 s83, s26, 41984
    buffer_load_dwordx4 a[164:167], v3, s[84:87], s83 offen sc1
    s_mov_b32 exec_lo, 0
    ds_write_b32 v175, v156 offset:24704
    ds_write_b32 v175, v157 offset:24976
    ds_write_b32 v175, v158 offset:25248
    ds_write_b32 v175, v159 offset:25520
    ds_write_b32 v175, v160 offset:26880
    ds_write_b32 v175, v161 offset:27152
    ds_write_b32 v175, v162 offset:27424
    ds_write_b32 v175, v163 offset:27696
    ds_write_b32 v175, v164 offset:29056
    ds_write_b32 v175, v165 offset:29328
    ds_write_b32 v175, v166 offset:29600
    ds_write_b32 v175, v167 offset:29872
    s_mov_b32 exec_hi, 0x100
    ds_write_b32 v175, v168 offset:31104
    s_mov_b64 exec, -1
    s_mov_b32 s89, 0x40000
mk_sp26:
    v_xor_b32 v136, s88, v229
    v_xor_b32 v137, s88, v231
    v_xor_b32 v138, s88, v233
    v_xor_b32 v139, s88, v235
    v_xor_b32 v140, s88, v237
    v_xor_b32 v141, s88, v239
    v_xor_b32 v142, s88, v241
    v_xor_b32 v143, s88, v243
    v_or3_b32 v136, v136, v137, v138
    v_or3_b32 v139, v139, v140, v141
    v_or3_b32 v136, v136, v142, v143
    v_or_b32 v136, v136, v139
    v_cmp_ne_u32 vcc, 0, v136
    s_cbranch_vccz mk_spd27
    buffer_load_dwordx4 v[228:231], v180, s[16:19], 0 offen offset:0 sc1
    buffer_load_dwordx4 v[232:235], v180, s[16:19], 0 offen offset:16 sc1
    buffer_load_dwordx4 v[236:239], v180, s[16:19], 0 offen offset:32 sc1
    buffer_load_dwordx4 v[240:243], v180, s[16:19], 0 offen offset:48 sc1
    s_sub_u32 s89, s89, 1
    s_cmp_lg_u32 s89, 0
    s_waitcnt vmcnt(0)
    s_cbranch_scc1 mk_sp26
mk_spd27:
    v_lshlrev_b32 v229, 16, v230
    s_add_u32 s83, s26, 62464
    buffer_load_dwordx4 a[168:171], v3, s[84:87], s83 offen sc1
    v_and_b32 v231, 0xffff0000, v230
    v_and_b32 v230, 0xffff0000, v228
    v_lshlrev_b32 v228, 16, v228
    v_lshlrev_b32 v233, 16, v234
    v_and_b32 v235, 0xffff0000, v234
    v_and_b32 v234, 0xffff0000, v232
    v_lshlrev_b32 v232, 16, v232
    v_lshlrev_b32 v237, 16, v238
    v_and_b32 v239, 0xffff0000, v238
    v_and_b32 v238, 0xffff0000, v236
    v_lshlrev_b32 v236, 16, v236
    v_lshlrev_b32 v241, 16, v242
    v_and_b32 v243, 0xffff0000, v242
    v_and_b32 v242, 0xffff0000, v240
    v_lshlrev_b32 v240, 16, v240
    v_rcp_f32 v230, v230
    s_add_u32 s83, s26, 82944
    buffer_load_dwordx4 a[172:175], v3, s[84:87], s83 offen sc1
    v_rcp_f32 v231, v231
    v_rcp_f32 v234, v234
    v_rcp_f32 v235, v235
    v_rcp_f32 v238, v238
    s_add_u32 s83, s26, 2048
    buffer_load_dwordx4 a[176:179], v3, s[84:87], s83 offen sc1
    v_rcp_f32 v239, v239
    v_rcp_f32 v242, v242
    v_rcp_f32 v243, v243
    v_lshlrev_b32 v224, 16, v224
    v_lshlrev_b32 v225, 16, v225
    v_lshlrev_b32 v226, 16, v226
    v_pk_mul_f32 v[228:229], v[228:229], v[230:231] neg_lo:[1,0] neg_hi:[1,0]
    s_add_u32 s83, s26, 22528
    buffer_load_dwordx4 a[180:183], v3, s[84:87], s83 offen sc1
    v_pk_mul_f32 v[232:233], v[232:233], v[234:235] neg_lo:[1,0] neg_hi:[1,0]
    v_pk_mul_f32 v[236:237], v[236:237], v[238:239] neg_lo:[1,0] neg_hi:[1,0]
    v_pk_mul_f32 v[240:241], v[240:241], v[242:243] neg_lo:[1,0] neg_hi:[1,0]
    buffer_load_dwordx4 v[216:219], v210, s[92:95], 0 offen sc1
    s_lshl_b32 s68, s62, 7
    s_add_u32 s68, s68, 5243008
    s_add_u32 s69, s68, 128
    s_sub_u32 s67, s68, 128
    s_cmp_lg_u32 s63, 0
    s_cselect_b32 s67, 0x40000000, s67
    s_waitcnt vmcnt(17)
    s_cmp_eq_u32 s63, 0
    s_cbranch_scc0 mk_lno30
    s_waitcnt vmcnt(13)
mk_lno30:
    v_lshlrev_b32 v24, 16, v28
    v_and_b32 v25, 0xffff0000, v28
    s_add_u32 s83, s26, 43008
    buffer_load_dwordx4 a[184:187], v3, s[84:87], s83 offen sc1
    v_lshlrev_b32 v26, 16, v29
    v_and_b32 v27, 0xffff0000, v29
    v_lshlrev_b32 v28, 16, v30
    v_and_b32 v29, 0xffff0000, v30
    v_lshlrev_b32 v30, 16, v31
    v_and_b32 v31, 0xffff0000, v31
    v_pk_fma_f32 v[152:153], v[24:25], v[230:231], v[228:229]
    v_pk_fma_f32 v[154:155], v[26:27], v[234:235], v[232:233]
    v_pk_fma_f32 v[156:157], v[28:29], v[238:239], v[236:237]
    v_pk_fma_f32 v[158:159], v[30:31], v[242:243], v[240:241]
    v_cvt_pk_bf16_f32 v108, v152, v153
    v_cvt_pk_bf16_f32 v109, v154, v155
    v_cvt_pk_bf16_f32 v110, v156, v157
    v_cvt_pk_bf16_f32 v111, v158, v159
    ds_write_b128 v207, v[108:111] offset:35072
    s_add_u32 s83, s26, 63488
    buffer_load_dwordx4 a[188:191], v3, s[84:87], s83 offen sc1
    v_add_u32 v5, 34912, v208
    ds_write2_b32 v5, v108, v109 offset0:0 offset1:1
    ds_write2_b32 v5, v110, v111 offset0:2 offset1:3
    v_pk_fma_f32 v[24:25], v[152:153], v[226:227], v[24:25] op_sel:[0,0,0] op_sel_hi:[1,0,1]
    v_pk_fma_f32 v[26:27], v[154:155], v[226:227], v[26:27] op_sel:[0,0,0] op_sel_hi:[1,0,1]
    v_pk_fma_f32 v[28:29], v[156:157], v[226:227], v[28:29] op_sel:[0,0,0] op_sel_hi:[1,0,1]
    v_pk_fma_f32 v[30:31], v[158:159], v[226:227], v[30:31] op_sel:[0,0,0] op_sel_hi:[1,0,1]
    v_lshlrev_b32 v16, 16, v20
    v_and_b32 v17, 0xffff0000, v20
    v_lshlrev_b32 v18, 16, v21
    v_and_b32 v19, 0xffff0000, v21
    v_lshlrev_b32 v20, 16, v22
    v_and_b32 v21, 0xffff0000, v22
    v_lshlrev_b32 v22, 16, v23
    s_add_u32 s83, s26, 83968
    buffer_load_dwordx4 a[192:195], v3, s[84:87], s83 offen sc1
    v_and_b32 v23, 0xffff0000, v23
    v_pk_fma_f32 v[160:161], v[16:17], v[230:231], v[228:229]
    v_pk_fma_f32 v[162:163], v[18:19], v[234:235], v[232:233]
    v_pk_fma_f32 v[164:165], v[20:21], v[238:239], v[236:237]
    v_pk_fma_f32 v[166:167], v[22:23], v[242:243], v[240:241]
    v_cvt_pk_bf16_f32 v104, v160, v161
    v_cvt_pk_bf16_f32 v105, v162, v163
    v_cvt_pk_bf16_f32 v106, v164, v165
    v_cvt_pk_bf16_f32 v107, v166, v167
    ds_write_b128 v207, v[104:107] offset:160
    ds_write2_b32 v208, v104, v105 offset0:0 offset1:1
    ds_write2_b32 v208, v106, v107 offset0:2 offset1:3
    v_pk_fma_f32 v[16:17], v[160:161], v[224:225], v[16:17] op_sel:[0,1,0] op_sel_hi:[1,1,1]
    s_add_u32 s83, s26, 3072
    buffer_load_dwordx4 a[196:199], v3, s[84:87], s83 offen sc1
    v_pk_fma_f32 v[18:19], v[162:163], v[224:225], v[18:19] op_sel:[0,1,0] op_sel_hi:[1,1,1]
    v_pk_fma_f32 v[20:21], v[164:165], v[224:225], v[20:21] op_sel:[0,1,0] op_sel_hi:[1,1,1]
    v_pk_fma_f32 v[22:23], v[166:167], v[224:225], v[22:23] op_sel:[0,1,0] op_sel_hi:[1,1,1]
    s_cmp_lg_u32 s63, 0
    s_cbranch_scc1 mk_u028
    v_lshlrev_b32 v8, 16, v12
    v_and_b32 v9, 0xffff0000, v12
    v_lshlrev_b32 v10, 16, v13
    v_and_b32 v11, 0xffff0000, v13
    v_lshlrev_b32 v12, 16, v14
    v_and_b32 v13, 0xffff0000, v14
    v_lshlrev_b32 v14, 16, v15
    v_and_b32 v15, 0xffff0000, v15
    v_pk_fma_f32 v[152:153], v[8:9], v[230:231], v[228:229]
    v_pk_fma_f32 v[154:155], v[10:11], v[234:235], v[232:233]
    v_pk_fma_f32 v[156:157], v[12:13], v[238:239], v[236:237]
    v_pk_fma_f32 v[158:159], v[14:15], v[242:243], v[240:241]
    v_cvt_pk_bf16_f32 v100, v152, v153
    v_cvt_pk_bf16_f32 v101, v154, v155
    v_cvt_pk_bf16_f32 v102, v156, v157
    v_cvt_pk_bf16_f32 v103, v158, v159
    v_add_u32 v4, 69824, v207
    ds_write_b128 v4, v[100:103] offset:160
    v_add_u32 v5, 69824, v208
    ds_write2_b32 v5, v100, v101 offset0:0 offset1:1
    ds_write2_b32 v5, v102, v103 offset0:2 offset1:3
    v_pk_fma_f32 v[8:9], v[152:153], v[224:225], v[8:9] op_sel:[0,0,0] op_sel_hi:[1,0,1]
    v_pk_fma_f32 v[10:11], v[154:155], v[224:225], v[10:11] op_sel:[0,0,0] op_sel_hi:[1,0,1]
    v_pk_fma_f32 v[12:13], v[156:157], v[224:225], v[12:13] op_sel:[0,0,0] op_sel_hi:[1,0,1]
    v_pk_fma_f32 v[14:15], v[158:159], v[224:225], v[14:15] op_sel:[0,0,0] op_sel_hi:[1,0,1]
    s_branch mk_u331
mk_u028:
    s_lshl_b32 s29, s64, 4
    s_lshl_b32 s28, s3, 2
    s_add_u32 s28, s28, s29
    s_add_u32 s28, s28, 20480
    s_waitcnt vmcnt(17)
    s_mov_b64 exec, 1
    buffer_store_dword v245, off, s[92:95], s28 sc1
    s_mov_b64 exec, -1
mk_u331:
    s_cmp_lg_u32 s26, 1073741824
    s_cbranch_scc1 mk_u129
    s_mov_b32 s89, 0x40000
    s_waitcnt vmcnt(4)
mk_fp32:
    v_xor_b32 v216, s88, v216
    v_xor_b32 v217, s88, v217
    v_xor_b32 v218, s88, v218
    v_xor_b32 v219, s88, v219
    v_or3_b32 v216, v216, v217, v218
    v_or_b32 v216, v216, v219
    v_cmp_ne_u32 vcc, 0, v216
    s_cbranch_vccz mk_fpd33
    buffer_load_dwordx4 v[216:219], v210, s[92:95], 0 offen sc1
    s_sub_u32 s89, s89, 1
    s_cmp_lg_u32 s89, 0
    s_waitcnt vmcnt(0)
    s_cbranch_scc1 mk_fp32
mk_fpd33:
    s_add_u32 s83, s80, 0
    buffer_load_dwordx4 a[136:139], v3, s[84:87], s83 offen sc1
    s_add_u32 s83, s80, 20480
    buffer_load_dwordx4 a[140:143], v3, s[84:87], s83 offen sc1
    s_add_u32 s83, s80, 40960
    buffer_load_dwordx4 a[144:147], v3, s[84:87], s83 offen sc1
    s_add_u32 s83, s80, 61440
    buffer_load_dwordx4 a[148:151], v3, s[84:87], s83 offen sc1
    s_add_u32 s83, s80, 81920
    buffer_load_dwordx4 a[152:155], v3, s[84:87], s83 offen sc1
    s_add_u32 s83, s80, 1024
    buffer_load_dwordx4 a[156:159], v3, s[84:87], s83 offen sc1
    s_add_u32 s83, s80, 21504
    buffer_load_dwordx4 a[160:163], v3, s[84:87], s83 offen sc1
    s_add_u32 s83, s80, 41984
    buffer_load_dwordx4 a[164:167], v3, s[84:87], s83 offen sc1
    s_add_u32 s83, s80, 62464
    buffer_load_dwordx4 a[168:171], v3, s[84:87], s83 offen sc1
    s_add_u32 s83, s80, 82944
    buffer_load_dwordx4 a[172:175], v3, s[84:87], s83 offen sc1
    s_add_u32 s83, s80, 2048
    buffer_load_dwordx4 a[176:179], v3, s[84:87], s83 offen sc1
    s_add_u32 s83, s80, 22528
    buffer_load_dwordx4 a[180:183], v3, s[84:87], s83 offen sc1
    s_add_u32 s83, s80, 43008
    buffer_load_dwordx4 a[184:187], v3, s[84:87], s83 offen sc1
    s_add_u32 s83, s80, 63488
    buffer_load_dwordx4 a[188:191], v3, s[84:87], s83 offen sc1
    s_add_u32 s83, s80, 83968
    buffer_load_dwordx4 a[192:195], v3, s[84:87], s83 offen sc1
    s_add_u32 s83, s80, 3072
    buffer_load_dwordx4 a[196:199], v3, s[84:87], s83 offen sc1
mk_u129:
    s_waitcnt lgkmcnt(0)
    s_barrier
    v_add_u32 v5, 69824, v209
    v_mov_b32 v4, 113440
    s_cmp_lt_u32 s3, 2
    s_cbranch_scc1 mk_pr34
    ds_read_b128 v[164:167], v209 offset:35072
    ds_read_b128 v[168:171], v209 offset:35088
    ds_read_b128 v[156:159], v209 offset:160
    ds_read_b128 v[160:163], v209 offset:176
    ds_read_b128 v[148:151], v5 offset:160
    ds_read_b128 v[152:155], v5 offset:176
    ds_read_b128 v[32:35], v194
    ds_read_b128 v[36:39], v195
    ds_read_b128 v[40:43], v196
    ds_read_b128 v[44:47], v197
    ds_read_b128 v[48:51], v198
    ds_read_b128 v[52:55], v199
    s_waitcnt lgkmcnt(10)
    v_mfma_f32_32x32x16_bf16 v[92:107], a[236:239], v[164:167], 0
    ds_read_b128 v[56:59], v200
    ds_read_b128 v[60:63], v201
    ds_read_b128 v[64:67], v202
    ds_read_b128 v[68:71], v203
    ds_read_b128 v[72:75], v204
    ds_read_b128 v[112:115], v4 offset:0
    ds_read_b128 v[116:119], v4 offset:11264
    ds_read_b128 v[120:123], v4 offset:22528
    ds_read_b128 v[140:143], v221 offset:35072
    ds_read_b64 v[144:145], v222 offset:35072
    ds_read_b128 v[132:135], v221 offset:160
    ds_read_b64 v[136:137], v222 offset:160
    v_add_u32 v221, 69824, v221
    v_add_u32 v222, 69824, v222
    ds_read_b128 v[124:127], v221 offset:160
    ds_read_b64 v[128:129], v222 offset:160
    v_mfma_f32_32x32x16_bf16 v[92:107], a[240:243], v[168:171], v[92:107]
    s_add_u32 s83, s80, 23552
    buffer_load_dwordx4 a[200:203], v3, s[84:87], s83 offen sc1
    s_add_u32 s83, s80, 44032
    buffer_load_dwordx4 a[204:207], v3, s[84:87], s83 offen sc1
    s_add_u32 s83, s80, 64512
    buffer_load_dwordx4 a[208:211], v3, s[84:87], s83 offen sc1
    s_waitcnt lgkmcnt(15)
    v_pk_add_f32 v[32:33], v[32:33], v[34:35]
    v_pk_add_f32 v[36:37], v[36:37], v[38:39]
    v_pk_add_f32 v[40:41], v[40:41], v[42:43]
    v_pk_add_f32 v[44:45], v[44:45], v[46:47]
    s_waitcnt lgkmcnt(12)
    v_pk_add_f32 v[48:49], v[48:49], v[50:51]
    v_pk_add_f32 v[52:53], v[52:53], v[54:55]
    v_pk_add_f32 v[56:57], v[56:57], v[58:59]
    v_pk_add_f32 v[60:61], v[60:61], v[62:63]
    s_waitcnt lgkmcnt(9)
    v_pk_add_f32 v[64:65], v[64:65], v[66:67]
    v_pk_add_f32 v[68:69], v[68:69], v[70:71]
    v_pk_add_f32 v[72:73], v[72:73], v[74:75]
    v_mfma_f32_32x32x16_bf16 v[228:243], a[236:239], v[156:159], 0
    v_add_f32 v32, v32, v33
    v_add_f32 v36, v36, v37
    s_add_u32 s83, s80, 84992
    buffer_load_dwordx4 a[212:215], v3, s[84:87], s83 offen sc1
    v_add_f32 v40, v40, v41
    v_add_f32 v44, v44, v45
    v_add_f32 v48, v48, v49
    v_add_f32 v52, v52, v53
    v_add_f32 v56, v56, v57
    v_add_f32 v60, v60, v61
    v_add_f32 v64, v64, v65
    v_add_f32 v68, v68, v69
    v_add_f32 v72, v72, v73
    v_cvt_pk_bf16_f32 v76, v32, v36
    v_cvt_pk_bf16_f32 v77, v40, v44
    v_cvt_pk_bf16_f32 v78, v48, v52
    v_cvt_pk_bf16_f32 v79, v56, v60
    ds_write_b128 v205, v[76:79] offset:0
    v_cvt_pk_bf16_f32 v80, v36, v40
    v_cvt_pk_bf16_f32 v92, v92, v93
    v_cvt_pk_bf16_f32 v93, v94, v95
    v_cvt_pk_bf16_f32 v94, v96, v97
    v_cvt_pk_bf16_f32 v95, v98, v99
    ds_write_b128 v220, v[92:95] offset:41568
    v_mfma_f32_32x32x16_bf16 v[228:243], a[240:243], v[160:163], v[228:243]
    v_cvt_pk_bf16_f32 v81, v44, v48
    s_add_u32 s83, s80, 4096
    buffer_load_dwordx4 a[216:219], v3, s[84:87], s83 offen sc1
    v_cvt_pk_bf16_f32 v82, v52, v56
    v_cvt_pk_bf16_f32 v83, v60, v64
    ds_write_b128 v205, v[80:83] offset:3744
    v_cvt_pk_bf16_f32 v84, v40, v44
    v_cvt_pk_bf16_f32 v85, v48, v52
    v_cvt_pk_bf16_f32 v86, v56, v60
    v_cvt_pk_bf16_f32 v87, v64, v68
    ds_write_b128 v205, v[84:87] offset:7488
    v_cvt_pk_bf16_f32 v88, v44, v48
    v_cvt_pk_bf16_f32 v89, v52, v56
    v_cvt_pk_bf16_f32 v90, v60, v64
    v_cvt_pk_bf16_f32 v91, v68, v72
    ds_write_b128 v205, v[88:91] offset:11232
    s_waitcnt lgkmcnt(11)
    v_pk_add_f32 v[112:113], v[112:113], v[114:115]
    s_add_u32 s83, s80, 24576
    buffer_load_dwordx4 a[220:223], v3, s[84:87], s83 offen sc1
    v_cvt_pk_bf16_f32 v100, v100, v101
    v_cvt_pk_bf16_f32 v101, v102, v103
    v_cvt_pk_bf16_f32 v102, v104, v105
    v_cvt_pk_bf16_f32 v103, v106, v107
    ds_write_b128 v220, v[100:103] offset:60096
    v_mfma_f32_32x32x16_bf16 v[92:107], a[236:239], v[148:151], 0
    v_pk_add_f32 v[116:117], v[116:117], v[118:119]
    v_pk_add_f32 v[120:121], v[120:121], v[122:123]
    v_add_f32 v176, v112, v113
    v_add_f32 v177, v116, v117
    v_add_f32 v178, v120, v121
    s_waitcnt lgkmcnt(10)
    v_and_b32 v32, 0xffff0000, v141
    v_lshlrev_b32 v33, 16, v142
    v_and_b32 v34, 0xffff0000, v142
    v_lshlrev_b32 v35, 16, v143
    v_and_b32 v36, 0xffff0000, v143
    v_lshlrev_b32 v37, 16, v144
    v_and_b32 v38, 0xffff0000, v144
    v_lshlrev_b32 v39, 16, v145
    v_pk_fma_f32 v[24:25], v[32:33], v[178:179], v[24:25] op_sel:[0,0,0] op_sel_hi:[1,0,1] neg_lo:[1,0,0] neg_hi:[1,0,0]
    v_pk_fma_f32 v[26:27], v[34:35], v[178:179], v[26:27] op_sel:[0,0,0] op_sel_hi:[1,0,1] neg_lo:[1,0,0] neg_hi:[1,0,0]
    s_add_u32 s83, s80, 45056
    buffer_load_dwordx4 a[224:227], v3, s[84:87], s83 offen sc1
    v_pk_fma_f32 v[28:29], v[36:37], v[178:179], v[28:29] op_sel:[0,0,0] op_sel_hi:[1,0,1] neg_lo:[1,0,0] neg_hi:[1,0,0]
    v_cvt_pk_bf16_f32 v228, v228, v229
    v_cvt_pk_bf16_f32 v229, v230, v231
    v_cvt_pk_bf16_f32 v230, v232, v233
    v_cvt_pk_bf16_f32 v231, v234, v235
    ds_write_b128 v220, v[228:231] offset:6656
    v_mfma_f32_32x32x16_bf16 v[92:107], a[240:243], v[152:155], v[92:107]
    v_pk_fma_f32 v[30:31], v[38:39], v[178:179], v[30:31] op_sel:[0,0,0] op_sel_hi:[1,0,1] neg_lo:[1,0,0] neg_hi:[1,0,0]
    s_waitcnt lgkmcnt(9)
    v_and_b32 v32, 0xffff0000, v133
    v_lshlrev_b32 v33, 16, v134
    v_and_b32 v34, 0xffff0000, v134
    v_lshlrev_b32 v35, 16, v135
    v_and_b32 v36, 0xffff0000, v135
    v_lshlrev_b32 v37, 16, v136
    v_and_b32 v38, 0xffff0000, v136
    v_lshlrev_b32 v39, 16, v137
    v_pk_fma_f32 v[16:17], v[32:33], v[176:177], v[16:17] op_sel:[0,1,0] op_sel_hi:[1,1,1] neg_lo:[1,0,0] neg_hi:[1,0,0]
    v_pk_fma_f32 v[18:19], v[34:35], v[176:177], v[18:19] op_sel:[0,1,0] op_sel_hi:[1,1,1] neg_lo:[1,0,0] neg_hi:[1,0,0]
    v_pk_fma_f32 v[20:21], v[36:37], v[176:177], v[20:21] op_sel:[0,1,0] op_sel_hi:[1,1,1] neg_lo:[1,0,0] neg_hi:[1,0,0]
    v_pk_fma_f32 v[22:23], v[38:39], v[176:177], v[22:23] op_sel:[0,1,0] op_sel_hi:[1,1,1] neg_lo:[1,0,0] neg_hi:[1,0,0]
    s_add_u32 s83, s80, 65536
    buffer_load_dwordx4 a[228:231], v3, s[84:87], s83 offen sc1
    v_cvt_pk_bf16_f32 v236, v236, v237
    v_cvt_pk_bf16_f32 v237, v238, v239
    v_cvt_pk_bf16_f32 v238, v240, v241
    v_cvt_pk_bf16_f32 v239, v242, v243
    ds_write_b128 v220, v[236:239] offset:25184
    v_add_u32 v5, 69824, v220
    s_cmp_lg_u32 s63, 0
    s_cbranch_scc1 mk_pre36
    v_cvt_pk_bf16_f32 v92, v92, v93
    v_cvt_pk_bf16_f32 v93, v94, v95
    v_cvt_pk_bf16_f32 v94, v96, v97
    v_cvt_pk_bf16_f32 v95, v98, v99
    ds_write_b128 v5, v[92:95] offset:6656
    v_cvt_pk_bf16_f32 v100, v100, v101
    v_cvt_pk_bf16_f32 v101, v102, v103
    v_cvt_pk_bf16_f32 v102, v104, v105
    v_cvt_pk_bf16_f32 v103, v106, v107
    ds_write_b128 v5, v[100:103] offset:25184
    s_waitcnt lgkmcnt(10)
    v_and_b32 v32, 0xffff0000, v125
    v_lshlrev_b32 v33, 16, v126
    v_and_b32 v34, 0xffff0000, v126
    v_lshlrev_b32 v35, 16, v127
    v_and_b32 v36, 0xffff0000, v127
    v_lshlrev_b32 v37, 16, v128
    v_and_b32 v38, 0xffff0000, v128
    v_lshlrev_b32 v39, 16, v129
    v_pk_fma_f32 v[8:9], v[32:33], v[176:177], v[8:9] op_sel:[0,0,0] op_sel_hi:[1,0,1] neg_lo:[1,0,0] neg_hi:[1,0,0]
    v_pk_fma_f32 v[10:11], v[34:35], v[176:177], v[10:11] op_sel:[0,0,0] op_sel_hi:[1,0,1] neg_lo:[1,0,0] neg_hi:[1,0,0]
    v_pk_fma_f32 v[12:13], v[36:37], v[176:177], v[12:13] op_sel:[0,0,0] op_sel_hi:[1,0,1] neg_lo:[1,0,0] neg_hi:[1,0,0]
    v_pk_fma_f32 v[14:15], v[38:39], v[176:177], v[14:15] op_sel:[0,0,0] op_sel_hi:[1,0,1] neg_lo:[1,0,0] neg_hi:[1,0,0]
    s_branch mk_pre36
mk_pr34:
    ds_read_b128 v[164:167], v209 offset:35072
    ds_read_b128 v[168:171], v209 offset:35088
    ds_read_b128 v[156:159], v209 offset:160
    ds_read_b128 v[160:163], v209 offset:176
    ds_read_b128 v[148:151], v5 offset:160
    ds_read_b128 v[152:155], v5 offset:176
    ds_read_b128 v[32:35], v194
    ds_read_b128 v[36:39], v195
    ds_read_b128 v[40:43], v196
    ds_read_b128 v[44:47], v197
    ds_read_b128 v[48:51], v198
    ds_read_b128 v[52:55], v199
    s_waitcnt lgkmcnt(10)
    v_mfma_f32_32x32x16_bf16 v[92:107], a[236:239], v[164:167], 0
    ds_read_b128 v[56:59], v200
    ds_read_b128 v[60:63], v201
    ds_read_b128 v[64:67], v202
    ds_read_b128 v[68:71], v203
    ds_read_b128 v[72:75], v204
    v_mfma_f32_32x32x16_bf16 v[92:107], a[240:243], v[168:171], v[92:107]
    s_add_u32 s83, s80, 23552
    buffer_load_dwordx4 a[200:203], v3, s[84:87], s83 offen sc1
    s_add_u32 s83, s80, 44032
    buffer_load_dwordx4 a[204:207], v3, s[84:87], s83 offen sc1
    s_add_u32 s83, s80, 64512
    buffer_load_dwordx4 a[208:211], v3, s[84:87], s83 offen sc1
    s_waitcnt lgkmcnt(7)
    v_mfma_f32_32x32x16_bf16 v[228:243], a[244:247], v[164:167], 0
    v_pk_add_f32 v[32:33], v[32:33], v[34:35]
    v_pk_add_f32 v[36:37], v[36:37], v[38:39]
    v_pk_add_f32 v[40:41], v[40:41], v[42:43]
    v_pk_add_f32 v[44:45], v[44:45], v[46:47]
    s_waitcnt lgkmcnt(3)
    v_pk_add_f32 v[48:49], v[48:49], v[50:51]
    v_cvt_pk_bf16_f32 v92, v92, v93
    v_cvt_pk_bf16_f32 v93, v94, v95
    v_cvt_pk_bf16_f32 v94, v96, v97
    v_cvt_pk_bf16_f32 v95, v98, v99
    ds_write_b128 v220, v[92:95] offset:41568
    v_mfma_f32_32x32x16_bf16 v[228:243], a[248:251], v[168:171], v[228:243]
    v_pk_add_f32 v[52:53], v[52:53], v[54:55]
    v_pk_add_f32 v[56:57], v[56:57], v[58:59]
    s_add_u32 s83, s80, 84992
    buffer_load_dwordx4 a[212:215], v3, s[84:87], s83 offen sc1
    v_pk_add_f32 v[60:61], v[60:61], v[62:63]
    s_waitcnt lgkmcnt(1)
    v_pk_add_f32 v[64:65], v[64:65], v[66:67]
    v_cvt_pk_bf16_f32 v100, v100, v101
    v_cvt_pk_bf16_f32 v101, v102, v103
    v_cvt_pk_bf16_f32 v102, v104, v105
    v_cvt_pk_bf16_f32 v103, v106, v107
    ds_write_b128 v220, v[100:103] offset:60096
    v_mfma_f32_32x32x16_bf16 v[124:139], a[236:239], v[156:159], 0
    v_pk_add_f32 v[68:69], v[68:69], v[70:71]
    v_pk_add_f32 v[72:73], v[72:73], v[74:75]
    v_add_f32 v32, v32, v33
    v_add_f32 v36, v36, v37
    v_add_f32 v40, v40, v41
    v_add_f32 v44, v44, v45
    v_cvt_pk_bf16_f32 v228, v228, v229
    v_cvt_pk_bf16_f32 v229, v230, v231
    v_cvt_pk_bf16_f32 v230, v232, v233
    v_cvt_pk_bf16_f32 v231, v234, v235
    ds_write_b128 v220, v[228:231] offset:47840
    v_mfma_f32_32x32x16_bf16 v[124:139], a[240:243], v[160:163], v[124:139]
    s_add_u32 s83, s80, 4096
    buffer_load_dwordx4 a[216:219], v3, s[84:87], s83 offen sc1
    v_add_f32 v48, v48, v49
    v_add_f32 v52, v52, v53
    v_add_f32 v56, v56, v57
    v_add_f32 v60, v60, v61
    v_add_f32 v64, v64, v65
    v_cvt_pk_bf16_f32 v236, v236, v237
    v_cvt_pk_bf16_f32 v237, v238, v239
    v_cvt_pk_bf16_f32 v238, v240, v241
    v_cvt_pk_bf16_f32 v239, v242, v243
    ds_write_b128 v220, v[236:239] offset:51584
    v_mfma_f32_32x32x16_bf16 v[92:107], a[244:247], v[156:159], 0
    v_add_f32 v68, v68, v69
    v_add_f32 v72, v72, v73
    v_cvt_pk_bf16_f32 v76, v32, v36
    v_cvt_pk_bf16_f32 v77, v40, v44
    s_add_u32 s83, s80, 24576
    buffer_load_dwordx4 a[220:223], v3, s[84:87], s83 offen sc1
    v_cvt_pk_bf16_f32 v78, v48, v52
    v_cvt_pk_bf16_f32 v124, v124, v125
    v_cvt_pk_bf16_f32 v125, v126, v127
    v_cvt_pk_bf16_f32 v126, v128, v129
    v_cvt_pk_bf16_f32 v127, v130, v131
    ds_write_b128 v220, v[124:127] offset:6656
    v_mfma_f32_32x32x16_bf16 v[92:107], a[248:251], v[160:163], v[92:107]
    v_cvt_pk_bf16_f32 v79, v56, v60
    ds_write_b128 v205, v[76:79] offset:0
    v_cvt_pk_bf16_f32 v80, v36, v40
    v_cvt_pk_bf16_f32 v81, v44, v48
    v_cvt_pk_bf16_f32 v82, v52, v56
    v_cvt_pk_bf16_f32 v83, v60, v64
    v_cvt_pk_bf16_f32 v132, v132, v133
    v_cvt_pk_bf16_f32 v133, v134, v135
    v_cvt_pk_bf16_f32 v134, v136, v137
    v_cvt_pk_bf16_f32 v135, v138, v139
    ds_write_b128 v220, v[132:135] offset:25184
    v_mfma_f32_32x32x16_bf16 v[228:243], a[236:239], v[148:151], 0
    ds_write_b128 v205, v[80:83] offset:3744
    v_cvt_pk_bf16_f32 v84, v40, v44
    s_add_u32 s83, s80, 45056
    buffer_load_dwordx4 a[224:227], v3, s[84:87], s83 offen sc1
    v_cvt_pk_bf16_f32 v85, v48, v52
    v_cvt_pk_bf16_f32 v86, v56, v60
    v_cvt_pk_bf16_f32 v87, v64, v68
    v_cvt_pk_bf16_f32 v92, v92, v93
    v_cvt_pk_bf16_f32 v93, v94, v95
    v_cvt_pk_bf16_f32 v94, v96, v97
    v_cvt_pk_bf16_f32 v95, v98, v99
    ds_write_b128 v220, v[92:95] offset:12928
    v_mfma_f32_32x32x16_bf16 v[228:243], a[240:243], v[152:155], v[228:243]
    ds_write_b128 v205, v[84:87] offset:7488
    v_cvt_pk_bf16_f32 v88, v44, v48
    v_cvt_pk_bf16_f32 v89, v52, v56
    v_cvt_pk_bf16_f32 v90, v60, v64
    v_cvt_pk_bf16_f32 v91, v68, v72
    ds_write_b128 v205, v[88:91] offset:11232
    v_cvt_pk_bf16_f32 v100, v100, v101
    v_cvt_pk_bf16_f32 v101, v102, v103
    v_cvt_pk_bf16_f32 v102, v104, v105
    v_cvt_pk_bf16_f32 v103, v106, v107
    ds_write_b128 v220, v[100:103] offset:16672
    v_mfma_f32_32x32x16_bf16 v[124:139], a[244:247], v[148:151], 0
    s_add_u32 s83, s80, 65536
    buffer_load_dwordx4 a[228:231], v3, s[84:87], s83 offen sc1
    v_mfma_f32_32x32x16_bf16 v[124:139], a[248:251], v[152:155], v[124:139]
    v_add_u32 v5, 69824, v220
    s_cmp_lg_u32 s63, 0
    s_cbranch_scc1 mk_pre36
    v_cvt_pk_bf16_f32 v228, v228, v229
    v_cvt_pk_bf16_f32 v229, v230, v231
    v_cvt_pk_bf16_f32 v230, v232, v233
    v_cvt_pk_bf16_f32 v231, v234, v235
    ds_write_b128 v5, v[228:231] offset:6656
    v_cvt_pk_bf16_f32 v236, v236, v237
    v_cvt_pk_bf16_f32 v237, v238, v239
    v_cvt_pk_bf16_f32 v238, v240, v241
    v_cvt_pk_bf16_f32 v239, v242, v243
    ds_write_b128 v5, v[236:239] offset:25184
    v_cvt_pk_bf16_f32 v124, v124, v125
    v_cvt_pk_bf16_f32 v125, v126, v127
    v_cvt_pk_bf16_f32 v126, v128, v129
    v_cvt_pk_bf16_f32 v127, v130, v131
    ds_write_b128 v5, v[124:127] offset:12928
    v_cvt_pk_bf16_f32 v132, v132, v133
    v_cvt_pk_bf16_f32 v133, v134, v135
    v_cvt_pk_bf16_f32 v134, v136, v137
    v_cvt_pk_bf16_f32 v135, v138, v139
    ds_write_b128 v5, v[132:135] offset:16672
mk_pre36:
    s_cmp_eq_u32 s3, 0
    s_cbranch_scc1 mk_cp037
    s_cmp_eq_u32 s3, 1
    s_cbranch_scc1 mk_cp138
mk_cp239:
    s_cmp_lg_u32 s63, 0
    s_cbranch_scc1 mk_cln41
    ds_read_b128 v[100:103], v188 offset:864
    ds_read_b128 v[104:107], v187 offset:928
    ds_read_b128 v[96:99], v187 offset:768
    ds_read_b128 v[92:95], v187 offset:704
    ds_read_b128 v[88:91], v187 offset:640
    ds_read_b128 v[84:87], v188 offset:576
    ds_read_b128 v[80:83], v187 offset:480
    ds_read_b128 v[76:79], v187 offset:416
    ds_read_b128 v[72:75], v187 offset:352
    s_waitcnt lgkmcnt(9)
    s_barrier
    ds_read2_b64 v[32:35], v182 offset0:64 offset1:65
    ds_read2_b64 v[36:39], v182 offset0:56 offset1:57
    ds_read2_b64 v[40:43], v182 offset0:48 offset1:49
    ds_read2_b64 v[44:47], v182 offset0:40 offset1:41
    ds_read2_b64 v[48:51], v182 offset0:32 offset1:33
    ds_read2_b64 v[52:55], v182 offset0:24 offset1:25
    ds_read2_b64 v[56:59], v182 offset0:16 offset1:17
    ds_read2_b64 v[60:63], v182 offset0:8 offset1:9
    s_waitcnt lgkmcnt(7)
    v_mfma_f32_16x16x32_bf16 v[116:119], v[32:35], v[100:103], 0
    s_add_u32 s83, s80, 86016
    buffer_load_dwordx4 a[232:235], v3, s[84:87], s83 offen sc1
    v_mfma_f32_16x16x32_bf16 v[120:123], v[32:35], v[104:107], 0
    s_waitcnt lgkmcnt(6)
    v_mfma_f32_16x16x32_bf16 v[116:119], v[36:39], v[96:99], v[116:119]
    ds_read2_b64 v[64:67], v182 offset0:0 offset1:1
    ds_read_b128 v[68:71], v188 offset:288
    v_mfma_f32_16x16x32_bf16 v[120:123], v[36:39], v[100:103], v[120:123]
    s_waitcnt lgkmcnt(7)
    v_mfma_f32_16x16x32_bf16 v[116:119], v[40:43], v[92:95], v[116:119]
    s_add_u32 s83, s80, 819200
    buffer_load_dwordx4 a[36:39], v3, s[84:87], s83 offen sc1
    v_mfma_f32_16x16x32_bf16 v[120:123], v[40:43], v[96:99], v[120:123]
    s_waitcnt lgkmcnt(6)
    ds_read_b128 v[108:111], v187 offset:992
    ds_read_b128 v[112:115], v187 offset:1056
    v_mfma_f32_16x16x32_bf16 v[116:119], v[44:47], v[88:91], v[116:119]
    v_mfma_f32_16x16x32_bf16 v[120:123], v[44:47], v[92:95], v[120:123]
    s_waitcnt lgkmcnt(7)
    s_add_u32 s83, s80, 839680
    v_mfma_f32_16x16x32_bf16 v[116:119], v[48:51], v[84:87], v[116:119]
    buffer_load_dwordx4 a[40:43], v3, s[84:87], s83 offen sc1
    v_mfma_f32_16x16x32_bf16 v[120:123], v[48:51], v[88:91], v[120:123]
    s_waitcnt lgkmcnt(6)
    v_mfma_f32_16x16x32_bf16 v[116:119], v[52:55], v[80:83], v[116:119]
    s_add_u32 s83, s80, 860160
    buffer_load_dwordx4 a[44:47], v3, s[84:87], s83 offen sc1
    v_mfma_f32_16x16x32_bf16 v[120:123], v[52:55], v[84:87], v[120:123]
    s_waitcnt lgkmcnt(5)
    v_mfma_f32_16x16x32_bf16 v[116:119], v[56:59], v[76:79], v[116:119]
    v_mfma_f32_16x16x32_bf16 v[120:123], v[56:59], v[80:83], v[120:123]
    s_waitcnt lgkmcnt(4)
    s_add_u32 s83, s80, 880640
    v_mfma_f32_16x16x32_bf16 v[116:119], v[60:63], v[72:75], v[116:119]
    buffer_load_dwordx4 a[48:51], v3, s[84:87], s83 offen sc1
    v_mfma_f32_16x16x32_bf16 v[120:123], v[60:63], v[76:79], v[120:123]
    s_waitcnt lgkmcnt(2)
    v_mfma_f32_16x16x32_bf16 v[116:119], v[64:67], v[68:71], v[116:119]
    s_add_u32 s83, s80, 901120
    buffer_load_dwordx4 a[52:55], v3, s[84:87], s83 offen sc1
    v_mfma_f32_16x16x32_bf16 v[120:123], v[64:67], v[72:75], v[120:123]
    s_waitcnt lgkmcnt(1)
    v_mfma_f32_16x16x32_bf16 v[124:127], v[32:35], v[108:111], 0
    s_waitcnt lgkmcnt(0)
    v_mfma_f32_16x16x32_bf16 v[128:131], v[32:35], v[112:115], 0
    s_add_u32 s83, s80, 820224
    buffer_load_dwordx4 a[56:59], v3, s[84:87], s83 offen sc1
    v_mfma_f32_16x16x32_bf16 v[124:127], v[36:39], v[104:107], v[124:127]
    ds_write_b128 v189, v[116:119] offset:0
    v_mfma_f32_16x16x32_bf16 v[128:131], v[36:39], v[108:111], v[128:131]
    ds_write_b128 v189, v[120:123] offset:64
    v_mfma_f32_16x16x32_bf16 v[124:127], v[40:43], v[100:103], v[124:127]
    s_add_u32 s83, s80, 840704
    buffer_load_dwordx4 a[60:63], v3, s[84:87], s83 offen sc1
    v_mfma_f32_16x16x32_bf16 v[128:131], v[40:43], v[104:107], v[128:131]
    ds_read2_b64 v[32:35], v183 offset0:64 offset1:65
    v_mfma_f32_16x16x32_bf16 v[124:127], v[44:47], v[96:99], v[124:127]
    v_mfma_f32_16x16x32_bf16 v[128:131], v[44:47], v[100:103], v[128:131]
    s_add_u32 s83, s80, 861184
    buffer_load_dwordx4 a[64:67], v3, s[84:87], s83 offen sc1
    v_mfma_f32_16x16x32_bf16 v[124:127], v[48:51], v[92:95], v[124:127]
    ds_read_b128 v[100:103], v186 offset:864
    ds_read_b128 v[104:107], v185 offset:928
    v_mfma_f32_16x16x32_bf16 v[128:131], v[48:51], v[96:99], v[128:131]
    ds_read2_b64 v[36:39], v183 offset0:56 offset1:57
    v_mfma_f32_16x16x32_bf16 v[124:127], v[52:55], v[88:91], v[124:127]
    s_add_u32 s83, s80, 881664
    buffer_load_dwordx4 a[68:71], v3, s[84:87], s83 offen sc1
    v_mfma_f32_16x16x32_bf16 v[128:131], v[52:55], v[92:95], v[128:131]
    ds_read_b128 v[96:99], v185 offset:768
    ds_read2_b64 v[40:43], v183 offset0:48 offset1:49
    v_mfma_f32_16x16x32_bf16 v[124:127], v[56:59], v[84:87], v[124:127]
    ds_read_b128 v[92:95], v185 offset:704
    ds_read2_b64 v[44:47], v183 offset0:40 offset1:41
    v_mfma_f32_16x16x32_bf16 v[128:131], v[56:59], v[88:91], v[128:131]
    s_add_u32 s83, s80, 902144
    buffer_load_dwordx4 a[72:75], v3, s[84:87], s83 offen sc1
    v_mfma_f32_16x16x32_bf16 v[124:127], v[60:63], v[80:83], v[124:127]
    ds_read_b128 v[88:91], v185 offset:640
    ds_read2_b64 v[48:51], v183 offset0:32 offset1:33
    v_mfma_f32_16x16x32_bf16 v[128:131], v[60:63], v[84:87], v[128:131]
    v_mfma_f32_16x16x32_bf16 v[124:127], v[64:67], v[76:79], v[124:127]
    s_add_u32 s83, s80, 821248
    buffer_load_dwordx4 a[76:79], v3, s[84:87], s83 offen sc1
    v_mfma_f32_16x16x32_bf16 v[128:131], v[64:67], v[80:83], v[128:131]
    s_waitcnt lgkmcnt(8)
    ds_read_b128 v[84:87], v186 offset:576
    ds_read2_b64 v[52:55], v183 offset0:24 offset1:25
mk_ck42:
    v_mfma_f32_16x16x32_bf16 v[116:119], v[32:35], v[100:103], 0
    s_waitcnt lgkmcnt(9)
    s_add_u32 s83, s80, 841728
    ds_read_b128 v[80:83], v185 offset:480
    v_mfma_f32_16x16x32_bf16 v[120:123], v[32:35], v[104:107], 0
    s_waitcnt lgkmcnt(8)
    buffer_load_dwordx4 a[80:83], v3, s[84:87], s83 offen sc1
    v_mfma_f32_16x16x32_bf16 v[116:119], v[36:39], v[96:99], v[116:119]
    ds_write_b128 v189, v[124:127] offset:128
    v_mfma_f32_16x16x32_bf16 v[120:123], v[36:39], v[100:103], v[120:123]
    s_waitcnt lgkmcnt(7)
    ds_write_b128 v189, v[128:131] offset:192
    v_mfma_f32_16x16x32_bf16 v[116:119], v[40:43], v[92:95], v[116:119]
    s_add_u32 s83, s80, 862208
    buffer_load_dwordx4 a[84:87], v3, s[84:87], s83 offen sc1
    v_mfma_f32_16x16x32_bf16 v[120:123], v[40:43], v[96:99], v[120:123]
    s_waitcnt lgkmcnt(6)
    ds_read2_b64 v[56:59], v183 offset0:16 offset1:17
    ds_read_b128 v[76:79], v185 offset:416
    v_mfma_f32_16x16x32_bf16 v[116:119], v[44:47], v[88:91], v[116:119]
    ds_read2_b64 v[60:63], v183 offset0:8 offset1:9
    ds_read_b128 v[72:75], v185 offset:352
    v_mfma_f32_16x16x32_bf16 v[120:123], v[44:47], v[92:95], v[120:123]
    s_waitcnt lgkmcnt(8)
    s_add_u32 s83, s80, 882688
    ds_read2_b64 v[64:67], v183 offset0:0 offset1:1
    s_waitcnt lgkmcnt(5)
    s_barrier
    v_mfma_f32_16x16x32_bf16 v[116:119], v[48:51], v[84:87], v[116:119]
    buffer_load_dwordx4 a[88:91], v3, s[84:87], s83 offen sc1
    ds_read_b128 v[132:135], v191 offset:0
    ds_read_b128 v[136:139], v191 offset:4352
    v_mfma_f32_16x16x32_bf16 v[120:123], v[48:51], v[88:91], v[120:123]
    ds_read_b128 v[140:143], v192 offset:8192
    ds_read_b128 v[144:147], v192 offset:11840
    v_mfma_f32_16x16x32_bf16 v[116:119], v[52:55], v[80:83], v[116:119]
    s_add_u32 s83, s80, 903168
    ds_read_b128 v[148:151], v192 offset:14976
    ds_read_b128 v[152:155], v192 offset:18048
    v_mfma_f32_16x16x32_bf16 v[120:123], v[52:55], v[84:87], v[120:123]
    s_waitcnt lgkmcnt(9)
    ds_read_b128 v[68:71], v186 offset:288
    buffer_load_dwordx4 a[92:95], v3, s[84:87], s83 offen sc1
    ds_read_b128 v[156:159], v192 offset:20096
    ds_read_b128 v[160:163], v192 offset:22144
    v_mfma_f32_16x16x32_bf16 v[116:119], v[56:59], v[76:79], v[116:119]
    buffer_load_dwordx4 v[232:235], v223, s[92:95], 0 offen sc1
    v_mfma_f32_16x16x32_bf16 v[120:123], v[56:59], v[80:83], v[120:123]
    s_waitcnt lgkmcnt(10)
    ds_read_b128 v[108:111], v185 offset:992
    ds_read_b128 v[112:115], v185 offset:1056
    v_mfma_f32_16x16x32_bf16 v[116:119], v[60:63], v[72:75], v[116:119]
    s_add_u32 s83, s80, 822272
    buffer_load_dwordx4 a[96:99], v3, s[84:87], s83 offen sc1
    v_mfma_f32_16x16x32_bf16 v[120:123], v[60:63], v[76:79], v[120:123]
    s_waitcnt lgkmcnt(4)
    buffer_store_dwordx4 a[0:3], v3, s[84:87], s39 offen sc1
    s_add_u32 s39, s39, 55296
    v_mfma_f32_16x16x32_bf16 v[116:119], v[64:67], v[68:71], v[116:119]
    s_add_u32 s83, s80, 842752
    buffer_load_dwordx4 a[100:103], v3, s[84:87], s83 offen sc1
    v_mfma_f32_16x16x32_bf16 v[120:123], v[64:67], v[72:75], v[120:123]
    s_waitcnt lgkmcnt(1)
    v_pk_add_f32 v[8:9], v[8:9], v[132:133]
    v_pk_add_f32 v[10:11], v[10:11], v[134:135]
    v_mfma_f32_16x16x32_bf16 v[124:127], v[32:35], v[108:111], 0
    s_waitcnt lgkmcnt(0)
    v_pk_add_f32 v[12:13], v[12:13], v[136:137]
    v_pk_add_f32 v[14:15], v[14:15], v[138:139]
    v_mfma_f32_16x16x32_bf16 v[128:131], v[32:35], v[112:115], 0
    s_add_u32 s83, s80, 863232
    buffer_load_dwordx4 a[104:107], v3, s[84:87], s83 offen sc1
    v_mfma_f32_16x16x32_bf16 v[124:127], v[36:39], v[104:107], v[124:127]
    ds_write_b128 v189, v[116:119] offset:26240
    v_mfma_f32_16x16x32_bf16 v[128:131], v[36:39], v[108:111], v[128:131]
    ds_write_b128 v189, v[120:123] offset:26304
    v_pk_add_f32 v[8:9], v[8:9], v[140:141]
    v_mfma_f32_16x16x32_bf16 v[124:127], v[40:43], v[100:103], v[124:127]
    s_add_u32 s83, s80, 883712
    buffer_load_dwordx4 a[108:111], v3, s[84:87], s83 offen sc1
    v_pk_add_f32 v[10:11], v[10:11], v[142:143]
    v_mfma_f32_16x16x32_bf16 v[128:131], v[40:43], v[104:107], v[128:131]
    ds_read2_b64 v[32:35], v184 offset0:64 offset1:65
    v_pk_add_f32 v[12:13], v[12:13], v[144:145]
    v_mfma_f32_16x16x32_bf16 v[124:127], v[44:47], v[96:99], v[124:127]
    buffer_store_dwordx4 a[4:7], v3, s[84:87], s39 offen sc1
    v_pk_add_f32 v[14:15], v[14:15], v[146:147]
    v_mfma_f32_16x16x32_bf16 v[128:131], v[44:47], v[100:103], v[128:131]
    s_add_u32 s39, s39, 55296
    s_add_u32 s83, s80, 904192
    v_pk_add_f32 v[8:9], v[8:9], v[148:149]
    v_mfma_f32_16x16x32_bf16 v[124:127], v[48:51], v[92:95], v[124:127]
    buffer_load_dwordx4 a[112:115], v3, s[84:87], s83 offen sc1
    v_pk_add_f32 v[10:11], v[10:11], v[150:151]
    v_mfma_f32_16x16x32_bf16 v[128:131], v[48:51], v[96:99], v[128:131]
    ds_read_b128 v[100:103], v186 offset:35776
    ds_read_b128 v[104:107], v185 offset:35840
    v_pk_add_f32 v[12:13], v[12:13], v[152:153]
    v_mfma_f32_16x16x32_bf16 v[124:127], v[52:55], v[88:91], v[124:127]
    s_add_u32 s83, s80, 823296
    buffer_load_dwordx4 a[116:119], v3, s[84:87], s83 offen sc1
    v_pk_add_f32 v[14:15], v[14:15], v[154:155]
    v_mfma_f32_16x16x32_bf16 v[128:131], v[52:55], v[92:95], v[128:131]
    ds_read2_b64 v[36:39], v184 offset0:56 offset1:57
    ds_read_b128 v[96:99], v185 offset:35680
    v_pk_add_f32 v[8:9], v[8:9], v[156:157]
    v_mfma_f32_16x16x32_bf16 v[124:127], v[56:59], v[84:87], v[124:127]
    ds_read2_b64 v[40:43], v184 offset0:48 offset1:49
    ds_read_b128 v[92:95], v185 offset:35616
    v_pk_add_f32 v[10:11], v[10:11], v[158:159]
    v_mfma_f32_16x16x32_bf16 v[128:131], v[56:59], v[88:91], v[128:131]
    s_add_u32 s83, s80, 843776
    buffer_load_dwordx4 a[120:123], v3, s[84:87], s83 offen sc1
    v_pk_add_f32 v[12:13], v[12:13], v[160:161]
    v_mfma_f32_16x16x32_bf16 v[124:127], v[60:63], v[80:83], v[124:127]
    ds_read2_b64 v[44:47], v184 offset0:40 offset1:41
    ds_read_b128 v[88:91], v185 offset:35552
    v_pk_add_f32 v[14:15], v[14:15], v[162:163]
    v_mfma_f32_16x16x32_bf16 v[128:131], v[60:63], v[84:87], v[128:131]
    ds_read2_b64 v[48:51], v184 offset0:32 offset1:33
    v_cvt_pk_bf16_f32 v8, v8, v9
    v_mfma_f32_16x16x32_bf16 v[124:127], v[64:67], v[76:79], v[124:127]
    s_add_u32 s83, s80, 864256
    buffer_load_dwordx4 a[124:127], v3, s[84:87], s83 offen sc1
    v_cvt_pk_bf16_f32 v9, v10, v11
    v_mfma_f32_16x16x32_bf16 v[128:131], v[64:67], v[80:83], v[128:131]
    s_waitcnt lgkmcnt(8)
    buffer_store_dwordx4 a[8:11], v3, s[84:87], s39 offen sc1
    s_add_u32 s39, s39, 55296
    v_cvt_pk_bf16_f32 v10, v12, v13
    v_mfma_f32_16x16x32_bf16 v[116:119], v[32:35], v[100:103], 0
    s_waitcnt lgkmcnt(7)
    s_add_u32 s83, s80, 884736
    ds_read_b128 v[84:87], v186 offset:35488
    v_cvt_pk_bf16_f32 v11, v14, v15
    v_mfma_f32_16x16x32_bf16 v[120:123], v[32:35], v[104:107], 0
    s_waitcnt lgkmcnt(6)
    buffer_store_dwordx4 v[8:11], v193, s[16:19], s67 offen sc1
    v_mfma_f32_16x16x32_bf16 v[116:119], v[36:39], v[96:99], v[116:119]
    buffer_load_dwordx4 a[128:131], v3, s[84:87], s83 offen sc1
    v_mfma_f32_16x16x32_bf16 v[120:123], v[36:39], v[100:103], v[120:123]
    s_waitcnt lgkmcnt(4)
    ds_write_b128 v189, v[124:127] offset:26368
    v_mfma_f32_16x16x32_bf16 v[116:119], v[40:43], v[92:95], v[116:119]
    s_add_u32 s83, s80, 905216
    ds_write_b128 v189, v[128:131] offset:26432
    v_mfma_f32_16x16x32_bf16 v[120:123], v[40:43], v[96:99], v[120:123]
    s_waitcnt lgkmcnt(4)
    ds_read2_b64 v[52:55], v184 offset0:24 offset1:25
    ds_read_b128 v[80:83], v185 offset:35392
    v_mfma_f32_16x16x32_bf16 v[116:119], v[44:47], v[88:91], v[116:119]
    buffer_load_dwordx4 a[132:135], v3, s[84:87], s83 offen sc1
    v_mfma_f32_16x16x32_bf16 v[120:123], v[44:47], v[92:95], v[120:123]
    s_waitcnt lgkmcnt(4)
    ds_read2_b64 v[56:59], v184 offset0:16 offset1:17
    ds_read_b128 v[76:79], v185 offset:35328
    s_waitcnt lgkmcnt(4)
    s_mov_b32 s89, 0x40000
    s_waitcnt vmcnt(14)
mk_fp43:
    v_xor_b32 v232, s88, v232
    v_xor_b32 v233, s88, v233
    v_xor_b32 v234, s88, v234
    v_xor_b32 v235, s88, v235
    v_or3_b32 v232, v232, v233, v234
    v_or_b32 v232, v232, v235
    v_cmp_ne_u32 vcc, 0, v232
    s_cbranch_vccz mk_fpd44
    buffer_load_dwordx4 v[232:235], v223, s[92:95], 0 offen sc1
    s_sub_u32 s89, s89, 1
    s_cmp_lg_u32 s89, 0
    s_waitcnt vmcnt(0)
    s_cbranch_scc1 mk_fp43
mk_fpd44:
    s_barrier
    v_mfma_f32_16x16x32_bf16 v[116:119], v[48:51], v[84:87], v[116:119]
    ds_read_b128 v[132:135], v191 offset:26240
    ds_read_b128 v[136:139], v191 offset:30592
    v_mfma_f32_16x16x32_bf16 v[120:123], v[48:51], v[88:91], v[120:123]
    s_waitcnt lgkmcnt(4)
    ds_read2_b64 v[60:63], v184 offset0:8 offset1:9
    ds_read_b128 v[72:75], v185 offset:35264
    buffer_store_dwordx4 a[12:15], v3, s[84:87], s39 offen sc1
    ds_read_b128 v[140:143], v192 offset:34432
    ds_read_b128 v[144:147], v192 offset:38080
    v_mfma_f32_16x16x32_bf16 v[116:119], v[52:55], v[80:83], v[116:119]
    s_add_u32 s83, s81, 0
    buffer_load_dwordx4 v[212:215], v206, s[84:87], s83 offen offset:0 sc1
    ds_read_b128 v[148:151], v192 offset:41216
    ds_read_b128 v[152:155], v192 offset:44288
    v_mfma_f32_16x16x32_bf16 v[120:123], v[52:55], v[84:87], v[120:123]
    s_waitcnt lgkmcnt(8)
    ds_read2_b64 v[64:67], v184 offset0:0 offset1:1
    ds_read_b128 v[68:71], v186 offset:35200
    ds_read_b128 v[156:159], v192 offset:46336
    ds_read_b128 v[160:163], v192 offset:48384
    v_mfma_f32_16x16x32_bf16 v[116:119], v[56:59], v[76:79], v[116:119]
    s_add_u32 s83, s81, 512
    buffer_load_dwordx4 v[216:219], v206, s[84:87], s83 offen offset:0 sc1
    v_mfma_f32_16x16x32_bf16 v[120:123], v[56:59], v[80:83], v[120:123]
    s_waitcnt lgkmcnt(8)
    ds_read_b128 v[108:111], v185 offset:35904
    ds_read_b128 v[112:115], v185 offset:35968
    v_mfma_f32_16x16x32_bf16 v[116:119], v[60:63], v[72:75], v[116:119]
    s_add_u32 s83, s81, 1024
    buffer_load_dwordx4 v[220:223], v206, s[84:87], s83 offen offset:0 sc1
    v_mfma_f32_16x16x32_bf16 v[120:123], v[60:63], v[76:79], v[120:123]
    s_waitcnt lgkmcnt(4)
    v_pk_add_f32 v[16:17], v[16:17], v[132:133]
    v_mfma_f32_16x16x32_bf16 v[116:119], v[64:67], v[68:71], v[116:119]
    v_pk_add_f32 v[18:19], v[18:19], v[134:135]
    v_mfma_f32_16x16x32_bf16 v[120:123], v[64:67], v[72:75], v[120:123]
    s_waitcnt lgkmcnt(1)
    v_pk_add_f32 v[20:21], v[20:21], v[136:137]
    v_mfma_f32_16x16x32_bf16 v[124:127], v[32:35], v[108:111], 0
    s_waitcnt lgkmcnt(0)
    s_add_u32 s83, s81, 1536
    v_pk_add_f32 v[22:23], v[22:23], v[138:139]
    v_mfma_f32_16x16x32_bf16 v[128:131], v[32:35], v[112:115], 0
    buffer_load_dwordx4 v[224:227], v206, s[84:87], s83 offen offset:0 sc1
    v_mfma_f32_16x16x32_bf16 v[124:127], v[36:39], v[104:107], v[124:127]
    ds_write_b128 v189, v[116:119] offset:0
    v_mfma_f32_16x16x32_bf16 v[128:131], v[36:39], v[108:111], v[128:131]
    s_add_u32 s83, s81, 2048
    buffer_load_dwordx4 v[228:231], v206, s[84:87], s83 offen offset:0 sc1
    v_pk_add_f32 v[16:17], v[16:17], v[140:141]
    v_mfma_f32_16x16x32_bf16 v[124:127], v[40:43], v[100:103], v[124:127]
    ds_write_b128 v189, v[120:123] offset:64
    v_pk_add_f32 v[18:19], v[18:19], v[142:143]
    v_mfma_f32_16x16x32_bf16 v[128:131], v[40:43], v[104:107], v[128:131]
    v_pk_add_f32 v[20:21], v[20:21], v[144:145]
    v_pk_add_f32 v[22:23], v[22:23], v[146:147]
    v_mfma_f32_16x16x32_bf16 v[124:127], v[44:47], v[96:99], v[124:127]
    s_add_u32 s83, s81, 2560
    buffer_load_dwordx4 v[232:235], v206, s[84:87], s83 offen offset:0 sc1
    v_mfma_f32_16x16x32_bf16 v[128:131], v[44:47], v[100:103], v[128:131]
    v_pk_add_f32 v[16:17], v[16:17], v[148:149]
    v_pk_add_f32 v[18:19], v[18:19], v[150:151]
    v_mfma_f32_16x16x32_bf16 v[124:127], v[48:51], v[92:95], v[124:127]
    v_pk_add_f32 v[20:21], v[20:21], v[152:153]
    v_pk_add_f32 v[22:23], v[22:23], v[154:155]
    v_mfma_f32_16x16x32_bf16 v[128:131], v[48:51], v[96:99], v[128:131]
    v_pk_add_f32 v[16:17], v[16:17], v[156:157]
    v_mfma_f32_16x16x32_bf16 v[124:127], v[52:55], v[88:91], v[124:127]
    v_pk_add_f32 v[18:19], v[18:19], v[158:159]
    v_mfma_f32_16x16x32_bf16 v[128:131], v[52:55], v[92:95], v[128:131]
    v_pk_add_f32 v[20:21], v[20:21], v[160:161]
    v_mfma_f32_16x16x32_bf16 v[124:127], v[56:59], v[84:87], v[124:127]
    v_pk_add_f32 v[22:23], v[22:23], v[162:163]
    v_mfma_f32_16x16x32_bf16 v[128:131], v[56:59], v[88:91], v[128:131]
    v_cvt_pk_bf16_f32 v16, v16, v17
    v_mfma_f32_16x16x32_bf16 v[124:127], v[60:63], v[80:83], v[124:127]
    v_cvt_pk_bf16_f32 v17, v18, v19
    v_mfma_f32_16x16x32_bf16 v[128:131], v[60:63], v[84:87], v[128:131]
    v_cvt_pk_bf16_f32 v18, v20, v21
    v_mfma_f32_16x16x32_bf16 v[124:127], v[64:67], v[76:79], v[124:127]
    v_cvt_pk_bf16_f32 v19, v22, v23
    v_mfma_f32_16x16x32_bf16 v[128:131], v[64:67], v[80:83], v[128:131]
    buffer_store_dwordx4 v[16:19], v193, s[16:19], s68 offen sc1
    s_nop 4
    ds_write_b128 v189, v[124:127] offset:128
    s_nop 0
    ds_write_b128 v189, v[128:131] offset:192
    s_waitcnt vmcnt(7)
    s_waitcnt lgkmcnt(0)
    s_barrier
    ds_read_b128 v[132:135], v191 offset:0
    ds_read_b128 v[136:139], v191 offset:4352
    ds_read_b128 v[140:143], v192 offset:8192
    ds_read_b128 v[144:147], v192 offset:11840
    ds_read_b128 v[148:151], v192 offset:14976
    ds_read_b128 v[152:155], v192 offset:18048
    ds_read_b128 v[156:159], v192 offset:20096
    ds_read_b128 v[160:163], v192 offset:22144
    s_lshl_b32 s29, s3, 8
    s_lshl_b32 s28, s60, 5
    s_add_u32 s29, s29, s28
    s_add_u32 s29, s29, s61
    s_waitcnt lgkmcnt(6)
    v_pk_add_f32 v[24:25], v[24:25], v[132:133]
    v_pk_add_f32 v[26:27], v[26:27], v[134:135]
    v_pk_add_f32 v[28:29], v[28:29], v[136:137]
    v_pk_add_f32 v[30:31], v[30:31], v[138:139]
    s_waitcnt lgkmcnt(4)
    v_pk_add_f32 v[24:25], v[24:25], v[140:141]
    v_pk_add_f32 v[26:27], v[26:27], v[142:143]
    v_pk_add_f32 v[28:29], v[28:29], v[144:145]
    v_pk_add_f32 v[30:31], v[30:31], v[146:147]
    s_waitcnt lgkmcnt(2)
    v_pk_add_f32 v[24:25], v[24:25], v[148:149]
    v_pk_add_f32 v[26:27], v[26:27], v[150:151]
    v_pk_add_f32 v[28:29], v[28:29], v[152:153]
    v_pk_add_f32 v[30:31], v[30:31], v[154:155]
    s_waitcnt lgkmcnt(0)
    v_pk_add_f32 v[24:25], v[24:25], v[156:157]
    v_pk_add_f32 v[26:27], v[26:27], v[158:159]
    v_pk_add_f32 v[28:29], v[28:29], v[160:161]
    v_pk_add_f32 v[30:31], v[30:31], v[162:163]
    v_cvt_pk_bf16_f32 v24, v24, v25
    v_cvt_pk_bf16_f32 v25, v26, v27
    v_cvt_pk_bf16_f32 v26, v28, v29
    v_cvt_pk_bf16_f32 v27, v30, v31
    buffer_store_dwordx4 v[24:27], v193, s[16:19], s69 offen sc1
    s_branch mk_cj40
mk_cln41:
    s_waitcnt lgkmcnt(0)
    s_barrier
    ds_read2_b64 v[32:35], v183 offset0:64 offset1:65
    ds_read_b128 v[100:103], v186 offset:864
    ds_read_b128 v[104:107], v185 offset:928
    ds_read2_b64 v[36:39], v183 offset0:56 offset1:57
    ds_read_b128 v[96:99], v185 offset:768
    ds_read2_b64 v[40:43], v183 offset0:48 offset1:49
    ds_read_b128 v[92:95], v185 offset:704
    ds_read2_b64 v[44:47], v183 offset0:40 offset1:41
    ds_read_b128 v[88:91], v185 offset:640
    ds_read2_b64 v[48:51], v183 offset0:32 offset1:33
    ds_read_b128 v[84:87], v186 offset:576
    ds_read2_b64 v[52:55], v183 offset0:24 offset1:25
    s_add_u32 s83, s80, 86016
    buffer_load_dwordx4 a[232:235], v3, s[84:87], s83 offen sc1
    s_add_u32 s83, s80, 819200
    buffer_load_dwordx4 a[36:39], v3, s[84:87], s83 offen sc1
    s_add_u32 s83, s80, 839680
    buffer_load_dwordx4 a[40:43], v3, s[84:87], s83 offen sc1
    s_add_u32 s83, s80, 860160
    buffer_load_dwordx4 a[44:47], v3, s[84:87], s83 offen sc1
    s_add_u32 s83, s80, 880640
    buffer_load_dwordx4 a[48:51], v3, s[84:87], s83 offen sc1
    s_add_u32 s83, s80, 901120
    buffer_load_dwordx4 a[52:55], v3, s[84:87], s83 offen sc1
    s_add_u32 s83, s80, 820224
    buffer_load_dwordx4 a[56:59], v3, s[84:87], s83 offen sc1
    s_add_u32 s83, s80, 840704
    buffer_load_dwordx4 a[60:63], v3, s[84:87], s83 offen sc1
    s_add_u32 s83, s80, 861184
    buffer_load_dwordx4 a[64:67], v3, s[84:87], s83 offen sc1
    s_add_u32 s83, s80, 881664
    buffer_load_dwordx4 a[68:71], v3, s[84:87], s83 offen sc1
    s_add_u32 s83, s80, 902144
    buffer_load_dwordx4 a[72:75], v3, s[84:87], s83 offen sc1
    s_add_u32 s83, s80, 821248
    buffer_load_dwordx4 a[76:79], v3, s[84:87], s83 offen sc1
    s_waitcnt lgkmcnt(0)
    s_branch mk_ck42
mk_cp138:
    s_cmp_lg_u32 s63, 0
    s_cbranch_scc1 mk_cln45
    s_waitcnt lgkmcnt(0)
    s_barrier
    ds_read2_b64 v[32:35], v182 offset0:90 offset1:91
    ds_read_b64_tr_b16 v[68:69], v187 offset:512
    ds_read_b64_tr_b16 v[70:71], v187 offset:544
    ds_read_b64_tr_b16 v[72:73], v187 offset:640
    ds_read_b64_tr_b16 v[74:75], v187 offset:672
    ds_read_b64_tr_b16 v[76:77], v187 offset:768
    ds_read_b64_tr_b16 v[78:79], v187 offset:800
    ds_read2_b64 v[36:39], v182 offset0:86 offset1:87
    ds_read_b64_tr_b16 v[64:65], v187 offset:384
    ds_read_b64_tr_b16 v[66:67], v187 offset:416
    ds_read2_b64 v[40:43], v182 offset0:82 offset1:83
    ds_read_b64_tr_b16 v[60:61], v187 offset:256
    ds_read_b64_tr_b16 v[62:63], v187 offset:288
    ds_read2_b64 v[44:47], v182 offset0:78 offset1:79
    ds_read_b64_tr_b16 v[56:57], v187 offset:128
    ds_read_b64_tr_b16 v[58:59], v187 offset:160
    ds_read2_b64 v[48:51], v182 offset0:74 offset1:75
    ds_read_b64_tr_b16 v[52:53], v187 offset:0
    ds_read_b64_tr_b16 v[54:55], v187 offset:32
    s_waitcnt lgkmcnt(15)
    v_mfma_f32_16x16x32_bf16 v[96:99], v[68:71], v[32:35], 0
    s_waitcnt lgkmcnt(14)
    s_add_u32 s83, s80, 86016
    v_mfma_f32_16x16x32_bf16 v[100:103], v[72:75], v[32:35], 0
    s_waitcnt lgkmcnt(12)
    buffer_load_dwordx4 a[232:235], v3, s[84:87], s83 offen sc1
    v_mfma_f32_16x16x32_bf16 v[104:107], v[76:79], v[32:35], 0
    s_waitcnt lgkmcnt(9)
    ds_read_b64_tr_b16 v[80:81], v187 offset:896
    ds_read_b64_tr_b16 v[82:83], v187 offset:928
    v_mfma_f32_16x16x32_bf16 v[96:99], v[64:67], v[36:39], v[96:99]
    s_add_u32 s83, s80, 819200
    buffer_load_dwordx4 a[36:39], v3, s[84:87], s83 offen sc1
    v_mfma_f32_16x16x32_bf16 v[100:103], v[68:71], v[36:39], v[100:103]
    ds_read_b64_tr_b16 v[84:85], v187 offset:1024
    ds_read_b64_tr_b16 v[86:87], v187 offset:1056
    v_mfma_f32_16x16x32_bf16 v[104:107], v[72:75], v[36:39], v[104:107]
    s_waitcnt lgkmcnt(10)
    v_mfma_f32_16x16x32_bf16 v[96:99], v[60:63], v[40:43], v[96:99]
    s_add_u32 s83, s80, 839680
    buffer_load_dwordx4 a[40:43], v3, s[84:87], s83 offen sc1
    v_mfma_f32_16x16x32_bf16 v[100:103], v[64:67], v[40:43], v[100:103]
    v_mfma_f32_16x16x32_bf16 v[104:107], v[68:71], v[40:43], v[104:107]
    s_waitcnt lgkmcnt(7)
    v_mfma_f32_16x16x32_bf16 v[96:99], v[56:59], v[44:47], v[96:99]
    s_add_u32 s83, s80, 860160
    buffer_load_dwordx4 a[44:47], v3, s[84:87], s83 offen sc1
    v_mfma_f32_16x16x32_bf16 v[100:103], v[60:63], v[44:47], v[100:103]
    v_mfma_f32_16x16x32_bf16 v[104:107], v[64:67], v[44:47], v[104:107]
    s_waitcnt lgkmcnt(4)
    ds_read_b64_tr_b16 v[88:89], v187 offset:1152
    ds_read_b64_tr_b16 v[90:91], v187 offset:1184
    v_mfma_f32_16x16x32_bf16 v[96:99], v[52:55], v[48:51], v[96:99]
    s_add_u32 s83, s80, 880640
    buffer_load_dwordx4 a[48:51], v3, s[84:87], s83 offen sc1
    v_mfma_f32_16x16x32_bf16 v[100:103], v[56:59], v[48:51], v[100:103]
    ds_read_b64_tr_b16 v[92:93], v187 offset:1280
    ds_read_b64_tr_b16 v[94:95], v187 offset:1312
    v_mfma_f32_16x16x32_bf16 v[104:107], v[60:63], v[48:51], v[104:107]
    s_waitcnt lgkmcnt(6)
    v_mfma_f32_16x16x32_bf16 v[108:111], v[80:83], v[32:35], 0
    s_waitcnt lgkmcnt(4)
    s_add_u32 s83, s80, 901120
    v_mfma_f32_16x16x32_bf16 v[112:115], v[84:87], v[32:35], 0
    buffer_load_dwordx4 a[52:55], v3, s[84:87], s83 offen sc1
    v_mfma_f32_16x16x32_bf16 v[108:111], v[76:79], v[36:39], v[108:111]
    ds_write_b128 v189, v[96:99] offset:0
    v_mfma_f32_16x16x32_bf16 v[112:115], v[80:83], v[36:39], v[112:115]
    s_add_u32 s83, s80, 820224
    ds_write_b128 v189, v[100:103] offset:128
    v_mfma_f32_16x16x32_bf16 v[108:111], v[72:75], v[40:43], v[108:111]
    ds_write_b128 v189, v[104:107] offset:256
    v_mfma_f32_16x16x32_bf16 v[112:115], v[76:79], v[40:43], v[112:115]
    buffer_load_dwordx4 a[56:59], v3, s[84:87], s83 offen sc1
    v_mfma_f32_16x16x32_bf16 v[108:111], v[68:71], v[44:47], v[108:111]
    s_add_u32 s83, s80, 840704
    buffer_load_dwordx4 a[60:63], v3, s[84:87], s83 offen sc1
    v_mfma_f32_16x16x32_bf16 v[112:115], v[72:75], v[44:47], v[112:115]
    v_mfma_f32_16x16x32_bf16 v[108:111], v[64:67], v[48:51], v[108:111]
    v_mfma_f32_16x16x32_bf16 v[112:115], v[68:71], v[48:51], v[112:115]
    s_waitcnt lgkmcnt(5)
    s_add_u32 s83, s80, 861184
    v_mfma_f32_16x16x32_bf16 v[116:119], v[88:91], v[32:35], 0
    s_waitcnt lgkmcnt(3)
    buffer_load_dwordx4 a[64:67], v3, s[84:87], s83 offen sc1
    v_mfma_f32_16x16x32_bf16 v[120:123], v[92:95], v[32:35], 0
    s_nop 0
    ds_write_b128 v189, v[108:111] offset:384
    v_mfma_f32_16x16x32_bf16 v[116:119], v[84:87], v[36:39], v[116:119]
    s_add_u32 s83, s80, 881664
    buffer_load_dwordx4 a[68:71], v3, s[84:87], s83 offen sc1
    v_mfma_f32_16x16x32_bf16 v[120:123], v[88:91], v[36:39], v[120:123]
    ds_write_b128 v189, v[112:115] offset:512
    v_mfma_f32_16x16x32_bf16 v[116:119], v[80:83], v[40:43], v[116:119]
    ds_read2_b64 v[32:35], v183 offset0:90 offset1:91
    ds_read_b64_tr_b16 v[68:69], v185 offset:512
    v_mfma_f32_16x16x32_bf16 v[120:123], v[84:87], v[40:43], v[120:123]
    s_add_u32 s83, s80, 902144
    ds_read_b64_tr_b16 v[70:71], v185 offset:544
    v_mfma_f32_16x16x32_bf16 v[116:119], v[76:79], v[44:47], v[116:119]
    buffer_load_dwordx4 a[72:75], v3, s[84:87], s83 offen sc1
    v_mfma_f32_16x16x32_bf16 v[120:123], v[80:83], v[44:47], v[120:123]
    v_mfma_f32_16x16x32_bf16 v[116:119], v[72:75], v[48:51], v[116:119]
    s_add_u32 s83, s80, 821248
    buffer_load_dwordx4 a[76:79], v3, s[84:87], s83 offen sc1
    v_mfma_f32_16x16x32_bf16 v[120:123], v[76:79], v[48:51], v[120:123]
    s_waitcnt lgkmcnt(0)
    ds_read_b64_tr_b16 v[72:73], v185 offset:640
    ds_read_b64_tr_b16 v[74:75], v185 offset:672
mk_ck46:
    v_mfma_f32_16x16x32_bf16 v[96:99], v[68:71], v[32:35], 0
    s_waitcnt lgkmcnt(0)
    ds_read_b64_tr_b16 v[76:77], v185 offset:768
    ds_read_b64_tr_b16 v[78:79], v185 offset:800
    ds_read2_b64 v[36:39], v183 offset0:86 offset1:87
    ds_read_b64_tr_b16 v[64:65], v185 offset:384
    ds_read_b64_tr_b16 v[66:67], v185 offset:416
    v_mfma_f32_16x16x32_bf16 v[100:103], v[72:75], v[32:35], 0
    s_waitcnt lgkmcnt(3)
    ds_read2_b64 v[40:43], v183 offset0:82 offset1:83
    ds_read_b64_tr_b16 v[60:61], v185 offset:256
    ds_read_b64_tr_b16 v[62:63], v185 offset:288
    v_mfma_f32_16x16x32_bf16 v[104:107], v[76:79], v[32:35], 0
    s_waitcnt lgkmcnt(3)
    s_add_u32 s83, s80, 841728
    buffer_load_dwordx4 a[80:83], v3, s[84:87], s83 offen sc1
    v_mfma_f32_16x16x32_bf16 v[96:99], v[64:67], v[36:39], v[96:99]
    s_add_u32 s83, s80, 862208
    ds_write_b128 v189, v[116:119] offset:640
    v_mfma_f32_16x16x32_bf16 v[100:103], v[68:71], v[36:39], v[100:103]
    ds_read2_b64 v[44:47], v183 offset0:78 offset1:79
    ds_read_b64_tr_b16 v[56:57], v185 offset:128
    ds_read_b64_tr_b16 v[58:59], v185 offset:160
    ds_write_b128 v189, v[120:123] offset:768
    v_mfma_f32_16x16x32_bf16 v[104:107], v[72:75], v[36:39], v[104:107]
    s_waitcnt lgkmcnt(5)
    buffer_load_dwordx4 a[84:87], v3, s[84:87], s83 offen sc1
    v_mfma_f32_16x16x32_bf16 v[96:99], v[60:63], v[40:43], v[96:99]
    s_add_u32 s83, s80, 882688
    ds_read2_b64 v[48:51], v183 offset0:74 offset1:75
    ds_read_b64_tr_b16 v[52:53], v185 offset:0
    v_mfma_f32_16x16x32_bf16 v[100:103], v[64:67], v[40:43], v[100:103]
    s_waitcnt lgkmcnt(2)
    ds_read_b64_tr_b16 v[54:55], v185 offset:32
    ds_read_b64_tr_b16 v[80:81], v185 offset:896
    s_barrier
    v_mfma_f32_16x16x32_bf16 v[104:107], v[68:71], v[40:43], v[104:107]
    buffer_load_dwordx4 a[88:91], v3, s[84:87], s83 offen sc1
    ds_read_b128 v[124:127], v191 offset:0
    ds_read_b128 v[128:131], v191 offset:4352
    v_mfma_f32_16x16x32_bf16 v[96:99], v[56:59], v[44:47], v[96:99]
    s_add_u32 s83, s80, 903168
    ds_read_b128 v[132:135], v192 offset:8192
    ds_read_b128 v[136:139], v192 offset:11840
    v_mfma_f32_16x16x32_bf16 v[100:103], v[60:63], v[44:47], v[100:103]
    ds_read_b64_tr_b16 v[82:83], v185 offset:928
    ds_read_b128 v[140:143], v192 offset:14976
    ds_read_b128 v[144:147], v192 offset:18048
    v_mfma_f32_16x16x32_bf16 v[104:107], v[64:67], v[44:47], v[104:107]
    s_waitcnt lgkmcnt(8)
    buffer_load_dwordx4 a[92:95], v3, s[84:87], s83 offen sc1
    ds_read_b64_tr_b16 v[84:85], v185 offset:1024
    ds_read_b64_tr_b16 v[86:87], v185 offset:1056
    v_mfma_f32_16x16x32_bf16 v[96:99], v[52:55], v[48:51], v[96:99]
    s_add_u32 s83, s80, 822272
    buffer_load_dwordx4 v[232:235], v223, s[92:95], 0 offen sc1
    v_mfma_f32_16x16x32_bf16 v[100:103], v[56:59], v[48:51], v[100:103]
    buffer_load_dwordx4 a[96:99], v3, s[84:87], s83 offen sc1
    v_mfma_f32_16x16x32_bf16 v[104:107], v[60:63], v[48:51], v[104:107]
    s_waitcnt lgkmcnt(4)
    buffer_store_dwordx4 a[0:3], v3, s[84:87], s39 offen sc1
    v_mfma_f32_16x16x32_bf16 v[108:111], v[80:83], v[32:35], 0
    s_waitcnt lgkmcnt(0)
    s_add_u32 s83, s80, 842752
    ds_read_b64_tr_b16 v[88:89], v185 offset:1152
    s_add_u32 s39, s39, 55296
    v_mfma_f32_16x16x32_bf16 v[112:115], v[84:87], v[32:35], 0
    buffer_load_dwordx4 a[100:103], v3, s[84:87], s83 offen sc1
    v_mfma_f32_16x16x32_bf16 v[108:111], v[76:79], v[36:39], v[108:111]
    ds_write_b128 v189, v[96:99] offset:26240
    v_pk_add_f32 v[8:9], v[8:9], v[124:125]
    v_mfma_f32_16x16x32_bf16 v[112:115], v[80:83], v[36:39], v[112:115]
    s_add_u32 s83, s80, 863232
    ds_write_b128 v189, v[100:103] offset:26368
    v_pk_add_f32 v[10:11], v[10:11], v[126:127]
    v_mfma_f32_16x16x32_bf16 v[108:111], v[72:75], v[40:43], v[108:111]
    ds_write_b128 v189, v[104:107] offset:26496
    v_pk_add_f32 v[12:13], v[12:13], v[128:129]
    v_mfma_f32_16x16x32_bf16 v[112:115], v[76:79], v[40:43], v[112:115]
    buffer_load_dwordx4 a[104:107], v3, s[84:87], s83 offen sc1
    ds_read_b64_tr_b16 v[90:91], v185 offset:1184
    v_pk_add_f32 v[14:15], v[14:15], v[130:131]
    v_mfma_f32_16x16x32_bf16 v[108:111], v[68:71], v[44:47], v[108:111]
    s_add_u32 s83, s80, 883712
    ds_read_b64_tr_b16 v[92:93], v185 offset:1280
    ds_read_b64_tr_b16 v[94:95], v185 offset:1312
    v_pk_add_f32 v[8:9], v[8:9], v[132:133]
    v_mfma_f32_16x16x32_bf16 v[112:115], v[72:75], v[44:47], v[112:115]
    buffer_load_dwordx4 a[108:111], v3, s[84:87], s83 offen sc1
    v_pk_add_f32 v[10:11], v[10:11], v[134:135]
    v_mfma_f32_16x16x32_bf16 v[108:111], v[64:67], v[48:51], v[108:111]
    v_pk_add_f32 v[12:13], v[12:13], v[136:137]
    v_pk_add_f32 v[14:15], v[14:15], v[138:139]
    v_mfma_f32_16x16x32_bf16 v[112:115], v[68:71], v[48:51], v[112:115]
    s_waitcnt lgkmcnt(2)
    buffer_store_dwordx4 a[4:7], v3, s[84:87], s39 offen sc1
    v_mfma_f32_16x16x32_bf16 v[116:119], v[88:91], v[32:35], 0
    s_waitcnt lgkmcnt(0)
    s_add_u32 s83, s80, 904192
    s_add_u32 s39, s39, 55296
    v_pk_add_f32 v[8:9], v[8:9], v[140:141]
    v_mfma_f32_16x16x32_bf16 v[120:123], v[92:95], v[32:35], 0
    buffer_load_dwordx4 a[112:115], v3, s[84:87], s83 offen sc1
    v_pk_add_f32 v[10:11], v[10:11], v[142:143]
    v_mfma_f32_16x16x32_bf16 v[116:119], v[84:87], v[36:39], v[116:119]
    s_add_u32 s83, s80, 823296
    ds_write_b128 v189, v[108:111] offset:26624
    v_pk_add_f32 v[12:13], v[12:13], v[144:145]
    v_mfma_f32_16x16x32_bf16 v[120:123], v[88:91], v[36:39], v[120:123]
    buffer_load_dwordx4 a[116:119], v3, s[84:87], s83 offen sc1
    v_pk_add_f32 v[14:15], v[14:15], v[146:147]
    v_mfma_f32_16x16x32_bf16 v[116:119], v[80:83], v[40:43], v[116:119]
    ds_write_b128 v189, v[112:115] offset:26752
    v_cvt_pk_bf16_f32 v8, v8, v9
    v_mfma_f32_16x16x32_bf16 v[120:123], v[84:87], v[40:43], v[120:123]
    s_add_u32 s83, s80, 843776
    ds_read2_b64 v[32:35], v184 offset0:90 offset1:91
    ds_read_b64_tr_b16 v[68:69], v185 offset:35424
    ds_read_b64_tr_b16 v[70:71], v185 offset:35456
    v_cvt_pk_bf16_f32 v9, v10, v11
    v_mfma_f32_16x16x32_bf16 v[116:119], v[76:79], v[44:47], v[116:119]
    buffer_load_dwordx4 a[120:123], v3, s[84:87], s83 offen sc1
    v_cvt_pk_bf16_f32 v10, v12, v13
    v_mfma_f32_16x16x32_bf16 v[120:123], v[80:83], v[44:47], v[120:123]
    v_cvt_pk_bf16_f32 v11, v14, v15
    v_mfma_f32_16x16x32_bf16 v[116:119], v[72:75], v[48:51], v[116:119]
    s_add_u32 s83, s80, 864256
    buffer_store_dwordx4 v[8:11], v193, s[16:19], s67 offen sc1
    v_mfma_f32_16x16x32_bf16 v[120:123], v[76:79], v[48:51], v[120:123]
    s_waitcnt lgkmcnt(0)
    ds_read_b64_tr_b16 v[72:73], v185 offset:35552
    ds_read_b64_tr_b16 v[74:75], v185 offset:35584
    buffer_load_dwordx4 a[124:127], v3, s[84:87], s83 offen sc1
    v_mfma_f32_16x16x32_bf16 v[96:99], v[68:71], v[32:35], 0
    s_waitcnt lgkmcnt(0)
    ds_read_b64_tr_b16 v[76:77], v185 offset:35680
    ds_read_b64_tr_b16 v[78:79], v185 offset:35712
    ds_read2_b64 v[36:39], v184 offset0:86 offset1:87
    ds_read_b64_tr_b16 v[64:65], v185 offset:35296
    ds_read_b64_tr_b16 v[66:67], v185 offset:35328
    buffer_store_dwordx4 a[8:11], v3, s[84:87], s39 offen sc1
    s_add_u32 s39, s39, 55296
    v_mfma_f32_16x16x32_bf16 v[100:103], v[72:75], v[32:35], 0
    s_waitcnt lgkmcnt(3)
    ds_read2_b64 v[40:43], v184 offset0:82 offset1:83
    ds_read_b64_tr_b16 v[60:61], v185 offset:35168
    ds_read_b64_tr_b16 v[62:63], v185 offset:35200
    v_mfma_f32_16x16x32_bf16 v[104:107], v[76:79], v[32:35], 0
    s_waitcnt lgkmcnt(3)
    s_add_u32 s83, s80, 884736
    buffer_load_dwordx4 a[128:131], v3, s[84:87], s83 offen sc1
    v_mfma_f32_16x16x32_bf16 v[96:99], v[64:67], v[36:39], v[96:99]
    ds_write_b128 v189, v[116:119] offset:26880
    v_mfma_f32_16x16x32_bf16 v[100:103], v[68:71], v[36:39], v[100:103]
    s_add_u32 s83, s80, 905216
    ds_read2_b64 v[44:47], v184 offset0:78 offset1:79
    ds_read_b64_tr_b16 v[56:57], v185 offset:35040
    ds_read_b64_tr_b16 v[58:59], v185 offset:35072
    ds_write_b128 v189, v[120:123] offset:27008
    v_mfma_f32_16x16x32_bf16 v[104:107], v[72:75], v[36:39], v[104:107]
    s_waitcnt lgkmcnt(5)
    buffer_load_dwordx4 a[132:135], v3, s[84:87], s83 offen sc1
    v_mfma_f32_16x16x32_bf16 v[96:99], v[60:63], v[40:43], v[96:99]
    ds_read2_b64 v[48:51], v184 offset0:74 offset1:75
    ds_read_b64_tr_b16 v[52:53], v185 offset:34912
    v_mfma_f32_16x16x32_bf16 v[100:103], v[64:67], v[40:43], v[100:103]
    s_waitcnt lgkmcnt(2)
    ds_read_b64_tr_b16 v[54:55], v185 offset:34944
    ds_read_b64_tr_b16 v[80:81], v185 offset:35808
    s_mov_b32 s89, 0x40000
    s_waitcnt vmcnt(14)
mk_fp47:
    v_xor_b32 v232, s88, v232
    v_xor_b32 v233, s88, v233
    v_xor_b32 v234, s88, v234
    v_xor_b32 v235, s88, v235
    v_or3_b32 v232, v232, v233, v234
    v_or_b32 v232, v232, v235
    v_cmp_ne_u32 vcc, 0, v232
    s_cbranch_vccz mk_fpd48
    buffer_load_dwordx4 v[232:235], v223, s[92:95], 0 offen sc1
    s_sub_u32 s89, s89, 1
    s_cmp_lg_u32 s89, 0
    s_waitcnt vmcnt(0)
    s_cbranch_scc1 mk_fp47
mk_fpd48:
    s_barrier
    v_mfma_f32_16x16x32_bf16 v[104:107], v[68:71], v[40:43], v[104:107]
    ds_read_b128 v[124:127], v191 offset:26240
    ds_read_b128 v[128:131], v191 offset:30592
    v_mfma_f32_16x16x32_bf16 v[96:99], v[56:59], v[44:47], v[96:99]
    s_add_u32 s83, s81, 0
    ds_read_b128 v[132:135], v192 offset:34432
    ds_read_b128 v[136:139], v192 offset:38080
    v_mfma_f32_16x16x32_bf16 v[100:103], v[60:63], v[44:47], v[100:103]
    ds_read_b64_tr_b16 v[82:83], v185 offset:35840
    buffer_load_dwordx4 v[212:215], v206, s[84:87], s83 offen offset:0 sc1
    buffer_store_dwordx4 a[12:15], v3, s[84:87], s39 offen sc1
    ds_read_b128 v[140:143], v192 offset:41216
    ds_read_b128 v[144:147], v192 offset:44288
    v_mfma_f32_16x16x32_bf16 v[104:107], v[64:67], v[44:47], v[104:107]
    s_waitcnt lgkmcnt(8)
    ds_read_b64_tr_b16 v[84:85], v185 offset:35936
    ds_read_b64_tr_b16 v[86:87], v185 offset:35968
    v_mfma_f32_16x16x32_bf16 v[96:99], v[52:55], v[48:51], v[96:99]
    s_add_u32 s83, s81, 512
    buffer_load_dwordx4 v[216:219], v206, s[84:87], s83 offen offset:0 sc1
    v_mfma_f32_16x16x32_bf16 v[100:103], v[56:59], v[48:51], v[100:103]
    ds_read_b64_tr_b16 v[88:89], v185 offset:36064
    ds_read_b64_tr_b16 v[90:91], v185 offset:36096
    v_mfma_f32_16x16x32_bf16 v[104:107], v[60:63], v[48:51], v[104:107]
    s_waitcnt lgkmcnt(6)
    s_add_u32 s83, s81, 1024
    ds_read_b64_tr_b16 v[92:93], v185 offset:36192
    v_mfma_f32_16x16x32_bf16 v[108:111], v[80:83], v[32:35], 0
    s_waitcnt lgkmcnt(3)
    buffer_load_dwordx4 v[220:223], v206, s[84:87], s83 offen offset:0 sc1
    v_mfma_f32_16x16x32_bf16 v[112:115], v[84:87], v[32:35], 0
    ds_write_b128 v189, v[96:99] offset:0
    v_mfma_f32_16x16x32_bf16 v[108:111], v[76:79], v[36:39], v[108:111]
    ds_write_b128 v189, v[100:103] offset:128
    v_pk_add_f32 v[16:17], v[16:17], v[124:125]
    v_mfma_f32_16x16x32_bf16 v[112:115], v[80:83], v[36:39], v[112:115]
    s_add_u32 s83, s81, 1536
    buffer_load_dwordx4 v[224:227], v206, s[84:87], s83 offen offset:0 sc1
    v_pk_add_f32 v[18:19], v[18:19], v[126:127]
    v_mfma_f32_16x16x32_bf16 v[108:111], v[72:75], v[40:43], v[108:111]
    ds_write_b128 v189, v[104:107] offset:256
    v_pk_add_f32 v[20:21], v[20:21], v[128:129]
    v_mfma_f32_16x16x32_bf16 v[112:115], v[76:79], v[40:43], v[112:115]
    ds_read_b64_tr_b16 v[94:95], v185 offset:36224
    v_pk_add_f32 v[22:23], v[22:23], v[130:131]
    v_mfma_f32_16x16x32_bf16 v[108:111], v[68:71], v[44:47], v[108:111]
    s_add_u32 s83, s81, 2048
    buffer_load_dwordx4 v[228:231], v206, s[84:87], s83 offen offset:0 sc1
    v_pk_add_f32 v[16:17], v[16:17], v[132:133]
    v_mfma_f32_16x16x32_bf16 v[112:115], v[72:75], v[44:47], v[112:115]
    v_pk_add_f32 v[18:19], v[18:19], v[134:135]
    v_pk_add_f32 v[20:21], v[20:21], v[136:137]
    v_mfma_f32_16x16x32_bf16 v[108:111], v[64:67], v[48:51], v[108:111]
    v_pk_add_f32 v[22:23], v[22:23], v[138:139]
    v_pk_add_f32 v[16:17], v[16:17], v[140:141]
    v_mfma_f32_16x16x32_bf16 v[112:115], v[68:71], v[48:51], v[112:115]
    s_waitcnt lgkmcnt(5)
    s_add_u32 s83, s81, 2560
    v_pk_add_f32 v[18:19], v[18:19], v[142:143]
    v_mfma_f32_16x16x32_bf16 v[116:119], v[88:91], v[32:35], 0
    s_waitcnt lgkmcnt(0)
    buffer_load_dwordx4 v[232:235], v206, s[84:87], s83 offen offset:0 sc1
    v_mfma_f32_16x16x32_bf16 v[120:123], v[92:95], v[32:35], 0
    ds_write_b128 v189, v[108:111] offset:384
    v_mfma_f32_16x16x32_bf16 v[116:119], v[84:87], v[36:39], v[116:119]
    ds_write_b128 v189, v[112:115] offset:512
    v_pk_add_f32 v[20:21], v[20:21], v[144:145]
    v_mfma_f32_16x16x32_bf16 v[120:123], v[88:91], v[36:39], v[120:123]
    v_pk_add_f32 v[22:23], v[22:23], v[146:147]
    v_cvt_pk_bf16_f32 v16, v16, v17
    v_mfma_f32_16x16x32_bf16 v[116:119], v[80:83], v[40:43], v[116:119]
    v_cvt_pk_bf16_f32 v17, v18, v19
    v_cvt_pk_bf16_f32 v18, v20, v21
    v_mfma_f32_16x16x32_bf16 v[120:123], v[84:87], v[40:43], v[120:123]
    v_cvt_pk_bf16_f32 v19, v22, v23
    v_mfma_f32_16x16x32_bf16 v[116:119], v[76:79], v[44:47], v[116:119]
    buffer_store_dwordx4 v[16:19], v193, s[16:19], s68 offen sc1
    v_mfma_f32_16x16x32_bf16 v[120:123], v[80:83], v[44:47], v[120:123]
    v_mfma_f32_16x16x32_bf16 v[116:119], v[72:75], v[48:51], v[116:119]
    v_mfma_f32_16x16x32_bf16 v[120:123], v[76:79], v[48:51], v[120:123]
    s_nop 6
    ds_write_b128 v189, v[116:119] offset:640
    ds_write_b128 v189, v[120:123] offset:768
    s_waitcnt vmcnt(6)
    s_waitcnt lgkmcnt(0)
    s_barrier
    ds_read_b128 v[124:127], v191 offset:0
    ds_read_b128 v[128:131], v191 offset:4352
    ds_read_b128 v[132:135], v192 offset:8192
    ds_read_b128 v[136:139], v192 offset:11840
    ds_read_b128 v[140:143], v192 offset:14976
    ds_read_b128 v[144:147], v192 offset:18048
    s_lshl_b32 s29, s3, 8
    s_lshl_b32 s28, s60, 5
    s_add_u32 s29, s29, s28
    s_add_u32 s29, s29, s61
    s_waitcnt lgkmcnt(4)
    v_pk_add_f32 v[24:25], v[24:25], v[124:125]
    v_pk_add_f32 v[26:27], v[26:27], v[126:127]
    v_pk_add_f32 v[28:29], v[28:29], v[128:129]
    v_pk_add_f32 v[30:31], v[30:31], v[130:131]
    s_waitcnt lgkmcnt(2)
    v_pk_add_f32 v[24:25], v[24:25], v[132:133]
    v_pk_add_f32 v[26:27], v[26:27], v[134:135]
    v_pk_add_f32 v[28:29], v[28:29], v[136:137]
    v_pk_add_f32 v[30:31], v[30:31], v[138:139]
    s_waitcnt lgkmcnt(0)
    v_pk_add_f32 v[24:25], v[24:25], v[140:141]
    v_pk_add_f32 v[26:27], v[26:27], v[142:143]
    v_pk_add_f32 v[28:29], v[28:29], v[144:145]
    v_pk_add_f32 v[30:31], v[30:31], v[146:147]
    v_cvt_pk_bf16_f32 v24, v24, v25
    v_cvt_pk_bf16_f32 v25, v26, v27
    v_cvt_pk_bf16_f32 v26, v28, v29
    v_cvt_pk_bf16_f32 v27, v30, v31
    buffer_store_dwordx4 v[24:27], v193, s[16:19], s69 offen sc1
    s_branch mk_cj40
mk_cln45:
    s_waitcnt lgkmcnt(0)
    s_barrier
    ds_read2_b64 v[32:35], v183 offset0:90 offset1:91
    ds_read_b64_tr_b16 v[68:69], v185 offset:512
    ds_read_b64_tr_b16 v[70:71], v185 offset:544
    ds_read_b64_tr_b16 v[72:73], v185 offset:640
    ds_read_b64_tr_b16 v[74:75], v185 offset:672
    s_add_u32 s83, s80, 86016
    buffer_load_dwordx4 a[232:235], v3, s[84:87], s83 offen sc1
    s_add_u32 s83, s80, 819200
    buffer_load_dwordx4 a[36:39], v3, s[84:87], s83 offen sc1
    s_add_u32 s83, s80, 839680
    buffer_load_dwordx4 a[40:43], v3, s[84:87], s83 offen sc1
    s_add_u32 s83, s80, 860160
    buffer_load_dwordx4 a[44:47], v3, s[84:87], s83 offen sc1
    s_add_u32 s83, s80, 880640
    buffer_load_dwordx4 a[48:51], v3, s[84:87], s83 offen sc1
    s_add_u32 s83, s80, 901120
    buffer_load_dwordx4 a[52:55], v3, s[84:87], s83 offen sc1
    s_add_u32 s83, s80, 820224
    buffer_load_dwordx4 a[56:59], v3, s[84:87], s83 offen sc1
    s_add_u32 s83, s80, 840704
    buffer_load_dwordx4 a[60:63], v3, s[84:87], s83 offen sc1
    s_add_u32 s83, s80, 861184
    buffer_load_dwordx4 a[64:67], v3, s[84:87], s83 offen sc1
    s_add_u32 s83, s80, 881664
    buffer_load_dwordx4 a[68:71], v3, s[84:87], s83 offen sc1
    s_add_u32 s83, s80, 902144
    buffer_load_dwordx4 a[72:75], v3, s[84:87], s83 offen sc1
    s_add_u32 s83, s80, 821248
    buffer_load_dwordx4 a[76:79], v3, s[84:87], s83 offen sc1
    s_waitcnt lgkmcnt(0)
    s_branch mk_ck46
mk_cp037:
    s_cmp_lg_u32 s63, 0
    s_cbranch_scc1 mk_cln49
    s_waitcnt lgkmcnt(0)
    s_barrier
    ds_read2_b64 v[32:35], v182 offset0:178 offset1:179
    ds_read_b64_tr_b16 v[72:73], v188 offset:1536
    ds_read_b64_tr_b16 v[74:75], v188 offset:1664
    ds_read_b64_tr_b16 v[60:61], v188 offset:1024
    ds_read_b64_tr_b16 v[62:63], v188 offset:1152
    ds_read2_b64 v[44:47], v182 offset0:174 offset1:175
    ds_read_b64_tr_b16 v[48:49], v188 offset:512
    ds_read_b64_tr_b16 v[50:51], v188 offset:640
    ds_read2_b64 v[56:59], v182 offset0:170 offset1:171
    ds_read_b64_tr_b16 v[36:37], v188 offset:0
    ds_read_b64_tr_b16 v[38:39], v188 offset:128
    ds_read2_b64 v[68:71], v182 offset0:166 offset1:167
    ds_read2_b64 v[80:83], v182 offset0:134 offset1:135
    ds_read_b64_tr_b16 v[116:117], v187 offset:1024
    ds_read_b64_tr_b16 v[118:119], v187 offset:1088
    ds_read_b64_tr_b16 v[120:121], v187 offset:1280
    ds_read_b64_tr_b16 v[122:123], v187 offset:1344
    ds_read2_b64 v[84:87], v182 offset0:130 offset1:131
    ds_read_b64_tr_b16 v[112:113], v187 offset:768
    ds_read_b64_tr_b16 v[114:115], v187 offset:832
    ds_read2_b64 v[88:91], v182 offset0:126 offset1:127
    ds_read_b64_tr_b16 v[108:109], v187 offset:512
    ds_read_b64_tr_b16 v[110:111], v187 offset:576
    s_waitcnt lgkmcnt(15)
    v_mfma_f32_16x16x32_bf16 v[76:79], v[72:75], v[32:35], 0
    s_add_u32 s83, s80, 86016
    buffer_load_dwordx4 a[232:235], v3, s[84:87], s83 offen sc1
    v_mfma_f32_16x16x32_bf16 v[64:67], v[60:63], v[32:35], 0
    v_mfma_f32_16x16x32_bf16 v[76:79], v[60:63], v[44:47], v[76:79]
    ds_read2_b64 v[92:95], v182 offset0:122 offset1:123
    ds_read_b64_tr_b16 v[104:105], v187 offset:256
    v_mfma_f32_16x16x32_bf16 v[64:67], v[48:51], v[44:47], v[64:67]
    ds_read_b64_tr_b16 v[106:107], v187 offset:320
    v_mfma_f32_16x16x32_bf16 v[52:55], v[48:51], v[32:35], 0
    s_waitcnt lgkmcnt(15)
    s_add_u32 s83, s80, 819200
    ds_read2_b64 v[96:99], v182 offset0:118 offset1:119
    v_mfma_f32_16x16x32_bf16 v[76:79], v[48:51], v[56:59], v[76:79]
    buffer_load_dwordx4 a[36:39], v3, s[84:87], s83 offen sc1
    v_mfma_f32_16x16x32_bf16 v[64:67], v[36:39], v[56:59], v[64:67]
    ds_read_b64_tr_b16 v[100:101], v187 offset:0
    ds_read_b64_tr_b16 v[102:103], v187 offset:64
    v_mfma_f32_16x16x32_bf16 v[52:55], v[36:39], v[44:47], v[52:55]
    s_waitcnt lgkmcnt(15)
    s_add_u32 s83, s80, 839680
    ds_read_b64_tr_b16 v[124:125], v187 offset:1536
    v_mfma_f32_16x16x32_bf16 v[76:79], v[36:39], v[68:71], v[76:79]
    buffer_load_dwordx4 a[40:43], v3, s[84:87], s83 offen sc1
    v_mfma_f32_16x16x32_bf16 v[40:43], v[36:39], v[32:35], 0
    s_waitcnt lgkmcnt(15)
    ds_write_b128 v190, v[64:67] offset:1024
    v_mfma_f32_16x16x32_bf16 v[140:143], v[116:119], v[80:83], 0
    s_waitcnt lgkmcnt(14)
    ds_write_b128 v190, v[52:55] offset:512
    v_mfma_f32_16x16x32_bf16 v[144:147], v[120:123], v[80:83], 0
    s_waitcnt lgkmcnt(12)
    s_add_u32 s83, s80, 860160
    ds_read_b64_tr_b16 v[126:127], v187 offset:1600
    v_mfma_f32_16x16x32_bf16 v[140:143], v[112:115], v[84:87], v[140:143]
    buffer_load_dwordx4 a[44:47], v3, s[84:87], s83 offen sc1
    v_mfma_f32_16x16x32_bf16 v[144:147], v[116:119], v[84:87], v[144:147]
    s_waitcnt lgkmcnt(10)
    ds_write_b128 v190, v[76:79] offset:1536
    v_mfma_f32_16x16x32_bf16 v[140:143], v[108:111], v[88:91], v[140:143]
    s_add_u32 s83, s80, 880640
    ds_write_b128 v190, v[40:43] offset:0
    v_mfma_f32_16x16x32_bf16 v[144:147], v[112:115], v[88:91], v[144:147]
    s_waitcnt lgkmcnt(9)
    buffer_load_dwordx4 a[48:51], v3, s[84:87], s83 offen sc1
    v_mfma_f32_16x16x32_bf16 v[140:143], v[104:107], v[92:95], v[140:143]
    ds_read_b64_tr_b16 v[128:129], v187 offset:1792
    ds_read_b64_tr_b16 v[130:131], v187 offset:1856
    v_mfma_f32_16x16x32_bf16 v[144:147], v[108:111], v[92:95], v[144:147]
    s_waitcnt lgkmcnt(8)
    ds_read_b64_tr_b16 v[132:133], v187 offset:2048
    ds_read_b64_tr_b16 v[134:135], v187 offset:2112
    v_mfma_f32_16x16x32_bf16 v[140:143], v[100:103], v[96:99], v[140:143]
    s_add_u32 s83, s80, 901120
    buffer_load_dwordx4 a[52:55], v3, s[84:87], s83 offen sc1
    v_mfma_f32_16x16x32_bf16 v[144:147], v[104:107], v[96:99], v[144:147]
    s_waitcnt lgkmcnt(6)
    ds_read_b64_tr_b16 v[136:137], v187 offset:2304
    ds_read_b64_tr_b16 v[138:139], v187 offset:2368
    v_mfma_f32_16x16x32_bf16 v[148:151], v[124:127], v[80:83], 0
    s_waitcnt lgkmcnt(4)
    v_mfma_f32_16x16x32_bf16 v[152:155], v[128:131], v[80:83], 0
    s_add_u32 s83, s80, 820224
    buffer_load_dwordx4 a[56:59], v3, s[84:87], s83 offen sc1
    v_mfma_f32_16x16x32_bf16 v[148:151], v[120:123], v[84:87], v[148:151]
    ds_write_b128 v189, v[140:143] offset:0
    v_mfma_f32_16x16x32_bf16 v[152:155], v[124:127], v[84:87], v[152:155]
    ds_write_b128 v189, v[144:147] offset:256
    v_mfma_f32_16x16x32_bf16 v[148:151], v[116:119], v[88:91], v[148:151]
    v_mfma_f32_16x16x32_bf16 v[152:155], v[120:123], v[88:91], v[152:155]
    s_add_u32 s83, s80, 840704
    buffer_load_dwordx4 a[60:63], v3, s[84:87], s83 offen sc1
    v_mfma_f32_16x16x32_bf16 v[148:151], v[112:115], v[92:95], v[148:151]
    ds_read2_b64 v[32:35], v183 offset0:178 offset1:179
    ds_read_b64_tr_b16 v[72:73], v186 offset:1536
    v_mfma_f32_16x16x32_bf16 v[152:155], v[116:119], v[92:95], v[152:155]
    ds_read_b64_tr_b16 v[74:75], v186 offset:1664
    ds_read_b64_tr_b16 v[60:61], v186 offset:1024
    v_mfma_f32_16x16x32_bf16 v[148:151], v[108:111], v[96:99], v[148:151]
    s_add_u32 s83, s80, 861184
    buffer_load_dwordx4 a[64:67], v3, s[84:87], s83 offen sc1
    v_mfma_f32_16x16x32_bf16 v[152:155], v[112:115], v[96:99], v[152:155]
    s_waitcnt lgkmcnt(8)
    ds_read_b64_tr_b16 v[62:63], v186 offset:1152
    ds_read2_b64 v[44:47], v183 offset0:174 offset1:175
    v_mfma_f32_16x16x32_bf16 v[156:159], v[132:135], v[80:83], 0
    s_waitcnt lgkmcnt(8)
    ds_read_b64_tr_b16 v[48:49], v186 offset:512
    ds_read_b64_tr_b16 v[50:51], v186 offset:640
    v_mfma_f32_16x16x32_bf16 v[160:163], v[136:139], v[80:83], 0
    ds_write_b128 v189, v[148:151] offset:512
    v_mfma_f32_16x16x32_bf16 v[156:159], v[128:131], v[84:87], v[156:159]
    s_add_u32 s83, s80, 881664
    buffer_load_dwordx4 a[68:71], v3, s[84:87], s83 offen sc1
    v_mfma_f32_16x16x32_bf16 v[160:163], v[132:135], v[84:87], v[160:163]
    ds_write_b128 v189, v[152:155] offset:768
    v_mfma_f32_16x16x32_bf16 v[156:159], v[124:127], v[88:91], v[156:159]
    ds_read2_b64 v[56:59], v183 offset0:170 offset1:171
    ds_read_b64_tr_b16 v[36:37], v186 offset:0
    v_mfma_f32_16x16x32_bf16 v[160:163], v[128:131], v[88:91], v[160:163]
    s_add_u32 s83, s80, 902144
    buffer_load_dwordx4 a[72:75], v3, s[84:87], s83 offen sc1
    v_mfma_f32_16x16x32_bf16 v[156:159], v[120:123], v[92:95], v[156:159]
    ds_read_b64_tr_b16 v[38:39], v186 offset:128
    ds_read2_b64 v[68:71], v183 offset0:166 offset1:167
    v_mfma_f32_16x16x32_bf16 v[160:163], v[124:127], v[92:95], v[160:163]
    ds_read2_b64 v[80:83], v183 offset0:134 offset1:135
    v_mfma_f32_16x16x32_bf16 v[156:159], v[116:119], v[96:99], v[156:159]
    s_add_u32 s83, s80, 821248
    buffer_load_dwordx4 a[76:79], v3, s[84:87], s83 offen sc1
    v_mfma_f32_16x16x32_bf16 v[160:163], v[120:123], v[96:99], v[160:163]
    s_waitcnt lgkmcnt(12)
    ds_read_b64_tr_b16 v[116:117], v185 offset:1024
    ds_read_b64_tr_b16 v[118:119], v185 offset:1088
mk_ck50:
    v_mfma_f32_16x16x32_bf16 v[76:79], v[72:75], v[32:35], 0
    s_waitcnt lgkmcnt(12)
    s_add_u32 s83, s80, 841728
    ds_read_b64_tr_b16 v[120:121], v185 offset:1280
    v_mfma_f32_16x16x32_bf16 v[64:67], v[60:63], v[32:35], 0
    s_waitcnt lgkmcnt(12)
    buffer_load_dwordx4 a[80:83], v3, s[84:87], s83 offen sc1
    v_mfma_f32_16x16x32_bf16 v[76:79], v[60:63], v[44:47], v[76:79]
    s_waitcnt lgkmcnt(10)
    ds_write_b128 v189, v[156:159] offset:1024
    v_mfma_f32_16x16x32_bf16 v[64:67], v[48:51], v[44:47], v[64:67]
    ds_write_b128 v189, v[160:163] offset:1280
    v_mfma_f32_16x16x32_bf16 v[52:55], v[48:51], v[32:35], 0
    s_waitcnt lgkmcnt(9)
    s_add_u32 s83, s80, 862208
    ds_read_b64_tr_b16 v[122:123], v185 offset:1344
    v_mfma_f32_16x16x32_bf16 v[76:79], v[48:51], v[56:59], v[76:79]
    s_waitcnt lgkmcnt(8)
    buffer_load_dwordx4 a[84:87], v3, s[84:87], s83 offen sc1
    v_mfma_f32_16x16x32_bf16 v[64:67], v[36:39], v[56:59], v[64:67]
    ds_read2_b64 v[84:87], v183 offset0:130 offset1:131
    ds_read_b64_tr_b16 v[112:113], v185 offset:768
    v_mfma_f32_16x16x32_bf16 v[52:55], v[36:39], v[44:47], v[52:55]
    s_waitcnt lgkmcnt(9)
    ds_read_b64_tr_b16 v[114:115], v185 offset:832
    ds_read2_b64 v[88:91], v183 offset0:126 offset1:127
    s_waitcnt lgkmcnt(5)
    s_barrier
    v_mfma_f32_16x16x32_bf16 v[76:79], v[36:39], v[68:71], v[76:79]
    s_add_u32 s83, s80, 882688
    ds_read_b128 v[164:167], v191 offset:0
    ds_read_b128 v[168:171], v191 offset:4352
    v_mfma_f32_16x16x32_bf16 v[40:43], v[36:39], v[32:35], 0
    buffer_load_dwordx4 a[88:91], v3, s[84:87], s83 offen sc1
    ds_read_b64_tr_b16 v[108:109], v185 offset:512
    ds_read_b64_tr_b16 v[110:111], v185 offset:576
    ds_read_b128 v[172:175], v192 offset:8192
    ds_read_b128 v[176:179], v192 offset:11840
    v_mfma_f32_16x16x32_bf16 v[140:143], v[116:119], v[80:83], 0
    s_waitcnt lgkmcnt(10)
    ds_read2_b64 v[92:95], v183 offset0:122 offset1:123
    ds_read_b64_tr_b16 v[104:105], v185 offset:256
    v_mfma_f32_16x16x32_bf16 v[144:147], v[120:123], v[80:83], 0
    s_waitcnt lgkmcnt(9)
    ds_read_b64_tr_b16 v[106:107], v185 offset:320
    ds_write_b128 v190, v[64:67] offset:27264
    v_mfma_f32_16x16x32_bf16 v[140:143], v[112:115], v[84:87], v[140:143]
    s_add_u32 s83, s80, 903168
    buffer_load_dwordx4 v[232:235], v223, s[92:95], 0 offen sc1
    ds_write_b128 v190, v[52:55] offset:26752
    v_mfma_f32_16x16x32_bf16 v[144:147], v[116:119], v[84:87], v[144:147]
    s_waitcnt lgkmcnt(7)
    buffer_load_dwordx4 a[92:95], v3, s[84:87], s83 offen sc1
    ds_read2_b64 v[96:99], v183 offset0:118 offset1:119
    ds_read_b64_tr_b16 v[100:101], v185 offset:0
    ds_read_b64_tr_b16 v[102:103], v185 offset:64
    ds_write_b128 v190, v[76:79] offset:27776
    v_mfma_f32_16x16x32_bf16 v[140:143], v[108:111], v[88:91], v[140:143]
    s_add_u32 s83, s80, 822272
    ds_write_b128 v190, v[40:43] offset:26240
    v_mfma_f32_16x16x32_bf16 v[144:147], v[112:115], v[88:91], v[144:147]
    s_waitcnt lgkmcnt(7)
    ds_read_b64_tr_b16 v[124:125], v185 offset:1536
    ds_read_b64_tr_b16 v[126:127], v185 offset:1600
    buffer_store_dwordx4 a[0:3], v3, s[84:87], s39 offen sc1
    s_add_u32 s39, s39, 55296
    v_mfma_f32_16x16x32_bf16 v[140:143], v[104:107], v[92:95], v[140:143]
    buffer_load_dwordx4 a[96:99], v3, s[84:87], s83 offen sc1
    ds_read_b64_tr_b16 v[128:129], v185 offset:1792
    ds_read_b64_tr_b16 v[130:131], v185 offset:1856
    v_mfma_f32_16x16x32_bf16 v[144:147], v[108:111], v[92:95], v[144:147]
    s_waitcnt lgkmcnt(6)
    ds_read_b64_tr_b16 v[132:133], v185 offset:2048
    ds_read_b64_tr_b16 v[134:135], v185 offset:2112
    v_pk_add_f32 v[8:9], v[8:9], v[164:165]
    v_mfma_f32_16x16x32_bf16 v[140:143], v[100:103], v[96:99], v[140:143]
    s_add_u32 s83, s80, 842752
    buffer_load_dwordx4 a[100:103], v3, s[84:87], s83 offen sc1
    v_pk_add_f32 v[10:11], v[10:11], v[166:167]
    v_mfma_f32_16x16x32_bf16 v[144:147], v[104:107], v[96:99], v[144:147]
    s_waitcnt lgkmcnt(4)
    ds_read_b64_tr_b16 v[136:137], v185 offset:2304
    ds_read_b64_tr_b16 v[138:139], v185 offset:2368
    v_pk_add_f32 v[12:13], v[12:13], v[168:169]
    v_mfma_f32_16x16x32_bf16 v[148:151], v[124:127], v[80:83], 0
    s_waitcnt lgkmcnt(4)
    v_pk_add_f32 v[14:15], v[14:15], v[170:171]
    v_mfma_f32_16x16x32_bf16 v[152:155], v[128:131], v[80:83], 0
    s_add_u32 s83, s80, 863232
    buffer_load_dwordx4 a[104:107], v3, s[84:87], s83 offen sc1
    s_mov_b32 exec_lo, 0
    v_pk_add_f32 v[8:9], v[8:9], v[172:173]
    v_pk_add_f32 v[10:11], v[10:11], v[174:175]
    v_pk_add_f32 v[12:13], v[12:13], v[176:177]
    v_pk_add_f32 v[14:15], v[14:15], v[178:179]
    s_mov_b32 exec_lo, -1
    v_mfma_f32_16x16x32_bf16 v[148:151], v[120:123], v[84:87], v[148:151]
    ds_write_b128 v189, v[140:143] offset:26240
    v_mfma_f32_16x16x32_bf16 v[152:155], v[124:127], v[84:87], v[152:155]
    ds_write_b128 v189, v[144:147] offset:26496
    v_mfma_f32_16x16x32_bf16 v[148:151], v[116:119], v[88:91], v[148:151]
    buffer_store_dwordx4 a[4:7], v3, s[84:87], s39 offen sc1
    v_mfma_f32_16x16x32_bf16 v[152:155], v[120:123], v[88:91], v[152:155]
    s_add_u32 s39, s39, 55296
    s_add_u32 s83, s80, 883712
    v_cvt_pk_bf16_f32 v8, v8, v9
    v_mfma_f32_16x16x32_bf16 v[148:151], v[112:115], v[92:95], v[148:151]
    buffer_load_dwordx4 a[108:111], v3, s[84:87], s83 offen sc1
    v_cvt_pk_bf16_f32 v9, v10, v11
    v_mfma_f32_16x16x32_bf16 v[152:155], v[116:119], v[92:95], v[152:155]
    ds_read2_b64 v[32:35], v184 offset0:178 offset1:179
    ds_read_b64_tr_b16 v[72:73], v186 offset:36448
    v_cvt_pk_bf16_f32 v10, v12, v13
    v_mfma_f32_16x16x32_bf16 v[148:151], v[108:111], v[96:99], v[148:151]
    s_add_u32 s83, s80, 904192
    buffer_load_dwordx4 a[112:115], v3, s[84:87], s83 offen sc1
    v_cvt_pk_bf16_f32 v11, v14, v15
    v_mfma_f32_16x16x32_bf16 v[152:155], v[112:115], v[96:99], v[152:155]
    s_waitcnt lgkmcnt(6)
    buffer_store_dwordx4 v[8:11], v193, s[16:19], s67 offen sc1
    v_mfma_f32_16x16x32_bf16 v[156:159], v[132:135], v[80:83], 0
    s_waitcnt lgkmcnt(4)
    ds_read_b64_tr_b16 v[74:75], v186 offset:36576
    ds_read_b64_tr_b16 v[60:61], v186 offset:35936
    v_mfma_f32_16x16x32_bf16 v[160:163], v[136:139], v[80:83], 0
    ds_write_b128 v189, v[148:151] offset:26752
    v_mfma_f32_16x16x32_bf16 v[156:159], v[128:131], v[84:87], v[156:159]
    s_add_u32 s83, s80, 823296
    buffer_load_dwordx4 a[116:119], v3, s[84:87], s83 offen sc1
    v_mfma_f32_16x16x32_bf16 v[160:163], v[132:135], v[84:87], v[160:163]
    ds_write_b128 v189, v[152:155] offset:27008
    v_mfma_f32_16x16x32_bf16 v[156:159], v[124:127], v[88:91], v[156:159]
    buffer_store_dwordx4 a[8:11], v3, s[84:87], s39 offen sc1
    v_mfma_f32_16x16x32_bf16 v[160:163], v[128:131], v[88:91], v[160:163]
    s_add_u32 s39, s39, 55296
    s_add_u32 s83, s80, 843776
    ds_read_b64_tr_b16 v[62:63], v186 offset:36064
    v_mfma_f32_16x16x32_bf16 v[156:159], v[120:123], v[92:95], v[156:159]
    buffer_load_dwordx4 a[120:123], v3, s[84:87], s83 offen sc1
    v_mfma_f32_16x16x32_bf16 v[160:163], v[124:127], v[92:95], v[160:163]
    ds_read2_b64 v[44:47], v184 offset0:174 offset1:175
    ds_read_b64_tr_b16 v[48:49], v186 offset:35424
    v_mfma_f32_16x16x32_bf16 v[156:159], v[116:119], v[96:99], v[156:159]
    s_add_u32 s83, s80, 864256
    ds_read_b64_tr_b16 v[50:51], v186 offset:35552
    ds_read2_b64 v[56:59], v184 offset0:170 offset1:171
    v_mfma_f32_16x16x32_bf16 v[160:163], v[120:123], v[96:99], v[160:163]
    s_waitcnt lgkmcnt(8)
    buffer_load_dwordx4 a[124:127], v3, s[84:87], s83 offen sc1
    v_mfma_f32_16x16x32_bf16 v[76:79], v[72:75], v[32:35], 0
    s_waitcnt lgkmcnt(4)
    ds_read_b64_tr_b16 v[36:37], v186 offset:34912
    ds_read_b64_tr_b16 v[38:39], v186 offset:35040
    v_mfma_f32_16x16x32_bf16 v[64:67], v[60:63], v[32:35], 0
    s_waitcnt lgkmcnt(5)
    s_add_u32 s83, s80, 884736
    ds_read2_b64 v[68:71], v184 offset0:166 offset1:167
    v_mfma_f32_16x16x32_bf16 v[76:79], v[60:63], v[44:47], v[76:79]
    s_waitcnt lgkmcnt(4)
    buffer_load_dwordx4 a[128:131], v3, s[84:87], s83 offen sc1
    v_mfma_f32_16x16x32_bf16 v[64:67], v[48:51], v[44:47], v[64:67]
    ds_write_b128 v189, v[156:159] offset:27264
    v_mfma_f32_16x16x32_bf16 v[52:55], v[48:51], v[32:35], 0
    s_waitcnt lgkmcnt(4)
    ds_write_b128 v189, v[160:163] offset:27520
    v_mfma_f32_16x16x32_bf16 v[76:79], v[48:51], v[56:59], v[76:79]
    s_waitcnt lgkmcnt(3)
    ds_read2_b64 v[80:83], v184 offset0:134 offset1:135
    ds_read_b64_tr_b16 v[116:117], v185 offset:35936
    ds_read_b64_tr_b16 v[118:119], v185 offset:36000
    buffer_store_dwordx4 a[12:15], v3, s[84:87], s39 offen sc1
    v_mfma_f32_16x16x32_bf16 v[64:67], v[36:39], v[56:59], v[64:67]
    s_add_u32 s83, s80, 905216
    buffer_load_dwordx4 a[132:135], v3, s[84:87], s83 offen sc1
    ds_read_b64_tr_b16 v[120:121], v185 offset:36192
    ds_read_b64_tr_b16 v[122:123], v185 offset:36256
    v_mfma_f32_16x16x32_bf16 v[52:55], v[36:39], v[44:47], v[52:55]
    s_waitcnt lgkmcnt(7)
    ds_read2_b64 v[84:87], v184 offset0:130 offset1:131
    ds_read_b64_tr_b16 v[112:113], v185 offset:35680
    ds_read_b64_tr_b16 v[114:115], v185 offset:35744
    s_waitcnt lgkmcnt(8)
    s_mov_b32 s89, 0x40000
    s_waitcnt vmcnt(16)
mk_fp51:
    v_xor_b32 v232, s88, v232
    v_xor_b32 v233, s88, v233
    v_xor_b32 v234, s88, v234
    v_xor_b32 v235, s88, v235
    v_or3_b32 v232, v232, v233, v234
    v_or_b32 v232, v232, v235
    v_cmp_ne_u32 vcc, 0, v232
    s_cbranch_vccz mk_fpd52
    buffer_load_dwordx4 v[232:235], v223, s[92:95], 0 offen sc1
    s_sub_u32 s89, s89, 1
    s_cmp_lg_u32 s89, 0
    s_waitcnt vmcnt(0)
    s_cbranch_scc1 mk_fp51
mk_fpd52:
    s_barrier
    v_mfma_f32_16x16x32_bf16 v[76:79], v[36:39], v[68:71], v[76:79]
    ds_read_b128 v[164:167], v191 offset:26240
    ds_read_b128 v[168:171], v191 offset:30592
    v_mfma_f32_16x16x32_bf16 v[40:43], v[36:39], v[32:35], 0
    s_waitcnt lgkmcnt(7)
    ds_read2_b64 v[88:91], v184 offset0:126 offset1:127
    ds_read_b64_tr_b16 v[108:109], v185 offset:35424
    ds_read_b64_tr_b16 v[110:111], v185 offset:35488
    ds_read_b128 v[172:175], v192 offset:34432
    ds_read_b128 v[176:179], v192 offset:38080
    v_mfma_f32_16x16x32_bf16 v[140:143], v[116:119], v[80:83], 0
    s_waitcnt lgkmcnt(10)
    s_add_u32 s83, s81, 0
    buffer_load_dwordx4 v[212:215], v206, s[84:87], s83 offen offset:0 sc1
    v_mfma_f32_16x16x32_bf16 v[144:147], v[120:123], v[80:83], 0
    s_waitcnt lgkmcnt(7)
    ds_read2_b64 v[92:95], v184 offset0:122 offset1:123
    ds_read_b64_tr_b16 v[104:105], v185 offset:35168
    ds_read_b64_tr_b16 v[106:107], v185 offset:35232
    ds_write_b128 v190, v[64:67] offset:1024
    v_mfma_f32_16x16x32_bf16 v[140:143], v[112:115], v[84:87], v[140:143]
    s_add_u32 s83, s81, 512
    buffer_load_dwordx4 v[216:219], v206, s[84:87], s83 offen offset:0 sc1
    ds_write_b128 v190, v[52:55] offset:512
    v_mfma_f32_16x16x32_bf16 v[144:147], v[116:119], v[84:87], v[144:147]
    s_waitcnt lgkmcnt(7)
    ds_read2_b64 v[96:99], v184 offset0:118 offset1:119
    ds_read_b64_tr_b16 v[100:101], v185 offset:34912
    ds_read_b64_tr_b16 v[102:103], v185 offset:34976
    ds_write_b128 v190, v[76:79] offset:1536
    v_mfma_f32_16x16x32_bf16 v[140:143], v[108:111], v[88:91], v[140:143]
    s_add_u32 s83, s81, 1024
    ds_write_b128 v190, v[40:43] offset:0
    v_mfma_f32_16x16x32_bf16 v[144:147], v[112:115], v[88:91], v[144:147]
    s_waitcnt lgkmcnt(7)
    ds_read_b64_tr_b16 v[124:125], v185 offset:36448
    ds_read_b64_tr_b16 v[126:127], v185 offset:36512
    v_mfma_f32_16x16x32_bf16 v[140:143], v[104:107], v[92:95], v[140:143]
    buffer_load_dwordx4 v[220:223], v206, s[84:87], s83 offen offset:0 sc1
    ds_read_b64_tr_b16 v[128:129], v185 offset:36704
    ds_read_b64_tr_b16 v[130:131], v185 offset:36768
    v_mfma_f32_16x16x32_bf16 v[144:147], v[108:111], v[92:95], v[144:147]
    s_waitcnt lgkmcnt(6)
    ds_read_b64_tr_b16 v[132:133], v185 offset:36960
    ds_read_b64_tr_b16 v[134:135], v185 offset:37024
    v_pk_add_f32 v[16:17], v[16:17], v[164:165]
    v_mfma_f32_16x16x32_bf16 v[140:143], v[100:103], v[96:99], v[140:143]
    s_add_u32 s83, s81, 1536
    buffer_load_dwordx4 v[224:227], v206, s[84:87], s83 offen offset:0 sc1
    v_pk_add_f32 v[18:19], v[18:19], v[166:167]
    v_mfma_f32_16x16x32_bf16 v[144:147], v[104:107], v[96:99], v[144:147]
    s_waitcnt lgkmcnt(4)
    ds_read_b64_tr_b16 v[136:137], v185 offset:37216
    ds_read_b64_tr_b16 v[138:139], v185 offset:37280
    v_pk_add_f32 v[20:21], v[20:21], v[168:169]
    v_mfma_f32_16x16x32_bf16 v[148:151], v[124:127], v[80:83], 0
    s_waitcnt lgkmcnt(4)
    v_pk_add_f32 v[22:23], v[22:23], v[170:171]
    v_mfma_f32_16x16x32_bf16 v[152:155], v[128:131], v[80:83], 0
    s_add_u32 s83, s81, 2048
    buffer_load_dwordx4 v[228:231], v206, s[84:87], s83 offen offset:0 sc1
    s_mov_b32 exec_lo, 0
    v_pk_add_f32 v[16:17], v[16:17], v[172:173]
    v_pk_add_f32 v[18:19], v[18:19], v[174:175]
    v_pk_add_f32 v[20:21], v[20:21], v[176:177]
    v_pk_add_f32 v[22:23], v[22:23], v[178:179]
    s_mov_b32 exec_lo, -1
    v_mfma_f32_16x16x32_bf16 v[148:151], v[120:123], v[84:87], v[148:151]
    ds_write_b128 v189, v[140:143] offset:0
    v_mfma_f32_16x16x32_bf16 v[152:155], v[124:127], v[84:87], v[152:155]
    ds_write_b128 v189, v[144:147] offset:256
    v_mfma_f32_16x16x32_bf16 v[148:151], v[116:119], v[88:91], v[148:151]
    s_add_u32 s83, s81, 2560
    buffer_load_dwordx4 v[232:235], v206, s[84:87], s83 offen offset:0 sc1
    v_mfma_f32_16x16x32_bf16 v[152:155], v[120:123], v[88:91], v[152:155]
    v_cvt_pk_bf16_f32 v16, v16, v17
    v_cvt_pk_bf16_f32 v17, v18, v19
    v_mfma_f32_16x16x32_bf16 v[148:151], v[112:115], v[92:95], v[148:151]
    v_cvt_pk_bf16_f32 v18, v20, v21
    v_cvt_pk_bf16_f32 v19, v22, v23
    v_mfma_f32_16x16x32_bf16 v[152:155], v[116:119], v[92:95], v[152:155]
    buffer_store_dwordx4 v[16:19], v193, s[16:19], s68 offen sc1
    v_mfma_f32_16x16x32_bf16 v[148:151], v[108:111], v[96:99], v[148:151]
    v_mfma_f32_16x16x32_bf16 v[152:155], v[112:115], v[96:99], v[152:155]
    s_waitcnt lgkmcnt(4)
    v_mfma_f32_16x16x32_bf16 v[156:159], v[132:135], v[80:83], 0
    s_waitcnt lgkmcnt(2)
    v_mfma_f32_16x16x32_bf16 v[160:163], v[136:139], v[80:83], 0
    s_nop 2
    ds_write_b128 v189, v[148:151] offset:512
    v_mfma_f32_16x16x32_bf16 v[156:159], v[128:131], v[84:87], v[156:159]
    ds_write_b128 v189, v[152:155] offset:768
    v_mfma_f32_16x16x32_bf16 v[160:163], v[132:135], v[84:87], v[160:163]
    v_mfma_f32_16x16x32_bf16 v[156:159], v[124:127], v[88:91], v[156:159]
    v_mfma_f32_16x16x32_bf16 v[160:163], v[128:131], v[88:91], v[160:163]
    v_mfma_f32_16x16x32_bf16 v[156:159], v[120:123], v[92:95], v[156:159]
    v_mfma_f32_16x16x32_bf16 v[160:163], v[124:127], v[92:95], v[160:163]
    v_mfma_f32_16x16x32_bf16 v[156:159], v[116:119], v[96:99], v[156:159]
    v_mfma_f32_16x16x32_bf16 v[160:163], v[120:123], v[96:99], v[160:163]
    s_nop 6
    ds_write_b128 v189, v[156:159] offset:1024
    ds_write_b128 v189, v[160:163] offset:1280
    s_waitcnt vmcnt(8)
    s_waitcnt lgkmcnt(0)
    s_barrier
    ds_read_b128 v[164:167], v191 offset:0
    ds_read_b128 v[168:171], v191 offset:4352
    ds_read_b128 v[172:175], v192 offset:8192
    ds_read_b128 v[176:179], v192 offset:11840
    s_lshl_b32 s29, s3, 8
    s_lshl_b32 s28, s60, 5
    s_add_u32 s29, s29, s28
    s_add_u32 s29, s29, s61
    s_waitcnt lgkmcnt(2)
    v_pk_add_f32 v[24:25], v[24:25], v[164:165]
    v_pk_add_f32 v[26:27], v[26:27], v[166:167]
    v_pk_add_f32 v[28:29], v[28:29], v[168:169]
    v_pk_add_f32 v[30:31], v[30:31], v[170:171]
    s_waitcnt lgkmcnt(0)
    s_mov_b32 exec_lo, 0
    v_pk_add_f32 v[24:25], v[24:25], v[172:173]
    v_pk_add_f32 v[26:27], v[26:27], v[174:175]
    v_pk_add_f32 v[28:29], v[28:29], v[176:177]
    v_pk_add_f32 v[30:31], v[30:31], v[178:179]
    s_mov_b32 exec_lo, -1
    v_cvt_pk_bf16_f32 v24, v24, v25
    v_cvt_pk_bf16_f32 v25, v26, v27
    v_cvt_pk_bf16_f32 v26, v28, v29
    v_cvt_pk_bf16_f32 v27, v30, v31
    buffer_store_dwordx4 v[24:27], v193, s[16:19], s69 offen sc1
    s_branch mk_cj40
mk_cln49:
    s_waitcnt lgkmcnt(0)
    s_barrier
    ds_read2_b64 v[32:35], v183 offset0:178 offset1:179
    ds_read_b64_tr_b16 v[72:73], v186 offset:1536
    ds_read_b64_tr_b16 v[74:75], v186 offset:1664
    ds_read_b64_tr_b16 v[60:61], v186 offset:1024
    ds_read_b64_tr_b16 v[62:63], v186 offset:1152
    ds_read2_b64 v[44:47], v183 offset0:174 offset1:175
    ds_read_b64_tr_b16 v[48:49], v186 offset:512
    ds_read_b64_tr_b16 v[50:51], v186 offset:640
    ds_read2_b64 v[56:59], v183 offset0:170 offset1:171
    ds_read_b64_tr_b16 v[36:37], v186 offset:0
    ds_read_b64_tr_b16 v[38:39], v186 offset:128
    ds_read2_b64 v[68:71], v183 offset0:166 offset1:167
    ds_read2_b64 v[80:83], v183 offset0:134 offset1:135
    ds_read_b64_tr_b16 v[116:117], v185 offset:1024
    ds_read_b64_tr_b16 v[118:119], v185 offset:1088
    s_add_u32 s83, s80, 86016
    buffer_load_dwordx4 a[232:235], v3, s[84:87], s83 offen sc1
    s_add_u32 s83, s80, 819200
    buffer_load_dwordx4 a[36:39], v3, s[84:87], s83 offen sc1
    s_add_u32 s83, s80, 839680
    buffer_load_dwordx4 a[40:43], v3, s[84:87], s83 offen sc1
    s_add_u32 s83, s80, 860160
    buffer_load_dwordx4 a[44:47], v3, s[84:87], s83 offen sc1
    s_add_u32 s83, s80, 880640
    buffer_load_dwordx4 a[48:51], v3, s[84:87], s83 offen sc1
    s_add_u32 s83, s80, 901120
    buffer_load_dwordx4 a[52:55], v3, s[84:87], s83 offen sc1
    s_add_u32 s83, s80, 820224
    buffer_load_dwordx4 a[56:59], v3, s[84:87], s83 offen sc1
    s_add_u32 s83, s80, 840704
    buffer_load_dwordx4 a[60:63], v3, s[84:87], s83 offen sc1
    s_add_u32 s83, s80, 861184
    buffer_load_dwordx4 a[64:67], v3, s[84:87], s83 offen sc1
    s_add_u32 s83, s80, 881664
    buffer_load_dwordx4 a[68:71], v3, s[84:87], s83 offen sc1
    s_add_u32 s83, s80, 902144
    buffer_load_dwordx4 a[72:75], v3, s[84:87], s83 offen sc1
    s_add_u32 s83, s80, 821248
    buffer_load_dwordx4 a[76:79], v3, s[84:87], s83 offen sc1
    s_waitcnt lgkmcnt(0)
    s_branch mk_ck50
mk_cj40:
    s_lshl_b32 s28, s29, 4
    s_add_u32 s28, s28, 81920
    v_mov_b32 v30, s88
    s_waitcnt vmcnt(0)
    s_mov_b64 exec, 1
    buffer_store_dword v30, off, s[92:95], s28 sc1
    s_mov_b64 exec, -1
    s_mov_b64 exec, 1
    s_lshr_b32 s28, s22, 2
    s_lshl_b32 s28, s28, 9
    s_lshl_b32 s29, s3, 7
    s_add_u32 s28, s28, s29
    s_add_u32 s28, s28, 24576
    buffer_load_dword v24, off, s[92:95], s28 sc1
    buffer_load_dword v25, off, s[92:95], s28 offset:64 sc1
    s_lshl_b32 s28, s22, 7
    s_add_u32 s28, s28, 28672
    buffer_load_dword v26, off, s[92:95], s28 sc1
    buffer_load_dword v27, off, s[92:95], s28 offset:64 sc1
    s_lshl_b32 s28, s22, 9
    s_add_u32 s28, s28, 57344
    s_mov_b64 exec, 0xff
    v_lshlrev_b32 v23, 6, v0
    buffer_load_dword v28, v23, s[92:95], s28 offen sc1
    s_mov_b64 exec, -1
mk_c1:
    s_lshr_b32 s28, s22, 3
    s_lshl_b32 s28, s28, 8
    s_lshl_b32 s29, s3, 6
    s_add_u32 s28, s28, s29
    s_lshl_b32 s28, s28, 4
    s_add_u32 s28, s28, 81920
    v_lshl_add_u32 v31, v0, 4, s28
    s_mov_b32 s91, 0xc0135761
    v_mov_b32 v12, 0x3f803f80
    v_mov_b32 v13, 0x3f803f80
    v_mov_b32 v14, 0x3f803f80
    v_mov_b32 v15, 0x3f803f80
    s_barrier
    s_nop 0
    v_mfma_f32_16x16x32_bf16 v[32:35], a[136:139], v[12:15], 0
    s_add_u32 s83, s81, 3072
    buffer_load_dwordx4 v[236:239], v206, s[84:87], s83 offen offset:0 sc1
    v_lshrrev_b32 v19, 1, v7
    v_lshlrev_b32 v19, 8, v19
    v_and_b32 v18, 1, v7
    v_mfma_f32_16x16x32_bf16 v[36:39], a[140:143], v[12:15], 0
    s_add_u32 s83, s81, 3584
    buffer_load_dwordx4 v[240:243], v206, s[84:87], s83 offen offset:0 sc1
    v_lshl_add_u32 v19, v18, 3, v19
    v_lshl_add_u32 v20, v6, 4, v19
    v_lshrrev_b32 v16, 3, v0
    v_mfma_f32_16x16x32_bf16 v[40:43], a[144:147], v[12:15], 0
    s_add_u32 s83, s81, 4096
    buffer_load_dwordx4 v[244:247], v206, s[84:87], s83 offen offset:0 sc1
    v_and_b32 v17, 7, v0
    v_bfe_u32 v18, v0, 4, 1
    v_lshlrev_b32 v18, 2, v18
    v_mfma_f32_16x16x32_bf16 v[44:47], a[148:151], v[12:15], 0
    s_add_u32 s83, s81, 4608
    buffer_load_dwordx4 v[248:251], v206, s[84:87], s83 offen offset:0 sc1
    v_xor_b32 v17, v17, v18
    v_lshlrev_b32 v4, 7, v16
    v_lshl_add_u32 v4, v17, 4, v4
    v_mfma_f32_16x16x32_bf16 v[48:51], a[152:155], v[12:15], 0
    v_xor_b32 v5, 32, v4
    s_mul_i32 s27, s3, 20480
    s_mul_i32 s26, s22, 81920
    v_mfma_f32_16x16x32_bf16 v[32:35], a[156:159], v[12:15], v[32:35]
    s_add_u32 s83, s81, 5120
    buffer_load_dwordx4 v[252:255], v206, s[84:87], s83 offen offset:0 sc1
    s_add_u32 s26, s26, s27
    s_add_u32 s8, s4, 0x500000
    s_addc_u32 s9, s5, 0
    s_mov_b32 s10, 0x280000
    v_mfma_f32_16x16x32_bf16 v[36:39], a[160:163], v[12:15], v[36:39]
    s_add_u32 s83, s81, 5632
    buffer_load_dwordx4 a[0:3], v206, s[84:87], s83 offen offset:0 sc1
    s_mov_b32 s11, 0x00020000
    s_add_u32 s16, s4, 0x1048000
    s_addc_u32 s17, s5, 0
    s_mov_b32 s18, 0x780000
    v_mfma_f32_16x16x32_bf16 v[40:43], a[164:167], v[12:15], v[40:43]
    s_add_u32 s83, s81, 6144
    buffer_load_dwordx4 a[4:7], v206, s[84:87], s83 offen offset:0 sc1
    s_mov_b32 s19, 0x00020000
    v_lshrrev_b32 v16, 2, v6
    v_lshl_add_u32 v16, v7, 3, v16
    v_mfma_f32_16x16x32_bf16 v[44:47], a[168:171], v[12:15], v[44:47]
    v_lshlrev_b32 v16, 7, v16
    v_and_b32 v17, 3, v6
    v_lshl_add_u32 v16, v17, 3, v16
    v_mfma_f32_16x16x32_bf16 v[48:51], a[172:175], v[12:15], v[48:51]
    s_add_u32 s83, s81, 6656
    buffer_load_dwordx4 a[8:11], v206, s[84:87], s83 offen offset:0 sc1
    v_add_u32 v16, s27, v16
    v_lshrrev_b32 v17, 3, v6
    v_lshlrev_b32 v17, 1, v17
    v_mfma_f32_16x16x32_bf16 v[32:35], a[176:179], v[12:15], v[32:35]
    s_add_u32 s83, s81, 7168
    buffer_load_dwordx4 a[12:15], v206, s[84:87], s83 offen offset:0 sc1
    v_and_b32 v18, 1, v7
    v_or_b32 v17, v17, v18
    v_xor_b32 v18, s30, v17
    v_mfma_f32_16x16x32_bf16 v[36:39], a[180:183], v[12:15], v[36:39]
    s_add_u32 s83, s81, 7680
    buffer_load_dwordx4 a[16:19], v206, s[84:87], s83 offen offset:0 sc1
    v_lshl_add_u32 v8, v18, 5, v16
    v_xor_b32 v18, s31, v17
    v_lshl_add_u32 v9, v18, 5, v16
    v_mfma_f32_16x16x32_bf16 v[40:43], a[184:187], v[12:15], v[40:43]
    v_xor_b32 v18, s32, v17
    v_lshl_add_u32 v10, v18, 5, v16
    v_xor_b32 v18, s33, v17
    v_mfma_f32_16x16x32_bf16 v[44:47], a[188:191], v[12:15], v[44:47]
    s_add_u32 s83, s81, 8192
    buffer_load_dwordx4 a[20:23], v206, s[84:87], s83 offen offset:0 sc1
    v_lshl_add_u32 v11, v18, 5, v16
    s_mul_i32 s28, s3, 320
    s_add_u32 s28, s28, 159744
    v_mfma_f32_16x16x32_bf16 v[48:51], a[192:195], v[12:15], v[48:51]
    s_add_u32 s83, s81, 8704
    buffer_load_dwordx4 a[24:27], v206, s[84:87], s83 offen offset:0 sc1
    v_lshl_add_u32 v16, v7, 4, s28
    v_mov_b32 v17, 159744
    v_lshl_add_u32 v17, v7, 4, v17
    v_mfma_f32_16x16x32_bf16 v[32:35], a[196:199], v[12:15], v[32:35]
    s_add_u32 s83, s81, 9216
    buffer_load_dwordx4 a[28:31], v206, s[84:87], s83 offen offset:0 sc1
    v_bfe_u32 v22, v0, 2, 2
    v_and_b32 v19, 1, v7
    v_cmp_eq_u32 vcc, v19, v22
    v_mfma_f32_16x16x32_bf16 v[36:39], a[200:203], v[12:15], v[36:39]
    s_nop 0
    v_cndmask_b32 v188, 0, v12, vcc
    v_mov_b32 v189, v188
    v_mov_b32 v190, v188
    v_mfma_f32_16x16x32_bf16 v[40:43], a[204:207], v[12:15], v[40:43]
    s_add_u32 s83, s81, 9728
    buffer_load_dwordx4 a[32:35], v206, s[84:87], s83 offen offset:0 sc1
    v_mov_b32 v191, v188
    v_mfma_f32_16x16x32_bf16 v[44:47], a[208:211], v[12:15], v[44:47]
    s_add_u32 s83, s81, 10240
    buffer_load_dwordx4 a[236:239], v206, s[84:87], s83 offen offset:0 sc1
    v_mfma_f32_16x16x32_bf16 v[48:51], a[212:215], v[12:15], v[48:51]
    s_add_u32 s83, s81, 10752
    buffer_load_dwordx4 a[240:243], v206, s[84:87], s83 offen offset:0 sc1
    v_mfma_f32_16x16x32_bf16 v[32:35], a[216:219], v[12:15], v[32:35]
    v_mfma_f32_16x16x32_bf16 v[36:39], a[220:223], v[12:15], v[36:39]
    s_add_u32 s83, s81, 11264
    buffer_load_dwordx4 a[244:247], v206, s[84:87], s83 offen offset:0 sc1
    v_mfma_f32_16x16x32_bf16 v[40:43], a[224:227], v[12:15], v[40:43]
    s_add_u32 s83, s81, 11776
    buffer_load_dwordx4 a[248:251], v206, s[84:87], s83 offen offset:0 sc1
    v_mfma_f32_16x16x32_bf16 v[44:47], a[228:231], v[12:15], v[44:47]
    s_add_u32 s83, s81, 12288
    buffer_load_dwordx4 a[252:255], v206, s[84:87], s83 offen offset:0 sc1
    v_mfma_f32_16x16x32_bf16 v[48:51], a[232:235], v[12:15], v[48:51]
    s_mov_b32 exec_lo, 0x00010001
    s_mov_b32 exec_hi, 0x00010001
    ds_write_b128 v16, v[32:35] offset:0
    ds_write_b128 v16, v[36:39] offset:64
    ds_write_b128 v16, v[40:43] offset:128
    ds_write_b128 v16, v[44:47] offset:192
    s_nop 1
    ds_write_b128 v16, v[48:51] offset:256
    s_mov_b64 exec, -1
    s_waitcnt lgkmcnt(0)
    s_barrier
    ds_read_b128 v[32:35], v17 offset:0
    ds_read_b128 v[36:39], v17 offset:64
    ds_read_b128 v[40:43], v17 offset:128
    ds_read_b128 v[44:47], v17 offset:192
    ds_read_b128 v[48:51], v17 offset:256
    ds_read_b128 v[52:55], v17 offset:320
    ds_read_b128 v[56:59], v17 offset:384
    ds_read_b128 v[60:63], v17 offset:448
    ds_read_b128 v[64:67], v17 offset:512
    ds_read_b128 v[68:71], v17 offset:576
    s_waitcnt lgkmcnt(0)
    ds_read_b128 v[72:75], v17 offset:640
    ds_read_b128 v[76:79], v17 offset:704
    ds_read_b128 v[80:83], v17 offset:768
    ds_read_b128 v[84:87], v17 offset:832
    ds_read_b128 v[88:91], v17 offset:896
    ds_read_b128 v[92:95], v17 offset:960
    ds_read_b128 v[96:99], v17 offset:1024
    ds_read_b128 v[100:103], v17 offset:1088
    ds_read_b128 v[104:107], v17 offset:1152
    ds_read_b128 v[108:111], v17 offset:1216
    v_pk_add_f32 v[32:33], v[32:33], v[52:53]
    v_pk_add_f32 v[34:35], v[34:35], v[54:55]
    v_pk_add_f32 v[36:37], v[36:37], v[56:57]
    v_pk_add_f32 v[38:39], v[38:39], v[58:59]
    v_pk_add_f32 v[40:41], v[40:41], v[60:61]
    v_pk_add_f32 v[42:43], v[42:43], v[62:63]
    v_pk_add_f32 v[44:45], v[44:45], v[64:65]
    v_pk_add_f32 v[46:47], v[46:47], v[66:67]
    v_pk_add_f32 v[48:49], v[48:49], v[68:69]
    v_pk_add_f32 v[50:51], v[50:51], v[70:71]
    s_waitcnt lgkmcnt(0)
    buffer_load_dword v30, v31, s[92:95], 0 offen sc1
    v_pk_add_f32 v[72:73], v[72:73], v[92:93]
    v_pk_add_f32 v[74:75], v[74:75], v[94:95]
    v_pk_add_f32 v[76:77], v[76:77], v[96:97]
    v_pk_add_f32 v[78:79], v[78:79], v[98:99]
    v_pk_add_f32 v[80:81], v[80:81], v[100:101]
    v_pk_add_f32 v[82:83], v[82:83], v[102:103]
    v_pk_add_f32 v[84:85], v[84:85], v[104:105]
    v_pk_add_f32 v[86:87], v[86:87], v[106:107]
    v_pk_add_f32 v[88:89], v[88:89], v[108:109]
    v_pk_add_f32 v[90:91], v[90:91], v[110:111]
    v_pk_add_f32 v[192:193], v[32:33], v[72:73]
    v_pk_add_f32 v[194:195], v[34:35], v[74:75]
    v_pk_add_f32 v[196:197], v[36:37], v[76:77]
    v_pk_add_f32 v[198:199], v[38:39], v[78:79]
    v_pk_add_f32 v[200:201], v[40:41], v[80:81]
    v_pk_add_f32 v[202:203], v[42:43], v[82:83]
    v_pk_add_f32 v[204:205], v[44:45], v[84:85]
    v_pk_add_f32 v[206:207], v[46:47], v[86:87]
    v_pk_add_f32 v[208:209], v[48:49], v[88:89]
    v_pk_add_f32 v[210:211], v[50:51], v[90:91]
    v_and_b32 v145, 1, v7
    v_mul_u32_u24 v144, 20480, v145
    v_lshrrev_b32 v145, 1, v7
    v_lshl_add_u32 v144, v145, 8, v144
    v_and_b32 v145, 3, v0
    v_lshl_add_u32 v144, v145, 4, v144
    v_bfe_u32 v145, v0, 2, 1
    v_lshl_add_u32 v144, v145, 7, v144
    v_bfe_u32 v145, v0, 3, 1
    v_lshl_add_u32 v144, v145, 6, v144
    s_waitcnt vmcnt(0)
    v_cmp_ne_u32 vcc, s88, v30
    s_cbranch_vccz mk_eg53
    buffer_load_dword v30, v31, s[92:95], 0 offen sc1
    v_mfma_f32_16x16x32_bf16 v[176:179], v[188:191], v[212:215], 0
    v_mfma_f32_16x16x32_bf16 v[176:179], v[188:191], v[216:219], v[176:179]
    v_mfma_f32_16x16x32_bf16 v[176:179], v[188:191], v[220:223], v[176:179]
    v_mfma_f32_16x16x32_bf16 v[176:179], v[188:191], v[224:227], v[176:179]
    v_mfma_f32_16x16x32_bf16 v[176:179], v[188:191], v[228:231], v[176:179]
    v_mfma_f32_16x16x32_bf16 v[176:179], v[188:191], v[232:235], v[176:179]
    v_mfma_f32_16x16x32_bf16 v[176:179], v[188:191], v[236:239], v[176:179]
    v_mfma_f32_16x16x32_bf16 v[176:179], v[188:191], v[240:243], v[176:179]
    v_mfma_f32_16x16x32_bf16 v[176:179], v[188:191], v[244:247], v[176:179]
    v_mfma_f32_16x16x32_bf16 v[176:179], v[188:191], v[248:251], v[176:179]
    v_mfma_f32_16x16x32_bf16 v[176:179], v[188:191], v[252:255], v[176:179]
    v_mfma_f32_16x16x32_bf16 v[176:179], v[188:191], a[0:3], v[176:179]
    v_mfma_f32_16x16x32_bf16 v[176:179], v[188:191], a[4:7], v[176:179]
    v_mfma_f32_16x16x32_bf16 v[176:179], v[188:191], a[8:11], v[176:179]
    v_mfma_f32_16x16x32_bf16 v[176:179], v[188:191], a[12:15], v[176:179]
    v_mfma_f32_16x16x32_bf16 v[176:179], v[188:191], a[16:19], v[176:179]
    v_mfma_f32_16x16x32_bf16 v[176:179], v[188:191], a[20:23], v[176:179]
    v_mfma_f32_16x16x32_bf16 v[176:179], v[188:191], a[24:27], v[176:179]
    v_mfma_f32_16x16x32_bf16 v[176:179], v[188:191], a[28:31], v[176:179]
    v_mfma_f32_16x16x32_bf16 v[176:179], v[188:191], a[32:35], v[176:179]
    v_mfma_f32_16x16x32_bf16 v[176:179], v[188:191], a[236:239], v[176:179]
    v_mfma_f32_16x16x32_bf16 v[176:179], v[188:191], a[240:243], v[176:179]
    v_mfma_f32_16x16x32_bf16 v[176:179], v[188:191], a[244:247], v[176:179]
    v_mfma_f32_16x16x32_bf16 v[176:179], v[188:191], a[248:251], v[176:179]
    v_mfma_f32_16x16x32_bf16 v[176:179], v[188:191], a[252:255], v[176:179]
    s_mov_b32 s89, 0x40000
mk_pp55:
    s_waitcnt vmcnt(0)
    v_cmp_ne_u32 vcc, s88, v30
    s_cbranch_vccz mk_ppd56
    buffer_load_dword v30, v31, s[92:95], 0 offen sc1
    s_sub_u32 s89, s89, 1
    s_cmp_lg_u32 s89, 0
    s_cbranch_scc1 mk_pp55
mk_ppd56:
    s_add_u32 m0, s27, 0
    s_add_u32 s28, s26, 0
    buffer_load_dwordx4 v4, s[8:11], s28 offen offset:0 sc1 lds
    buffer_load_dwordx4 v5, s[8:11], s28 offen offset:1024 sc1 lds
    buffer_load_dwordx4 v4, s[8:11], s28 offen offset:2048 sc1 lds
    buffer_load_dwordx4 v5, s[8:11], s28 offen offset:3072 sc1 lds
    s_add_u32 m0, s27, 4096
    s_add_u32 s28, s26, 4096
    buffer_load_dwordx4 v4, s[8:11], s28 offen offset:0 sc1 lds
    buffer_load_dwordx4 v5, s[8:11], s28 offen offset:1024 sc1 lds
    buffer_load_dwordx4 v4, s[8:11], s28 offen offset:2048 sc1 lds
    buffer_load_dwordx4 v5, s[8:11], s28 offen offset:3072 sc1 lds
    s_add_u32 m0, s27, 8192
    s_add_u32 s28, s26, 8192
    buffer_load_dwordx4 v4, s[8:11], s28 offen offset:0 sc1 lds
    buffer_load_dwordx4 v5, s[8:11], s28 offen offset:1024 sc1 lds
    buffer_load_dwordx4 v4, s[8:11], s28 offen offset:2048 sc1 lds
    buffer_load_dwordx4 v5, s[8:11], s28 offen offset:3072 sc1 lds
    s_add_u32 m0, s27, 12288
    s_add_u32 s28, s26, 12288
    buffer_load_dwordx4 v4, s[8:11], s28 offen offset:0 sc1 lds
    buffer_load_dwordx4 v5, s[8:11], s28 offen offset:1024 sc1 lds
    buffer_load_dwordx4 v4, s[8:11], s28 offen offset:2048 sc1 lds
    buffer_load_dwordx4 v5, s[8:11], s28 offen offset:3072 sc1 lds
    s_add_u32 m0, s27, 16384
    s_add_u32 s28, s26, 16384
    buffer_load_dwordx4 v4, s[8:11], s28 offen offset:0 sc1 lds
    buffer_load_dwordx4 v5, s[8:11], s28 offen offset:1024 sc1 lds
    buffer_load_dwordx4 v4, s[8:11], s28 offen offset:2048 sc1 lds
    buffer_load_dwordx4 v5, s[8:11], s28 offen offset:3072 sc1 lds
    s_branch mk_ej54
mk_eg53:
    s_add_u32 m0, s27, 0
    s_add_u32 s28, s26, 0
    buffer_load_dwordx4 v4, s[8:11], s28 offen offset:0 sc1 lds
    buffer_load_dwordx4 v5, s[8:11], s28 offen offset:1024 sc1 lds
    buffer_load_dwordx4 v4, s[8:11], s28 offen offset:2048 sc1 lds
    buffer_load_dwordx4 v5, s[8:11], s28 offen offset:3072 sc1 lds
    s_add_u32 m0, s27, 4096
    s_add_u32 s28, s26, 4096
    buffer_load_dwordx4 v4, s[8:11], s28 offen offset:0 sc1 lds
    buffer_load_dwordx4 v5, s[8:11], s28 offen offset:1024 sc1 lds
    buffer_load_dwordx4 v4, s[8:11], s28 offen offset:2048 sc1 lds
    buffer_load_dwordx4 v5, s[8:11], s28 offen offset:3072 sc1 lds
    s_add_u32 m0, s27, 8192
    s_add_u32 s28, s26, 8192
    buffer_load_dwordx4 v4, s[8:11], s28 offen offset:0 sc1 lds
    buffer_load_dwordx4 v5, s[8:11], s28 offen offset:1024 sc1 lds
    buffer_load_dwordx4 v4, s[8:11], s28 offen offset:2048 sc1 lds
    buffer_load_dwordx4 v5, s[8:11], s28 offen offset:3072 sc1 lds
    s_add_u32 m0, s27, 12288
    s_add_u32 s28, s26, 12288
    buffer_load_dwordx4 v4, s[8:11], s28 offen offset:0 sc1 lds
    buffer_load_dwordx4 v5, s[8:11], s28 offen offset:1024 sc1 lds
    buffer_load_dwordx4 v4, s[8:11], s28 offen offset:2048 sc1 lds
    buffer_load_dwordx4 v5, s[8:11], s28 offen offset:3072 sc1 lds
    s_add_u32 m0, s27, 16384
    s_add_u32 s28, s26, 16384
    buffer_load_dwordx4 v4, s[8:11], s28 offen offset:0 sc1 lds
    buffer_load_dwordx4 v5, s[8:11], s28 offen offset:1024 sc1 lds
    buffer_load_dwordx4 v4, s[8:11], s28 offen offset:2048 sc1 lds
    buffer_load_dwordx4 v5, s[8:11], s28 offen offset:3072 sc1 lds
    v_mfma_f32_16x16x32_bf16 v[176:179], v[188:191], v[212:215], 0
    v_mfma_f32_16x16x32_bf16 v[176:179], v[188:191], v[216:219], v[176:179]
    v_mfma_f32_16x16x32_bf16 v[176:179], v[188:191], v[220:223], v[176:179]
    v_mfma_f32_16x16x32_bf16 v[176:179], v[188:191], v[224:227], v[176:179]
    v_mfma_f32_16x16x32_bf16 v[176:179], v[188:191], v[228:231], v[176:179]
    v_mfma_f32_16x16x32_bf16 v[176:179], v[188:191], v[232:235], v[176:179]
    v_mfma_f32_16x16x32_bf16 v[176:179], v[188:191], v[236:239], v[176:179]
    v_mfma_f32_16x16x32_bf16 v[176:179], v[188:191], v[240:243], v[176:179]
    v_mfma_f32_16x16x32_bf16 v[176:179], v[188:191], v[244:247], v[176:179]
    v_mfma_f32_16x16x32_bf16 v[176:179], v[188:191], v[248:251], v[176:179]
    v_mfma_f32_16x16x32_bf16 v[176:179], v[188:191], v[252:255], v[176:179]
    v_mfma_f32_16x16x32_bf16 v[176:179], v[188:191], a[0:3], v[176:179]
    v_mfma_f32_16x16x32_bf16 v[176:179], v[188:191], a[4:7], v[176:179]
    v_mfma_f32_16x16x32_bf16 v[176:179], v[188:191], a[8:11], v[176:179]
    v_mfma_f32_16x16x32_bf16 v[176:179], v[188:191], a[12:15], v[176:179]
    v_mfma_f32_16x16x32_bf16 v[176:179], v[188:191], a[16:19], v[176:179]
    v_mfma_f32_16x16x32_bf16 v[176:179], v[188:191], a[20:23], v[176:179]
    v_mfma_f32_16x16x32_bf16 v[176:179], v[188:191], a[24:27], v[176:179]
    v_mfma_f32_16x16x32_bf16 v[176:179], v[188:191], a[28:31], v[176:179]
    v_mfma_f32_16x16x32_bf16 v[176:179], v[188:191], a[32:35], v[176:179]
    v_mfma_f32_16x16x32_bf16 v[176:179], v[188:191], a[236:239], v[176:179]
    v_mfma_f32_16x16x32_bf16 v[176:179], v[188:191], a[240:243], v[176:179]
    v_mfma_f32_16x16x32_bf16 v[176:179], v[188:191], a[244:247], v[176:179]
    v_mfma_f32_16x16x32_bf16 v[176:179], v[188:191], a[248:251], v[176:179]
    v_mfma_f32_16x16x32_bf16 v[176:179], v[188:191], a[252:255], v[176:179]
mk_ej54:
    v_and_b32 v171, 7, v0
    v_min_u32 v171, 4, v171
    s_and_b32 s28, s3, 1
    s_lshl_b32 s29, s22, 2
    s_add_u32 s28, s28, s29
    s_sub_u32 s28, s28, 1
    v_add_u32 v171, s28, v171
    v_bfe_u32 v18, v171, 4, 3
    s_lshr_b32 s28, s22, 2
    v_cmp_eq_u32 vcc, s28, v18
    v_and_b32 v171, 15, v171
    v_lshl_add_u32 v171, v18, 7, v171
    v_bfe_u32 v18, v0, 3, 1
    v_lshl_add_u32 v171, v18, 4, v171
    s_lshl_b32 s28, s3, 5
    v_add_u32 v171, s28, v171
    v_lshlrev_b32 v171, 2, v171
    v_add_u32 v171, 8192, v171
    v_add_u32 v170, 16384, v171
    v_cndmask_b32 v170, v171, v170, vcc
    v_and_b32 v19, 3, v0
    v_xor_b32 v19, 1, v19
    v_lshl_add_u32 v19, v19, 2, v3
    s_mul_i32 s28, s33, 19456
    s_add_u32 s28, s28, 81920
    v_add_u32 v175, s28, v3
    v_add_u32 v31, s28, v19
    s_mul_i32 s28, s32, 19456
    s_add_u32 s28, s28, 81920
    v_add_u32 v174, s28, v3
    s_waitcnt vmcnt(16)
    ds_read_b64_tr_b16 v[146:147], v8 offset:0
    ds_read_b64_tr_b16 v[148:149], v8 offset:512
    ds_read_b64_tr_b16 v[150:151], v9 offset:0
    ds_read_b64_tr_b16 v[152:153], v9 offset:512
    s_waitcnt lgkmcnt(2)
    v_mfma_f32_16x16x32_bf16 v[32:35], a[136:139], v[146:149], 0
    s_mov_b32 s66, 0xaaaaaaaa
    v_add_u32 v30, s28, v19
    s_mul_i32 s28, s31, 19456
    v_mfma_f32_16x16x32_bf16 v[36:39], a[140:143], v[146:149], 0
    s_add_u32 s28, s28, 81920
    v_add_u32 v173, s28, v3
    v_add_u32 v29, s28, v19
    v_mfma_f32_16x16x32_bf16 v[40:43], a[144:147], v[146:149], 0
    s_mul_i32 s28, s30, 19456
    s_add_u32 s28, s28, 81920
    v_add_u32 v172, s28, v3
    v_mfma_f32_16x16x32_bf16 v[44:47], a[148:151], v[146:149], 0
    s_mov_b32 s67, 0xaaaaaaaa
    v_add_u32 v28, s28, v19
    v_lshrrev_b32 v22, 2, v6
    v_mfma_f32_16x16x32_bf16 v[48:51], a[152:155], v[146:149], 0
    s_add_u32 s68, s24, 0
    v_lshl_add_u32 v22, v22, 4, v6
    v_lshlrev_b32 v22, 4, v22
    v_mfma_f32_16x16x32_bf16 v[112:115], v[12:15], v[146:149], 0
    s_and_b32 s69, s68, 1
    ds_read_b64_tr_b16 v[154:155], v10 offset:0
    ds_read_b64_tr_b16 v[156:157], v10 offset:512
    v_mfma_f32_16x16x32_bf16 v[128:131], v[146:149], v[146:149], 0
    s_waitcnt lgkmcnt(2)
    v_and_b32 v18, 2, v6
    v_lshl_add_u32 v18, v18, 2, v22
    v_mfma_f32_16x16x32_bf16 v[52:55], a[136:139], v[150:153], 0
    s_lshl_b32 s69, s69, 9
    v_add_u32 v18, s28, v18
    v_lshrrev_b32 v16, 2, v6
    v_mfma_f32_16x16x32_bf16 v[56:59], a[140:143], v[150:153], 0
    s_lshr_b32 s60, s68, 1
    v_lshl_add_u32 v16, v7, 2, v16
    s_lshl_b32 s28, s24, 4
    v_mfma_f32_16x16x32_bf16 v[60:63], a[144:147], v[150:153], 0
    s_lshl_b32 s60, s60, 10
    v_add_u32 v16, s28, v16
    v_lshlrev_b32 v16, 7, v16
    v_mfma_f32_16x16x32_bf16 v[64:67], a[148:151], v[150:153], 0
    s_add_u32 s60, s60, s69
    v_and_b32 v17, 3, v6
    v_lshl_add_u32 v16, v17, 3, v16
    v_mfma_f32_16x16x32_bf16 v[68:71], a[152:155], v[150:153], 0
    s_add_u32 s68, s24, 1
    v_lshrrev_b32 v17, 3, v6
    v_lshlrev_b32 v17, 1, v17
    v_mfma_f32_16x16x32_bf16 v[116:119], v[12:15], v[150:153], 0
    s_and_b32 s69, s68, 1
    ds_read_b64_tr_b16 v[158:159], v11 offset:0
    ds_read_b64_tr_b16 v[160:161], v11 offset:512
    v_mfma_f32_16x16x32_bf16 v[132:135], v[150:153], v[150:153], 0
    s_waitcnt lgkmcnt(2)
    v_lshrrev_b32 v22, 1, v7
    v_or_b32 v17, v17, v22
    v_mfma_f32_16x16x32_bf16 v[72:75], a[136:139], v[154:157], 0
    s_lshl_b32 s69, s69, 9
    v_xor_b32 v17, s3, v17
    v_lshl_add_u32 v16, v17, 5, v16
    v_mfma_f32_16x16x32_bf16 v[76:79], a[140:143], v[154:157], 0
    s_lshr_b32 s61, s68, 1
    v_lshlrev_b32 v19, 4, v6
    v_sub_u32 v19, v20, v19
    v_mfma_f32_16x16x32_bf16 v[80:83], a[144:147], v[154:157], 0
    s_lshr_b32 s28, s23, 1
    s_lshr_b32 s29, s28, 1
    s_add_u32 s29, s29, 1
    v_mfma_f32_16x16x32_bf16 v[84:87], a[148:151], v[154:157], 0
    s_sub_u32 s38, 0, s29
    s_bitcmp1_b32 s28, 0
    s_cselect_b32 s38, s38, s29
    s_lshl_b32 s39, s22, 6
    v_mfma_f32_16x16x32_bf16 v[88:91], a[152:155], v[154:157], 0
    s_add_u32 s39, s39, s38
    s_lshl_b32 s28, s3, 4
    s_add_u32 s39, s39, s28
    v_mfma_f32_16x16x32_bf16 v[120:123], v[12:15], v[154:157], 0
    s_waitcnt vmcnt(12)
    ds_read_b64_tr_b16 v[146:147], v8 offset:4096
    ds_read_b64_tr_b16 v[148:149], v8 offset:4608
    v_mfma_f32_16x16x32_bf16 v[136:139], v[154:157], v[154:157], 0
    s_waitcnt lgkmcnt(2)
    v_add_u32 v21, s39, v6
    v_cmp_gt_u32 vcc, 2048, v21
    v_mfma_f32_16x16x32_bf16 v[92:95], a[136:139], v[158:161], 0
    s_lshl_b32 s61, s61, 10
    v_and_b32 v21, 2047, v21
    v_lshrrev_b32 v22, 4, v21
    v_mfma_f32_16x16x32_bf16 v[96:99], a[140:143], v[158:161], 0
    s_add_u32 s61, s61, s69
    v_and_b32 v21, 15, v21
    v_mul_u32_u24 v22, 20480, v22
    v_mfma_f32_16x16x32_bf16 v[100:103], a[144:147], v[158:161], 0
    s_add_u32 s68, s24, 2
    v_lshl_add_u32 v21, v21, 4, v19
    v_add_u32 v21, v21, v22
    v_mfma_f32_16x16x32_bf16 v[104:107], a[148:151], v[158:161], 0
    s_and_b32 s69, s68, 1
    v_mov_b32 v17, 0x7f800000
    s_lshl_b32 s69, s69, 9
    v_mfma_f32_16x16x32_bf16 v[108:111], a[152:155], v[158:161], 0
    s_lshr_b32 s62, s68, 1
    s_lshl_b32 s62, s62, 10
    s_add_u32 s62, s62, s69
    v_mfma_f32_16x16x32_bf16 v[124:127], v[12:15], v[158:161], 0
    s_add_u32 s68, s24, 3
    ds_read_b64_tr_b16 v[150:151], v9 offset:4096
    ds_read_b64_tr_b16 v[152:153], v9 offset:4608
    v_mfma_f32_16x16x32_bf16 v[140:143], v[158:161], v[158:161], 0
    s_waitcnt lgkmcnt(2)
    s_and_b32 s69, s68, 1
    s_lshl_b32 s69, s69, 9
    v_mfma_f32_16x16x32_bf16 v[32:35], a[156:159], v[146:149], v[32:35]
    s_lshr_b32 s63, s68, 1
    s_lshl_b32 s63, s63, 10
    s_add_u32 s63, s63, s69
    v_mfma_f32_16x16x32_bf16 v[36:39], a[160:163], v[146:149], v[36:39]
    s_add_u32 s68, s24, 4
    s_and_b32 s69, s68, 1
    s_lshl_b32 s69, s69, 9
    v_mfma_f32_16x16x32_bf16 v[40:43], a[164:167], v[146:149], v[40:43]
    s_add_u32 s83, s81, 12800
    buffer_load_dwordx4 a[136:139], v144, s[84:87], s83 offen offset:0 sc1
    v_mfma_f32_16x16x32_bf16 v[44:47], a[168:171], v[146:149], v[44:47]
    s_lshr_b32 s64, s68, 1
    s_lshl_b32 s64, s64, 10
    s_add_u32 s64, s64, s69
    v_mfma_f32_16x16x32_bf16 v[48:51], a[172:175], v[146:149], v[48:51]
    s_lshr_b32 s69, s22, 2
    s_lshl_b32 s69, s69, 7
    s_lshl_b32 s65, s23, 4
    v_mfma_f32_16x16x32_bf16 v[112:115], v[12:15], v[146:149], v[112:115]
    s_add_u32 s69, s69, s65
    ds_read_b64_tr_b16 v[154:155], v10 offset:4096
    ds_read_b64_tr_b16 v[156:157], v10 offset:4608
    v_mfma_f32_16x16x32_bf16 v[128:131], v[146:149], v[146:149], v[128:131]
    s_waitcnt lgkmcnt(2)
    s_and_b32 s65, s22, 3
    s_lshl_b32 s65, s65, 2
    v_mfma_f32_16x16x32_bf16 v[52:55], a[156:159], v[150:153], v[52:55]
    s_add_u32 s69, s69, s65
    buffer_load_dwordx4 a[140:143], v144, s[84:87], s83 offen offset:512 sc1
    v_mfma_f32_16x16x32_bf16 v[56:59], a[160:163], v[150:153], v[56:59]
    s_add_u32 s65, s69, s3
    s_add_u32 s69, s65, 1
    s_and_b32 s69, s69, 15
    v_mfma_f32_16x16x32_bf16 v[60:63], a[164:167], v[150:153], v[60:63]
    s_mul_i32 s40, s3, 5120
    s_lshl_b32 s41, s22, 2
    s_add_u32 s34, s41, s30
    v_mfma_f32_16x16x32_bf16 v[64:67], a[168:171], v[150:153], v[64:67]
    s_mul_i32 s34, s34, 20480
    s_add_u32 s35, s41, s31
    s_mul_i32 s35, s35, 20480
    v_mfma_f32_16x16x32_bf16 v[68:71], a[172:175], v[150:153], v[68:71]
    s_add_u32 s36, s41, s32
    s_mul_i32 s36, s36, 20480
    s_add_u32 s37, s41, s33
    v_mfma_f32_16x16x32_bf16 v[116:119], v[12:15], v[150:153], v[116:119]
    s_mul_i32 s37, s37, 20480
    buffer_load_dwordx4 a[144:147], v144, s[84:87], s83 offen offset:1024 sc1
    v_mfma_f32_16x16x32_bf16 v[132:135], v[150:153], v[150:153], v[132:135]
    s_waitcnt lgkmcnt(0)
    ds_read_b64_tr_b16 v[158:159], v11 offset:4096
    ds_read_b64_tr_b16 v[160:161], v11 offset:4608
    v_mfma_f32_16x16x32_bf16 v[72:75], a[156:159], v[154:157], v[72:75]
    s_add_u32 s12, s60, s34
    s_add_u32 s13, s61, s34
    s_add_u32 s14, s62, s34
    v_mfma_f32_16x16x32_bf16 v[76:79], a[160:163], v[154:157], v[76:79]
    s_add_u32 s15, s63, s34
    s_add_u32 s20, s64, s34
    s_add_u32 s34, s34, s40
    v_mfma_f32_16x16x32_bf16 v[80:83], a[164:167], v[154:157], v[80:83]
    s_add_u32 s35, s35, s40
    s_add_u32 s36, s36, s40
    s_add_u32 s37, s37, s40
    v_mfma_f32_16x16x32_bf16 v[84:87], a[168:171], v[154:157], v[84:87]
    s_lshl_b32 s41, s22, 3
    buffer_load_dwordx4 a[148:151], v144, s[84:87], s83 offen offset:1536 sc1
    v_mfma_f32_16x16x32_bf16 v[88:91], a[172:175], v[154:157], v[88:91]
    s_add_u32 s41, s41, s23
    s_lshl_b32 s41, s41, 2
    s_add_u32 s21, s41, s3
    v_mfma_f32_16x16x32_bf16 v[120:123], v[12:15], v[154:157], v[120:123]
    s_waitcnt vmcnt(12)
    ds_read_b64_tr_b16 v[146:147], v8 offset:8192
    ds_read_b64_tr_b16 v[148:149], v8 offset:8704
    v_mfma_f32_16x16x32_bf16 v[136:139], v[154:157], v[154:157], v[136:139]
    s_waitcnt lgkmcnt(2)
    s_lshl_b32 s70, s21, 7
    s_add_u32 s44, s4, 0x211b000
    s_addc_u32 s45, s5, 0
    v_mfma_f32_16x16x32_bf16 v[92:95], a[156:159], v[158:161], v[92:95]
    s_mov_b32 s46, 0x20000
    s_mov_b32 s47, 0x00020000
    s_add_u32 s8, s4, 0x1048000
    s_addc_u32 s9, s5, 0
    v_mfma_f32_16x16x32_bf16 v[96:99], a[160:163], v[158:161], v[96:99]
    s_mov_b32 s10, 0x280000
    buffer_load_dwordx4 a[152:155], v144, s[84:87], s83 offen offset:2048 sc1
    v_mfma_f32_16x16x32_bf16 v[100:103], a[164:167], v[158:161], v[100:103]
    s_mov_b32 s11, 0x00020000
    v_mfma_f32_16x16x32_bf16 v[104:107], a[168:171], v[158:161], v[104:107]
    v_mfma_f32_16x16x32_bf16 v[108:111], a[172:175], v[158:161], v[108:111]
    v_mfma_f32_16x16x32_bf16 v[124:127], v[12:15], v[158:161], v[124:127]
    ds_read_b64_tr_b16 v[150:151], v9 offset:8192
    ds_read_b64_tr_b16 v[152:153], v9 offset:8704
    v_mfma_f32_16x16x32_bf16 v[140:143], v[158:161], v[158:161], v[140:143]
    s_waitcnt lgkmcnt(2)
    v_mfma_f32_16x16x32_bf16 v[32:35], a[176:179], v[146:149], v[32:35]
    buffer_load_dwordx4 a[156:159], v144, s[84:87], s83 offen offset:2560 sc1
    v_mfma_f32_16x16x32_bf16 v[36:39], a[180:183], v[146:149], v[36:39]
    v_mfma_f32_16x16x32_bf16 v[40:43], a[184:187], v[146:149], v[40:43]
    v_mfma_f32_16x16x32_bf16 v[44:47], a[188:191], v[146:149], v[44:47]
    v_mfma_f32_16x16x32_bf16 v[48:51], a[192:195], v[146:149], v[48:51]
    buffer_load_dwordx4 a[160:163], v144, s[84:87], s83 offen offset:3072 sc1
    v_mfma_f32_16x16x32_bf16 v[112:115], v[12:15], v[146:149], v[112:115]
    ds_read_b64_tr_b16 v[154:155], v10 offset:8192
    ds_read_b64_tr_b16 v[156:157], v10 offset:8704
    v_mfma_f32_16x16x32_bf16 v[128:131], v[146:149], v[146:149], v[128:131]
    s_waitcnt lgkmcnt(2)
    v_mfma_f32_16x16x32_bf16 v[52:55], a[176:179], v[150:153], v[52:55]
    v_mfma_f32_16x16x32_bf16 v[56:59], a[180:183], v[150:153], v[56:59]
    v_mfma_f32_16x16x32_bf16 v[60:63], a[184:187], v[150:153], v[60:63]
    buffer_load_dwordx4 a[164:167], v144, s[84:87], s83 offen offset:3584 sc1
    v_mfma_f32_16x16x32_bf16 v[64:67], a[188:191], v[150:153], v[64:67]
    v_mfma_f32_16x16x32_bf16 v[68:71], a[192:195], v[150:153], v[68:71]
    v_mfma_f32_16x16x32_bf16 v[116:119], v[12:15], v[150:153], v[116:119]
    ds_read_b64_tr_b16 v[158:159], v11 offset:8192
    ds_read_b64_tr_b16 v[160:161], v11 offset:8704
    v_mfma_f32_16x16x32_bf16 v[132:135], v[150:153], v[150:153], v[132:135]
    s_waitcnt lgkmcnt(2)
    v_mfma_f32_16x16x32_bf16 v[72:75], a[176:179], v[154:157], v[72:75]
    s_add_u32 s83, s81, 16896
    buffer_load_dwordx4 a[168:171], v144, s[84:87], s83 offen offset:0 sc1
    v_mfma_f32_16x16x32_bf16 v[76:79], a[180:183], v[154:157], v[76:79]
    v_mfma_f32_16x16x32_bf16 v[80:83], a[184:187], v[154:157], v[80:83]
    v_mfma_f32_16x16x32_bf16 v[84:87], a[188:191], v[154:157], v[84:87]
    v_mfma_f32_16x16x32_bf16 v[88:91], a[192:195], v[154:157], v[88:91]
    v_mfma_f32_16x16x32_bf16 v[120:123], v[12:15], v[154:157], v[120:123]
    s_waitcnt vmcnt(13)
    buffer_load_dwordx4 a[172:175], v144, s[84:87], s83 offen offset:512 sc1
    v_mfma_f32_16x16x32_bf16 v[136:139], v[154:157], v[154:157], v[136:139]
    s_waitcnt lgkmcnt(0)
    ds_read_b64_tr_b16 v[162:163], v8 offset:12288
    ds_read_b64_tr_b16 v[164:165], v8 offset:12800
    v_mfma_f32_16x16x32_bf16 v[92:95], a[176:179], v[158:161], v[92:95]
    s_waitcnt vmcnt(10)
    ds_read_b64_tr_b16 v[166:167], v8 offset:16384
    ds_read_b64_tr_b16 v[168:169], v8 offset:16896
    v_mfma_f32_16x16x32_bf16 v[96:99], a[180:183], v[158:161], v[96:99]
    v_mfma_f32_16x16x32_bf16 v[100:103], a[184:187], v[158:161], v[100:103]
    ds_read_b64_tr_b16 v[146:147], v9 offset:12288
    ds_read_b64_tr_b16 v[148:149], v9 offset:12800
    v_mfma_f32_16x16x32_bf16 v[104:107], a[188:191], v[158:161], v[104:107]
    v_mfma_f32_16x16x32_bf16 v[108:111], a[192:195], v[158:161], v[108:111]
    v_mfma_f32_16x16x32_bf16 v[124:127], v[12:15], v[158:161], v[124:127]
    v_mfma_f32_16x16x32_bf16 v[140:143], v[158:161], v[158:161], v[140:143]
    s_waitcnt lgkmcnt(4)
    v_mfma_f32_16x16x32_bf16 v[112:115], v[12:15], v[162:165], v[112:115]
    buffer_load_dwordx4 a[176:179], v144, s[84:87], s83 offen offset:1024 sc1
    v_mfma_f32_16x16x32_bf16 v[128:131], v[162:165], v[162:165], v[128:131]
    s_waitcnt lgkmcnt(2)
    buffer_load_dwordx4 a[180:183], v144, s[84:87], s83 offen offset:1536 sc1
    v_mfma_f32_16x16x32_bf16 v[112:115], v[12:15], v[166:169], v[112:115]
    ds_read_b64_tr_b16 v[150:151], v9 offset:16384
    ds_read_b64_tr_b16 v[152:153], v9 offset:16896
    v_mfma_f32_16x16x32_bf16 v[128:131], v[166:169], v[166:169], v[128:131]
    s_waitcnt lgkmcnt(2)
    v_mfma_f32_16x16x32_bf16 v[116:119], v[12:15], v[146:149], v[116:119]
    v_mfma_f32_16x16x32_bf16 v[132:135], v[146:149], v[146:149], v[132:135]
    v_mfma_f32_16x16x32_bf16 v[52:55], a[196:199], v[146:149], v[52:55]
    buffer_load_dwordx4 a[184:187], v144, s[84:87], s83 offen offset:2048 sc1
    v_mfma_f32_16x16x32_bf16 v[56:59], a[200:203], v[146:149], v[56:59]
    s_nop 1
    ds_write_b128 v172, v[128:131] offset:15360
    v_mfma_f32_16x16x32_bf16 v[60:63], a[204:207], v[146:149], v[60:63]
    ds_write_b32 v28, v112 offset:15360
    v_mfma_f32_16x16x32_bf16 v[64:67], a[208:211], v[146:149], v[64:67]
    ds_read_b64_tr_b16 v[154:155], v10 offset:12288
    ds_read_b64_tr_b16 v[156:157], v10 offset:12800
    v_mfma_f32_16x16x32_bf16 v[68:71], a[212:215], v[146:149], v[68:71]
    s_waitcnt lgkmcnt(4)
    v_mfma_f32_16x16x32_bf16 v[116:119], v[12:15], v[150:153], v[116:119]
    buffer_load_dwordx4 a[188:191], v144, s[84:87], s83 offen offset:2560 sc1
    v_mfma_f32_16x16x32_bf16 v[132:135], v[150:153], v[150:153], v[132:135]
    v_mfma_f32_16x16x32_bf16 v[52:55], a[216:219], v[150:153], v[52:55]
    v_mfma_f32_16x16x32_bf16 v[56:59], a[220:223], v[150:153], v[56:59]
    v_mfma_f32_16x16x32_bf16 v[60:63], a[224:227], v[150:153], v[60:63]
    v_mfma_f32_16x16x32_bf16 v[64:67], a[228:231], v[150:153], v[64:67]
    buffer_load_dwordx4 a[192:195], v144, s[84:87], s83 offen offset:3072 sc1
    v_mfma_f32_16x16x32_bf16 v[68:71], a[232:235], v[150:153], v[68:71]
    s_waitcnt lgkmcnt(0)
    s_nop 0
    ds_write_b128 v173, v[132:135] offset:16384
    v_mfma_f32_16x16x32_bf16 v[120:123], v[12:15], v[154:157], v[120:123]
    ds_write_b32 v29, v116 offset:16384
    ds_read_b64_tr_b16 v[158:159], v10 offset:16384
    v_mfma_f32_16x16x32_bf16 v[136:139], v[154:157], v[154:157], v[136:139]
    ds_write_b128 v173, v[52:55] offset:0
    v_mfma_f32_16x16x32_bf16 v[72:75], a[196:199], v[154:157], v[72:75]
    ds_read_b64_tr_b16 v[160:161], v10 offset:16896
    v_mfma_f32_16x16x32_bf16 v[76:79], a[200:203], v[154:157], v[76:79]
    ds_write_b128 v173, v[56:59] offset:1024
    v_mfma_f32_16x16x32_bf16 v[80:83], a[204:207], v[154:157], v[80:83]
    ds_write_b128 v173, v[60:63] offset:2048
    v_mfma_f32_16x16x32_bf16 v[84:87], a[208:211], v[154:157], v[84:87]
    ds_write_b128 v173, v[64:67] offset:3072
    v_mfma_f32_16x16x32_bf16 v[88:91], a[212:215], v[154:157], v[88:91]
    s_waitcnt lgkmcnt(3)
    ds_write_b128 v173, v[68:71] offset:4096
    v_mfma_f32_16x16x32_bf16 v[120:123], v[12:15], v[158:161], v[120:123]
    ds_read_b64_tr_b16 v[146:147], v11 offset:12288
    ds_read_b64_tr_b16 v[148:149], v11 offset:12800
    v_mfma_f32_16x16x32_bf16 v[136:139], v[158:161], v[158:161], v[136:139]
    v_mfma_f32_16x16x32_bf16 v[72:75], a[216:219], v[158:161], v[72:75]
    v_mfma_f32_16x16x32_bf16 v[76:79], a[220:223], v[158:161], v[76:79]
    v_mfma_f32_16x16x32_bf16 v[80:83], a[224:227], v[158:161], v[80:83]
    v_mfma_f32_16x16x32_bf16 v[84:87], a[228:231], v[158:161], v[84:87]
    s_nop 3
    ds_write_b128 v174, v[136:139] offset:17408
    v_mfma_f32_16x16x32_bf16 v[88:91], a[232:235], v[158:161], v[88:91]
    s_waitcnt lgkmcnt(1)
    ds_write_b32 v30, v120 offset:17408
    ds_read_b64_tr_b16 v[150:151], v11 offset:16384
    v_mfma_f32_16x16x32_bf16 v[124:127], v[12:15], v[146:149], v[124:127]
    ds_write_b128 v174, v[72:75] offset:5120
    v_mfma_f32_16x16x32_bf16 v[140:143], v[146:149], v[146:149], v[140:143]
    ds_read_b64_tr_b16 v[152:153], v11 offset:16896
    v_mfma_f32_16x16x32_bf16 v[92:95], a[196:199], v[146:149], v[92:95]
    ds_write_b128 v174, v[76:79] offset:6144
    v_mfma_f32_16x16x32_bf16 v[96:99], a[200:203], v[146:149], v[96:99]
    ds_write_b128 v174, v[80:83] offset:7168
    v_mfma_f32_16x16x32_bf16 v[100:103], a[204:207], v[146:149], v[100:103]
    ds_write_b128 v174, v[84:87] offset:8192
    v_mfma_f32_16x16x32_bf16 v[104:107], a[208:211], v[146:149], v[104:107]
    ds_write_b128 v174, v[88:91] offset:9216
    v_mfma_f32_16x16x32_bf16 v[108:111], a[212:215], v[146:149], v[108:111]
    s_waitcnt lgkmcnt(4)
    v_mfma_f32_16x16x32_bf16 v[124:127], v[12:15], v[150:153], v[124:127]
    v_mfma_f32_16x16x32_bf16 v[140:143], v[150:153], v[150:153], v[140:143]
    v_mfma_f32_16x16x32_bf16 v[92:95], a[216:219], v[150:153], v[92:95]
    v_mfma_f32_16x16x32_bf16 v[96:99], a[220:223], v[150:153], v[96:99]
    v_mfma_f32_16x16x32_bf16 v[100:103], a[224:227], v[150:153], v[100:103]
    v_mfma_f32_16x16x32_bf16 v[104:107], a[228:231], v[150:153], v[104:107]
    s_nop 3
    ds_write_b128 v175, v[140:143] offset:18432
    v_mfma_f32_16x16x32_bf16 v[108:111], a[232:235], v[150:153], v[108:111]
    ds_write_b32 v31, v124 offset:18432
    v_mfma_f32_16x16x32_bf16 v[32:35], a[196:199], v[162:165], v[32:35]
    ds_write_b128 v175, v[92:95] offset:10240
    v_mfma_f32_16x16x32_bf16 v[36:39], a[200:203], v[162:165], v[36:39]
    ds_write_b128 v175, v[96:99] offset:11264
    v_mfma_f32_16x16x32_bf16 v[40:43], a[204:207], v[162:165], v[40:43]
    ds_write_b128 v175, v[100:103] offset:12288
    v_mfma_f32_16x16x32_bf16 v[44:47], a[208:211], v[162:165], v[44:47]
    ds_write_b128 v175, v[104:107] offset:13312
    v_mfma_f32_16x16x32_bf16 v[48:51], a[212:215], v[162:165], v[48:51]
    ds_write_b128 v175, v[108:111] offset:14336
    s_waitcnt lgkmcnt(0)
    s_barrier
    ds_read_b64 v[112:113], v18 offset:15360
    ds_read_b64 v[114:115], v18 offset:16384
    ds_read_b64 v[116:117], v18 offset:17408
    ds_read_b64 v[118:119], v18 offset:18432
    ds_read_b128 v[52:55], v172 offset:0
    ds_read_b128 v[72:75], v172 offset:5120
    ds_read_b128 v[92:95], v172 offset:10240
    ds_read_b128 v[56:59], v172 offset:1024
    ds_read_b128 v[76:79], v172 offset:6144
    ds_read_b128 v[96:99], v172 offset:11264
    ds_read_b128 v[60:63], v172 offset:2048
    ds_read_b128 v[80:83], v172 offset:7168
    ds_read_b128 v[100:103], v172 offset:12288
    ds_read_b128 v[64:67], v172 offset:3072
    ds_read_b128 v[84:87], v172 offset:8192
    ds_read_b128 v[104:107], v172 offset:13312
    ds_read_b128 v[68:71], v172 offset:4096
    ds_read_b128 v[88:91], v172 offset:9216
    ds_read_b128 v[108:111], v172 offset:14336
    v_mfma_f32_16x16x32_bf16 v[32:35], a[216:219], v[166:169], v[32:35]
    v_mfma_f32_16x16x32_bf16 v[36:39], a[220:223], v[166:169], v[36:39]
    v_mfma_f32_16x16x32_bf16 v[40:43], a[224:227], v[166:169], v[40:43]
    v_mfma_f32_16x16x32_bf16 v[44:47], a[228:231], v[166:169], v[44:47]
    v_mfma_f32_16x16x32_bf16 v[48:51], a[232:235], v[166:169], v[48:51]
    s_cmp_lt_u32 s69, 2
    s_cselect_b32 s76, 1, 0
    s_waitcnt lgkmcnt(15)
    v_pk_add_f32 v[112:113], v[112:113], v[114:115]
    v_pk_add_f32 v[116:117], v[116:117], v[118:119]
    v_pk_add_f32 v[112:113], v[112:113], v[116:117]
    v_cndmask_b32 v25, v113, v112, s[66:67]
    v_cndmask_b32 v27, v112, v113, s[66:67]
    v_mul_f32 v25, 0x3acccccd, v25
    v_mul_f32 v27, 0x3acccccd, v27
    v_fma_f32 v27, -v25, v25, v27
    v_max_f32 v27, 0, v27
    v_cvt_pk_bf16_f32 v24, v25, v25
    v_lshlrev_b32 v24, 16, v24
    v_cvt_pk_bf16_f32 v29, v27, v27
    v_lshlrev_b32 v29, 16, v29
    v_add_f32 v29, 0x3727c5ac, v29
    v_cvt_pk_bf16_f32 v29, v29, v29
    v_lshlrev_b32 v29, 16, v29
    v_sqrt_f32 v29, v29
    s_nop 0
    v_cvt_pk_bf16_f32 v29, v29, v29
    v_lshlrev_b32 v29, 16, v29
    v_rcp_f32 v26, v29
    v_sub_f32 v23, v25, v24
    v_mul_f32 v23, v23, v26
    v_mul_f32 v27, v27, v26
    v_mul_f32 v27, v27, v26
    v_cvt_pk_bf16_f32 v23, v23, v23
    v_lshlrev_b32 v23, 16, v23
    v_cvt_pk_bf16_f32 v31, v27, v27
    v_lshlrev_b32 v31, 16, v31
    v_add_f32 v31, 0x3727c5ac, v31
    v_cvt_pk_bf16_f32 v31, v31, v31
    v_lshlrev_b32 v31, 16, v31
    v_sqrt_f32 v31, v31
    s_nop 0
    v_cvt_pk_bf16_f32 v31, v31, v31
    v_lshlrev_b32 v31, 16, v31
    v_mul_f32 v122, v29, v31
    v_fma_f32 v28, v23, v29, v24
    v_rcp_f32 v22, v122
    v_cndmask_b32 v122, v17, v122, vcc
    v_cndmask_b32 v22, 0, v22, vcc
    v_mul_f32 v121, v22, v22
    v_mul_f32 v120, s91, v22
    v_mul_f32 v121, v121, v22
    v_mul_f32 v121, s90, v121
    s_waitcnt lgkmcnt(12)
    v_pk_add_f32 v[32:33], v[32:33], v[52:53]
    v_pk_add_f32 v[72:73], v[72:73], v[92:93]
    v_pk_fma_f32 v[32:33], v[192:193], v[28:29], v[32:33] op_sel_hi:[1,0,1] neg_lo:[1,0,0] neg_hi:[1,0,0]
    v_pk_add_f32 v[34:35], v[34:35], v[54:55]
    v_pk_add_f32 v[74:75], v[74:75], v[94:95]
    v_pk_fma_f32 v[34:35], v[194:195], v[28:29], v[34:35] op_sel_hi:[1,0,1] neg_lo:[1,0,0] neg_hi:[1,0,0]
    v_pk_add_f32 v[32:33], v[32:33], v[72:73]
    v_pk_add_f32 v[34:35], v[34:35], v[74:75]
    v_pk_mul_f32 v[140:141], v[32:33], v[32:33]
    v_pk_mul_f32 v[142:143], v[34:35], v[34:35]
    v_pk_fma_f32 v[140:141], v[140:141], v[120:121], v[120:121] op_sel:[0,1,0] op_sel_hi:[1,1,0]
    v_pk_fma_f32 v[142:143], v[142:143], v[120:121], v[120:121] op_sel:[0,1,0] op_sel_hi:[1,1,0]
    v_pk_mul_f32 v[140:141], v[140:141], v[32:33]
    v_pk_mul_f32 v[142:143], v[142:143], v[34:35]
    v_exp_f32 v140, v140
    v_exp_f32 v141, v141
    v_exp_f32 v142, v142
    v_exp_f32 v143, v143
    v_pk_fma_f32 v[140:141], v[140:141], v[122:123], v[122:123] op_sel_hi:[1,0,0]
    v_pk_fma_f32 v[142:143], v[142:143], v[122:123], v[122:123] op_sel_hi:[1,0,0]
    v_rcp_f32 v140, v140
    v_rcp_f32 v141, v141
    v_rcp_f32 v142, v142
    v_rcp_f32 v143, v143
    v_pk_mul_f32 v[32:33], v[32:33], v[140:141]
    v_pk_mul_f32 v[34:35], v[34:35], v[142:143]
    v_cvt_pk_bf16_f32 v128, v32, v33
    v_cvt_pk_bf16_f32 v129, v34, v35
    buffer_store_dwordx2 v[128:129], v21, s[16:19], s60 offen sc1
    s_waitcnt lgkmcnt(9)
    v_pk_add_f32 v[36:37], v[36:37], v[56:57]
    v_pk_add_f32 v[76:77], v[76:77], v[96:97]
    v_pk_fma_f32 v[36:37], v[196:197], v[28:29], v[36:37] op_sel_hi:[1,0,1] neg_lo:[1,0,0] neg_hi:[1,0,0]
    v_pk_add_f32 v[38:39], v[38:39], v[58:59]
    v_pk_add_f32 v[78:79], v[78:79], v[98:99]
    v_pk_fma_f32 v[38:39], v[198:199], v[28:29], v[38:39] op_sel_hi:[1,0,1] neg_lo:[1,0,0] neg_hi:[1,0,0]
    v_pk_add_f32 v[36:37], v[36:37], v[76:77]
    v_pk_add_f32 v[38:39], v[38:39], v[78:79]
    v_pk_mul_f32 v[124:125], v[36:37], v[36:37]
    v_pk_mul_f32 v[126:127], v[38:39], v[38:39]
    v_pk_fma_f32 v[124:125], v[124:125], v[120:121], v[120:121] op_sel:[0,1,0] op_sel_hi:[1,1,0]
    v_pk_fma_f32 v[126:127], v[126:127], v[120:121], v[120:121] op_sel:[0,1,0] op_sel_hi:[1,1,0]
    v_pk_mul_f32 v[124:125], v[124:125], v[36:37]
    v_pk_mul_f32 v[126:127], v[126:127], v[38:39]
    v_exp_f32 v124, v124
    v_exp_f32 v125, v125
    v_exp_f32 v126, v126
    v_exp_f32 v127, v127
    v_pk_fma_f32 v[124:125], v[124:125], v[122:123], v[122:123] op_sel_hi:[1,0,0]
    v_pk_fma_f32 v[126:127], v[126:127], v[122:123], v[122:123] op_sel_hi:[1,0,0]
    v_rcp_f32 v124, v124
    v_rcp_f32 v125, v125
    v_rcp_f32 v126, v126
    v_rcp_f32 v127, v127
    v_pk_mul_f32 v[36:37], v[36:37], v[124:125]
    v_pk_mul_f32 v[38:39], v[38:39], v[126:127]
    v_cvt_pk_bf16_f32 v130, v36, v37
    v_cvt_pk_bf16_f32 v131, v38, v39
    buffer_store_dwordx2 v[130:131], v21, s[16:19], s61 offen sc1
    s_waitcnt lgkmcnt(6)
    v_pk_add_f32 v[40:41], v[40:41], v[60:61]
    v_pk_add_f32 v[80:81], v[80:81], v[100:101]
    v_pk_fma_f32 v[40:41], v[200:201], v[28:29], v[40:41] op_sel_hi:[1,0,1] neg_lo:[1,0,0] neg_hi:[1,0,0]
    v_pk_add_f32 v[42:43], v[42:43], v[62:63]
    v_pk_add_f32 v[82:83], v[82:83], v[102:103]
    v_pk_fma_f32 v[42:43], v[202:203], v[28:29], v[42:43] op_sel_hi:[1,0,1] neg_lo:[1,0,0] neg_hi:[1,0,0]
    v_pk_add_f32 v[40:41], v[40:41], v[80:81]
    v_pk_add_f32 v[42:43], v[42:43], v[82:83]
    v_pk_mul_f32 v[140:141], v[40:41], v[40:41]
    v_pk_mul_f32 v[142:143], v[42:43], v[42:43]
    v_pk_fma_f32 v[140:141], v[140:141], v[120:121], v[120:121] op_sel:[0,1,0] op_sel_hi:[1,1,0]
    v_pk_fma_f32 v[142:143], v[142:143], v[120:121], v[120:121] op_sel:[0,1,0] op_sel_hi:[1,1,0]
    v_pk_mul_f32 v[140:141], v[140:141], v[40:41]
    v_pk_mul_f32 v[142:143], v[142:143], v[42:43]
    v_exp_f32 v140, v140
    v_exp_f32 v141, v141
    v_exp_f32 v142, v142
    v_exp_f32 v143, v143
    v_pk_fma_f32 v[140:141], v[140:141], v[122:123], v[122:123] op_sel_hi:[1,0,0]
    v_pk_fma_f32 v[142:143], v[142:143], v[122:123], v[122:123] op_sel_hi:[1,0,0]
    v_rcp_f32 v140, v140
    v_rcp_f32 v141, v141
    v_rcp_f32 v142, v142
    v_rcp_f32 v143, v143
    v_pk_mul_f32 v[40:41], v[40:41], v[140:141]
    v_pk_mul_f32 v[42:43], v[42:43], v[142:143]
    v_cvt_pk_bf16_f32 v132, v40, v41
    v_cvt_pk_bf16_f32 v133, v42, v43
    buffer_store_dwordx2 v[132:133], v21, s[16:19], s62 offen sc1
    s_waitcnt lgkmcnt(3)
    v_pk_add_f32 v[44:45], v[44:45], v[64:65]
    v_pk_add_f32 v[84:85], v[84:85], v[104:105]
    v_pk_fma_f32 v[44:45], v[204:205], v[28:29], v[44:45] op_sel_hi:[1,0,1] neg_lo:[1,0,0] neg_hi:[1,0,0]
    v_pk_add_f32 v[46:47], v[46:47], v[66:67]
    v_pk_add_f32 v[86:87], v[86:87], v[106:107]
    v_pk_fma_f32 v[46:47], v[206:207], v[28:29], v[46:47] op_sel_hi:[1,0,1] neg_lo:[1,0,0] neg_hi:[1,0,0]
    v_pk_add_f32 v[44:45], v[44:45], v[84:85]
    v_pk_add_f32 v[46:47], v[46:47], v[86:87]
    v_pk_mul_f32 v[124:125], v[44:45], v[44:45]
    v_pk_mul_f32 v[126:127], v[46:47], v[46:47]
    v_pk_fma_f32 v[124:125], v[124:125], v[120:121], v[120:121] op_sel:[0,1,0] op_sel_hi:[1,1,0]
    v_pk_fma_f32 v[126:127], v[126:127], v[120:121], v[120:121] op_sel:[0,1,0] op_sel_hi:[1,1,0]
    v_pk_mul_f32 v[124:125], v[124:125], v[44:45]
    v_pk_mul_f32 v[126:127], v[126:127], v[46:47]
    v_exp_f32 v124, v124
    v_exp_f32 v125, v125
    v_exp_f32 v126, v126
    v_exp_f32 v127, v127
    v_pk_fma_f32 v[124:125], v[124:125], v[122:123], v[122:123] op_sel_hi:[1,0,0]
    v_pk_fma_f32 v[126:127], v[126:127], v[122:123], v[122:123] op_sel_hi:[1,0,0]
    v_rcp_f32 v124, v124
    v_rcp_f32 v125, v125
    v_rcp_f32 v126, v126
    v_rcp_f32 v127, v127
    v_pk_mul_f32 v[44:45], v[44:45], v[124:125]
    v_pk_mul_f32 v[46:47], v[46:47], v[126:127]
    v_cvt_pk_bf16_f32 v134, v44, v45
    v_cvt_pk_bf16_f32 v135, v46, v47
    buffer_store_dwordx2 v[134:135], v21, s[16:19], s63 offen sc1
    s_waitcnt lgkmcnt(0)
    v_pk_add_f32 v[48:49], v[48:49], v[68:69]
    v_pk_add_f32 v[88:89], v[88:89], v[108:109]
    v_pk_fma_f32 v[48:49], v[208:209], v[28:29], v[48:49] op_sel_hi:[1,0,1] neg_lo:[1,0,0] neg_hi:[1,0,0]
    v_pk_add_f32 v[50:51], v[50:51], v[70:71]
    v_pk_add_f32 v[90:91], v[90:91], v[110:111]
    v_pk_fma_f32 v[50:51], v[210:211], v[28:29], v[50:51] op_sel_hi:[1,0,1] neg_lo:[1,0,0] neg_hi:[1,0,0]
    v_pk_add_f32 v[48:49], v[48:49], v[88:89]
    v_pk_add_f32 v[50:51], v[50:51], v[90:91]
    v_pk_mul_f32 v[140:141], v[48:49], v[48:49]
    v_pk_mul_f32 v[142:143], v[50:51], v[50:51]
    v_pk_fma_f32 v[140:141], v[140:141], v[120:121], v[120:121] op_sel:[0,1,0] op_sel_hi:[1,1,0]
    v_pk_fma_f32 v[142:143], v[142:143], v[120:121], v[120:121] op_sel:[0,1,0] op_sel_hi:[1,1,0]
    v_pk_mul_f32 v[140:141], v[140:141], v[48:49]
    v_pk_mul_f32 v[142:143], v[142:143], v[50:51]
    v_exp_f32 v140, v140
    v_exp_f32 v141, v141
    v_exp_f32 v142, v142
    v_exp_f32 v143, v143
    v_pk_fma_f32 v[140:141], v[140:141], v[122:123], v[122:123] op_sel_hi:[1,0,0]
    v_pk_fma_f32 v[142:143], v[142:143], v[122:123], v[122:123] op_sel_hi:[1,0,0]
    v_rcp_f32 v140, v140
    v_rcp_f32 v141, v141
    v_rcp_f32 v142, v142
    v_rcp_f32 v143, v143
    v_pk_mul_f32 v[48:49], v[48:49], v[140:141]
    v_pk_mul_f32 v[50:51], v[50:51], v[142:143]
    v_cvt_pk_bf16_f32 v136, v48, v49
    v_cvt_pk_bf16_f32 v137, v50, v51
    buffer_store_dwordx2 v[136:137], v21, s[16:19], s64 offen sc1
    ds_read_b64_tr_b16 v[156:157], v16 offset:0
    ds_read_b64_tr_b16 v[158:159], v16 offset:2048
    ds_read_b64_tr_b16 v[160:161], v16 offset:4096
    ds_read_b64_tr_b16 v[162:163], v16 offset:6144
    ds_read_b64_tr_b16 v[164:165], v16 offset:8192
    v_mul_f32 v25, -v24, v26
    s_lshl_b32 s75, s65, 2
    s_add_u32 s75, s75, 8192
    s_add_u32 s29, s75, 16384
    v_mov_b32 v23, s88
    s_waitcnt vmcnt(0)
    s_mov_b64 exec, 1
    buffer_store_dword v23, off, s[92:95], s29
    s_cmp_eq_u32 s76, 0
    s_cbranch_scc1 mk_se57
    buffer_store_dword v23, off, s[92:95], s75 sc1
mk_se57:
    s_mov_b64 exec, -1
    buffer_load_dword v30, v170, s[92:95], 0 offen sc1
    s_add_u32 s83, s74, 0
    buffer_load_dwordx4 a[196:199], v144, s[84:87], s83 offen offset:0 sc1
    buffer_load_dwordx4 a[200:203], v144, s[84:87], s83 offen offset:512 sc1
    buffer_load_dwordx4 a[204:207], v144, s[84:87], s83 offen offset:1024 sc1
    buffer_load_dwordx4 a[208:211], v144, s[84:87], s83 offen offset:1536 sc1
    buffer_load_dwordx4 a[212:215], v144, s[84:87], s83 offen offset:2048 sc1
    buffer_load_dwordx4 a[216:219], v144, s[84:87], s83 offen offset:2560 sc1
    buffer_load_dwordx4 a[220:223], v144, s[84:87], s83 offen offset:3072 sc1
    buffer_load_dwordx4 a[224:227], v144, s[84:87], s83 offen offset:3584 sc1
    s_add_u32 s83, s74, 4096
    buffer_load_dwordx4 a[228:231], v144, s[84:87], s83 offen offset:0 sc1
    buffer_load_dwordx4 a[232:235], v144, s[84:87], s83 offen offset:512 sc1
    buffer_load_dwordx4 v[192:195], v144, s[84:87], s83 offen offset:1024 sc1
    buffer_load_dwordx4 v[196:199], v144, s[84:87], s83 offen offset:1536 sc1
    buffer_load_dwordx4 v[200:203], v144, s[84:87], s83 offen offset:2048 sc1
    buffer_load_dwordx4 v[204:207], v144, s[84:87], s83 offen offset:2560 sc1
    buffer_load_dwordx4 v[208:211], v144, s[84:87], s83 offen offset:3072 sc1
    v_add_u32 v4, s27, v3
    v_mov_b32 v5, v20
    v_lshlrev_b32 v12, 3, v6
    s_waitcnt lgkmcnt(0)
    s_barrier
    s_waitcnt vmcnt(15)
    v_cmp_ne_u32 vcc, s88, v30
    s_cbranch_vccz mk_eg58
    buffer_load_dword v30, v170, s[92:95], 0 offen sc1
    v_mfma_f32_16x16x32_bf16 v[176:179], v[188:191], a[136:139], v[176:179]
    v_lshlrev_b32 v32, 16, v156
    v_and_b32 v33, 0xffff0000, v156
    v_mfma_f32_16x16x32_bf16 v[176:179], v[188:191], a[140:143], v[176:179]
    v_lshlrev_b32 v34, 16, v157
    v_and_b32 v35, 0xffff0000, v157
    v_mfma_f32_16x16x32_bf16 v[176:179], v[188:191], a[144:147], v[176:179]
    v_fma_f32 v32, v32, v26, v25
    v_fma_f32 v33, v33, v26, v25
    v_mfma_f32_16x16x32_bf16 v[176:179], v[188:191], a[148:151], v[176:179]
    v_fma_f32 v34, v34, v26, v25
    v_fma_f32 v35, v35, v26, v25
    v_mfma_f32_16x16x32_bf16 v[176:179], v[188:191], a[152:155], v[176:179]
    v_lshlrev_b32 v36, 16, v158
    v_and_b32 v37, 0xffff0000, v158
    v_mfma_f32_16x16x32_bf16 v[176:179], v[188:191], a[156:159], v[176:179]
    v_lshlrev_b32 v38, 16, v159
    v_and_b32 v39, 0xffff0000, v159
    v_mfma_f32_16x16x32_bf16 v[176:179], v[188:191], a[160:163], v[176:179]
    v_fma_f32 v36, v36, v26, v25
    v_fma_f32 v37, v37, v26, v25
    v_mfma_f32_16x16x32_bf16 v[176:179], v[188:191], a[164:167], v[176:179]
    v_fma_f32 v38, v38, v26, v25
    v_fma_f32 v39, v39, v26, v25
    v_mfma_f32_16x16x32_bf16 v[176:179], v[188:191], a[168:171], v[176:179]
    v_lshlrev_b32 v40, 16, v160
    v_and_b32 v41, 0xffff0000, v160
    v_mfma_f32_16x16x32_bf16 v[176:179], v[188:191], a[172:175], v[176:179]
    v_lshlrev_b32 v42, 16, v161
    v_and_b32 v43, 0xffff0000, v161
    v_mfma_f32_16x16x32_bf16 v[176:179], v[188:191], a[176:179], v[176:179]
    v_fma_f32 v40, v40, v26, v25
    v_fma_f32 v41, v41, v26, v25
    v_mfma_f32_16x16x32_bf16 v[176:179], v[188:191], a[180:183], v[176:179]
    v_fma_f32 v42, v42, v26, v25
    v_fma_f32 v43, v43, v26, v25
    v_mfma_f32_16x16x32_bf16 v[176:179], v[188:191], a[184:187], v[176:179]
    v_lshlrev_b32 v44, 16, v162
    v_and_b32 v45, 0xffff0000, v162
    v_mfma_f32_16x16x32_bf16 v[176:179], v[188:191], a[188:191], v[176:179]
    v_lshlrev_b32 v46, 16, v163
    v_and_b32 v47, 0xffff0000, v163
    v_mfma_f32_16x16x32_bf16 v[176:179], v[188:191], a[192:195], v[176:179]
    v_fma_f32 v44, v44, v26, v25
    v_fma_f32 v45, v45, v26, v25
    v_fma_f32 v46, v46, v26, v25
    v_fma_f32 v47, v47, v26, v25
    v_lshlrev_b32 v48, 16, v164
    v_and_b32 v49, 0xffff0000, v164
    v_lshlrev_b32 v50, 16, v165
    v_and_b32 v51, 0xffff0000, v165
    v_fma_f32 v48, v48, v26, v25
    v_fma_f32 v49, v49, v26, v25
    v_fma_f32 v50, v50, v26, v25
    v_fma_f32 v51, v51, v26, v25
    s_mov_b32 s89, 0x40000
    s_mov_b64 s[98:99], -1
mk_pq60:
    s_waitcnt vmcnt(0)
    v_cmp_ne_u32 vcc, s88, v30
    s_sub_u32 s89, s89, 1
    s_and_b64 s[98:99], vcc, s[98:99]
    s_cbranch_scc0 mk_pqd61
    s_and_b32 s28, s89, 7
    s_cbranch_scc1 mk_pqf62
    s_mov_b64 exec, 1
    buffer_store_dword v23, off, s[92:95], s75 sc1
    s_mov_b64 exec, -1
    buffer_load_dword v30, v171, s[92:95], 0 offen sc1
    s_cmp_lg_u32 s89, 0
    s_cbranch_scc1 mk_pq60
    s_branch mk_pqd61
mk_pqf62:
    buffer_load_dword v30, v170, s[92:95], 0 offen sc1
    s_branch mk_pq60
mk_pqd61:
    s_add_u32 m0, s27, 1024
    s_add_u32 s28, s35, 0
    buffer_load_dwordx4 v3, s[8:11], s28 offen sc1 lds
    s_add_u32 m0, s27, 2048
    s_add_u32 s28, s36, 0
    buffer_load_dwordx4 v3, s[8:11], s28 offen sc1 lds
    s_add_u32 m0, s27, 3072
    s_add_u32 s28, s37, 0
    buffer_load_dwordx4 v3, s[8:11], s28 offen sc1 lds
    s_add_u32 m0, s27, 0
    s_add_u32 s28, s34, 0
    buffer_load_dwordx4 v3, s[8:11], s28 offen sc1 lds
    s_add_u32 m0, s27, 5120
    s_add_u32 s28, s35, 1024
    buffer_load_dwordx4 v3, s[8:11], s28 offen sc1 lds
    s_add_u32 m0, s27, 6144
    s_add_u32 s28, s36, 1024
    buffer_load_dwordx4 v3, s[8:11], s28 offen sc1 lds
    s_add_u32 m0, s27, 7168
    s_add_u32 s28, s37, 1024
    buffer_load_dwordx4 v3, s[8:11], s28 offen sc1 lds
    s_add_u32 m0, s27, 4096
    s_add_u32 s28, s34, 1024
    buffer_load_dwordx4 v3, s[8:11], s28 offen sc1 lds
    s_add_u32 m0, s27, 9216
    s_add_u32 s28, s35, 2048
    buffer_load_dwordx4 v3, s[8:11], s28 offen sc1 lds
    s_add_u32 m0, s27, 10240
    s_add_u32 s28, s36, 2048
    buffer_load_dwordx4 v3, s[8:11], s28 offen sc1 lds
    s_add_u32 m0, s27, 11264
    s_add_u32 s28, s37, 2048
    buffer_load_dwordx4 v3, s[8:11], s28 offen sc1 lds
    s_add_u32 m0, s27, 8192
    s_add_u32 s28, s34, 2048
    buffer_load_dwordx4 v3, s[8:11], s28 offen sc1 lds
    s_add_u32 m0, s27, 13312
    s_add_u32 s28, s35, 3072
    buffer_load_dwordx4 v3, s[8:11], s28 offen sc1 lds
    s_add_u32 m0, s27, 17408
    s_add_u32 s28, s35, 4096
    buffer_load_dwordx4 v3, s[8:11], s28 offen sc1 lds
    s_add_u32 m0, s27, 14336
    s_add_u32 s28, s36, 3072
    buffer_load_dwordx4 v3, s[8:11], s28 offen sc1 lds
    s_add_u32 m0, s27, 18432
    s_add_u32 s28, s36, 4096
    buffer_load_dwordx4 v3, s[8:11], s28 offen sc1 lds
    s_add_u32 m0, s27, 15360
    s_add_u32 s28, s37, 3072
    buffer_load_dwordx4 v3, s[8:11], s28 offen sc1 lds
    s_add_u32 m0, s27, 19456
    s_add_u32 s28, s37, 4096
    buffer_load_dwordx4 v3, s[8:11], s28 offen sc1 lds
    s_add_u32 m0, s27, 12288
    s_add_u32 s28, s34, 3072
    buffer_load_dwordx4 v3, s[8:11], s28 offen sc1 lds
    s_add_u32 m0, s27, 16384
    s_add_u32 s28, s34, 4096
    buffer_load_dwordx4 v3, s[8:11], s28 offen sc1 lds
    s_branch mk_ej59
mk_eg58:
    s_add_u32 m0, s27, 1024
    s_add_u32 s28, s35, 0
    buffer_load_dwordx4 v3, s[8:11], s28 offen sc1 lds
    s_add_u32 m0, s27, 2048
    s_add_u32 s28, s36, 0
    buffer_load_dwordx4 v3, s[8:11], s28 offen sc1 lds
    s_add_u32 m0, s27, 3072
    s_add_u32 s28, s37, 0
    buffer_load_dwordx4 v3, s[8:11], s28 offen sc1 lds
    s_add_u32 m0, s27, 0
    s_add_u32 s28, s34, 0
    buffer_load_dwordx4 v3, s[8:11], s28 offen sc1 lds
    s_add_u32 m0, s27, 5120
    s_add_u32 s28, s35, 1024
    buffer_load_dwordx4 v3, s[8:11], s28 offen sc1 lds
    s_add_u32 m0, s27, 6144
    s_add_u32 s28, s36, 1024
    buffer_load_dwordx4 v3, s[8:11], s28 offen sc1 lds
    s_add_u32 m0, s27, 7168
    s_add_u32 s28, s37, 1024
    buffer_load_dwordx4 v3, s[8:11], s28 offen sc1 lds
    s_add_u32 m0, s27, 4096
    s_add_u32 s28, s34, 1024
    buffer_load_dwordx4 v3, s[8:11], s28 offen sc1 lds
    s_add_u32 m0, s27, 9216
    s_add_u32 s28, s35, 2048
    buffer_load_dwordx4 v3, s[8:11], s28 offen sc1 lds
    s_add_u32 m0, s27, 10240
    s_add_u32 s28, s36, 2048
    buffer_load_dwordx4 v3, s[8:11], s28 offen sc1 lds
    s_add_u32 m0, s27, 11264
    s_add_u32 s28, s37, 2048
    buffer_load_dwordx4 v3, s[8:11], s28 offen sc1 lds
    s_add_u32 m0, s27, 8192
    s_add_u32 s28, s34, 2048
    buffer_load_dwordx4 v3, s[8:11], s28 offen sc1 lds
    s_add_u32 m0, s27, 13312
    s_add_u32 s28, s35, 3072
    buffer_load_dwordx4 v3, s[8:11], s28 offen sc1 lds
    s_add_u32 m0, s27, 17408
    s_add_u32 s28, s35, 4096
    buffer_load_dwordx4 v3, s[8:11], s28 offen sc1 lds
    s_add_u32 m0, s27, 14336
    s_add_u32 s28, s36, 3072
    buffer_load_dwordx4 v3, s[8:11], s28 offen sc1 lds
    s_add_u32 m0, s27, 18432
    s_add_u32 s28, s36, 4096
    buffer_load_dwordx4 v3, s[8:11], s28 offen sc1 lds
    s_add_u32 m0, s27, 15360
    s_add_u32 s28, s37, 3072
    buffer_load_dwordx4 v3, s[8:11], s28 offen sc1 lds
    s_add_u32 m0, s27, 19456
    s_add_u32 s28, s37, 4096
    buffer_load_dwordx4 v3, s[8:11], s28 offen sc1 lds
    s_add_u32 m0, s27, 12288
    s_add_u32 s28, s34, 3072
    buffer_load_dwordx4 v3, s[8:11], s28 offen sc1 lds
    s_add_u32 m0, s27, 16384
    s_add_u32 s28, s34, 4096
    buffer_load_dwordx4 v3, s[8:11], s28 offen sc1 lds
    v_mfma_f32_16x16x32_bf16 v[176:179], v[188:191], a[136:139], v[176:179]
    v_lshlrev_b32 v32, 16, v156
    v_and_b32 v33, 0xffff0000, v156
    v_mfma_f32_16x16x32_bf16 v[176:179], v[188:191], a[140:143], v[176:179]
    v_lshlrev_b32 v34, 16, v157
    v_and_b32 v35, 0xffff0000, v157
    v_mfma_f32_16x16x32_bf16 v[176:179], v[188:191], a[144:147], v[176:179]
    v_fma_f32 v32, v32, v26, v25
    v_fma_f32 v33, v33, v26, v25
    v_mfma_f32_16x16x32_bf16 v[176:179], v[188:191], a[148:151], v[176:179]
    v_fma_f32 v34, v34, v26, v25
    v_fma_f32 v35, v35, v26, v25
    v_mfma_f32_16x16x32_bf16 v[176:179], v[188:191], a[152:155], v[176:179]
    v_lshlrev_b32 v36, 16, v158
    v_and_b32 v37, 0xffff0000, v158
    v_mfma_f32_16x16x32_bf16 v[176:179], v[188:191], a[156:159], v[176:179]
    v_lshlrev_b32 v38, 16, v159
    v_and_b32 v39, 0xffff0000, v159
    v_mfma_f32_16x16x32_bf16 v[176:179], v[188:191], a[160:163], v[176:179]
    v_fma_f32 v36, v36, v26, v25
    v_fma_f32 v37, v37, v26, v25
    v_mfma_f32_16x16x32_bf16 v[176:179], v[188:191], a[164:167], v[176:179]
    v_fma_f32 v38, v38, v26, v25
    v_fma_f32 v39, v39, v26, v25
    v_mfma_f32_16x16x32_bf16 v[176:179], v[188:191], a[168:171], v[176:179]
    v_lshlrev_b32 v40, 16, v160
    v_and_b32 v41, 0xffff0000, v160
    v_mfma_f32_16x16x32_bf16 v[176:179], v[188:191], a[172:175], v[176:179]
    v_lshlrev_b32 v42, 16, v161
    v_and_b32 v43, 0xffff0000, v161
    v_mfma_f32_16x16x32_bf16 v[176:179], v[188:191], a[176:179], v[176:179]
    v_fma_f32 v40, v40, v26, v25
    v_fma_f32 v41, v41, v26, v25
    v_mfma_f32_16x16x32_bf16 v[176:179], v[188:191], a[180:183], v[176:179]
    v_fma_f32 v42, v42, v26, v25
    v_fma_f32 v43, v43, v26, v25
    v_mfma_f32_16x16x32_bf16 v[176:179], v[188:191], a[184:187], v[176:179]
    v_lshlrev_b32 v44, 16, v162
    v_and_b32 v45, 0xffff0000, v162
    v_mfma_f32_16x16x32_bf16 v[176:179], v[188:191], a[188:191], v[176:179]
    v_lshlrev_b32 v46, 16, v163
    v_and_b32 v47, 0xffff0000, v163
    v_mfma_f32_16x16x32_bf16 v[176:179], v[188:191], a[192:195], v[176:179]
    v_fma_f32 v44, v44, v26, v25
    v_fma_f32 v45, v45, v26, v25
    v_fma_f32 v46, v46, v26, v25
    v_fma_f32 v47, v47, v26, v25
    v_lshlrev_b32 v48, 16, v164
    v_and_b32 v49, 0xffff0000, v164
    v_lshlrev_b32 v50, 16, v165
    v_and_b32 v51, 0xffff0000, v165
    v_fma_f32 v48, v48, v26, v25
    v_fma_f32 v49, v49, v26, v25
    v_fma_f32 v50, v50, v26, v25
    v_fma_f32 v51, v51, v26, v25
mk_ej59:
    s_waitcnt vmcnt(18)
    ds_read_b128 v[112:115], v4 offset:1024
    ds_read_b128 v[116:119], v4 offset:2048
    s_waitcnt lgkmcnt(1)
    v_mfma_f32_16x16x32_bf16 v[52:55], a[36:39], v[112:115], 0
    v_mfma_f32_16x16x32_bf16 v[56:59], a[40:43], v[112:115], 0
    v_mfma_f32_16x16x32_bf16 v[60:63], a[44:47], v[112:115], 0
    s_waitcnt vmcnt(16)
    ds_read_b128 v[120:123], v4 offset:3072
    s_add_u32 s8, s4, 0x17c8000
    s_addc_u32 s9, s5, 0
    v_mfma_f32_16x16x32_bf16 v[64:67], a[48:51], v[112:115], 0
    s_mov_b32 s10, 0x280000
    s_mov_b32 s11, 0x00020000
    s_add_u32 s16, s4, 0x1a48000
    s_addc_u32 s17, s5, 0
    v_mfma_f32_16x16x32_bf16 v[68:71], a[52:55], v[112:115], 0
    s_waitcnt lgkmcnt(1)
    s_getpc_b64 s[56:57]
mk_pc63:
    s_add_u32 s56, s56, mk_c3 - mk_pc63
    s_addc_u32 s57, s57, 0
    s_mov_b32 s58, mk_exit - mk_c3
    s_mov_b32 s59, 0x00020000
    s_lshr_b32 s83, s2, 3
    s_lshl_b32 s83, s83, 2
    s_add_u32 s83, s83, s3
    s_lshl_b32 s83, s83, 10
    buffer_load_dword v145, v3, s[56:59], s83 offen
    v_mfma_f32_16x16x32_bf16 v[72:75], a[36:39], v[116:119], 0
    s_mov_b32 s18, 0x6c0000
    s_mov_b32 s19, 0x00020000
    v_and_b32 v14, 31, v0
    v_mfma_f32_16x16x32_bf16 v[76:79], a[40:43], v[116:119], 0
    s_lshl_b32 s28, s22, 7
    s_add_u32 s28, s28, 12288
    v_lshl_add_u32 v14, v14, 2, s28
    v_mfma_f32_16x16x32_bf16 v[80:83], a[44:47], v[116:119], 0
    ds_read_b128 v[124:127], v4 offset:0
    v_add_u32 v13, 16384, v14
    v_mfma_f32_16x16x32_bf16 v[84:87], a[48:51], v[116:119], 0
    s_lshl_b32 s27, s3, 11
    s_mul_i32 s35, s22, 81920
    s_add_u32 s26, s35, s27
    v_mfma_f32_16x16x32_bf16 v[88:91], a[52:55], v[116:119], 0
    s_waitcnt lgkmcnt(1)
    s_mul_i32 s34, s3, 3072
    s_add_u32 s34, s34, 8192
    v_mfma_f32_16x16x32_bf16 v[92:95], a[36:39], v[120:123], 0
    s_add_u32 s35, s35, s34
    s_lshl_b32 s36, s22, 12
    v_lshrrev_b32 v19, 1, v7
    v_mfma_f32_16x16x32_bf16 v[96:99], a[40:43], v[120:123], 0
    v_and_b32 v21, 1, v7
    v_lshlrev_b32 v17, 11, v19
    v_mfma_f32_16x16x32_bf16 v[100:103], a[44:47], v[120:123], 0
    s_waitcnt vmcnt(15)
    ds_read_b128 v[128:131], v4 offset:5120
    v_lshl_add_u32 v17, v21, 7, v17
    v_mfma_f32_16x16x32_bf16 v[104:107], a[48:51], v[120:123], 0
    v_lshl_add_u32 v17, v6, 3, v17
    v_lshlrev_b32 v19, 8, v19
    v_mfma_f32_16x16x32_bf16 v[108:111], a[52:55], v[120:123], 0
    s_waitcnt lgkmcnt(1)
    v_lshl_add_u32 v19, v6, 4, v19
    v_mul_u32_u24 v20, 55296, v21
    v_mfma_f32_16x16x32_bf16 v[32:35], a[36:39], v[124:127], v[32:35]
    v_add_u32 v20, v20, v19
    v_mul_u32_u24 v8, 20480, v21
    v_mfma_f32_16x16x32_bf16 v[36:39], a[40:43], v[124:127], v[36:39]
    v_add_u32 v8, v8, v19
    s_mul_i32 s29, s22, 221184
    v_mfma_f32_16x16x32_bf16 v[40:43], a[44:47], v[124:127], v[40:43]
    s_lshl_b32 s28, s23, 2
    ds_read_b128 v[132:135], v4 offset:6144
    s_add_u32 s28, s28, s3
    v_mfma_f32_16x16x32_bf16 v[44:47], a[48:51], v[124:127], v[44:47]
    s_lshl_b32 s72, s28, 2
    s_lshl_b32 s28, s28, 10
    s_add_u32 s37, s29, s28
    v_mfma_f32_16x16x32_bf16 v[48:51], a[52:55], v[124:127], v[48:51]
    s_waitcnt lgkmcnt(1)
    s_add_u32 s38, s37, 110592
    s_lshl_b32 s28, s78, 10
    v_mfma_f32_16x16x32_bf16 v[52:55], a[56:59], v[128:131], v[52:55]
    s_add_u32 s28, s28, 32768
    s_add_u32 s39, s29, s28
    s_cmp_eq_u32 s78, 31
    s_cselect_b32 s39, 0x40000000, s39
    v_mfma_f32_16x16x32_bf16 v[56:59], a[60:63], v[128:131], v[56:59]
    s_add_u32 s40, s39, 110592
    s_lshl_b32 s42, s22, 9
    s_add_u32 s42, s42, 40960
    v_mfma_f32_16x16x32_bf16 v[60:63], a[64:67], v[128:131], v[60:63]
    s_add_u32 s83, s74, 7680
    buffer_load_dwordx4 a[36:39], v144, s[84:87], s83 offen offset:0 sc1
    v_mfma_f32_16x16x32_bf16 v[64:67], a[68:71], v[128:131], v[64:67]
    s_waitcnt vmcnt(14)
    ds_read_b128 v[136:139], v4 offset:7168
    s_add_u32 s72, s72, s42
    v_mfma_f32_16x16x32_bf16 v[68:71], a[72:75], v[128:131], v[68:71]
    s_waitcnt lgkmcnt(1)
    s_lshl_b32 s71, s78, 2
    s_add_u32 s71, s71, s42
    v_mfma_f32_16x16x32_bf16 v[72:75], a[56:59], v[132:135], v[72:75]
    s_mul_i32 s41, s3, 20480
    s_add_u32 s41, s41, 81920
    v_add_u32 v9, s41, v3
    v_mfma_f32_16x16x32_bf16 v[76:79], a[60:63], v[132:135], v[76:79]
    s_add_u32 s25, s77, 4096
    buffer_load_dwordx4 a[40:43], v144, s[84:87], s83 offen offset:512 sc1
    v_mfma_f32_16x16x32_bf16 v[80:83], a[64:67], v[132:135], v[80:83]
    ds_read_b128 v[140:143], v4 offset:4096
    v_add_u32 v10, s25, v3
    v_mfma_f32_16x16x32_bf16 v[84:87], a[68:71], v[132:135], v[84:87]
    s_lshl_b32 s25, s3, 13
    s_lshl_b32 s28, s79, 10
    s_add_u32 s28, s28, 32768
    v_mfma_f32_16x16x32_bf16 v[88:91], a[72:75], v[132:135], v[88:91]
    s_waitcnt lgkmcnt(1)
    buffer_load_dwordx4 a[44:47], v144, s[84:87], s83 offen offset:1024 sc1
    v_mfma_f32_16x16x32_bf16 v[92:95], a[56:59], v[136:139], v[92:95]
    s_and_b32 s43, s3, 1
    s_xor_b32 s48, s43, 0
    s_mul_i32 s48, s48, 55296
    v_mfma_f32_16x16x32_bf16 v[96:99], a[60:63], v[136:139], v[96:99]
    s_add_u32 s48, s48, s29
    s_add_u32 s52, s48, s28
    s_add_u32 s48, s48, s25
    v_mfma_f32_16x16x32_bf16 v[100:103], a[64:67], v[136:139], v[100:103]
    s_waitcnt vmcnt(14)
    ds_read_b128 v[112:115], v4 offset:9216
    s_xor_b32 s49, s43, 1
    v_mfma_f32_16x16x32_bf16 v[104:107], a[68:71], v[136:139], v[104:107]
    s_mul_i32 s49, s49, 55296
    buffer_load_dwordx4 a[48:51], v144, s[84:87], s83 offen offset:1536 sc1
    v_mfma_f32_16x16x32_bf16 v[108:111], a[72:75], v[136:139], v[108:111]
    s_waitcnt lgkmcnt(1)
    s_add_u32 s49, s49, s29
    s_add_u32 s53, s49, s28
    v_mfma_f32_16x16x32_bf16 v[32:35], a[56:59], v[140:143], v[32:35]
    s_add_u32 s49, s49, s25
    s_xor_b32 s50, s43, 2
    s_mul_i32 s50, s50, 55296
    v_mfma_f32_16x16x32_bf16 v[36:39], a[60:63], v[140:143], v[36:39]
    s_add_u32 s50, s50, s29
    buffer_load_dwordx4 a[52:55], v144, s[84:87], s83 offen offset:2048 sc1
    v_mfma_f32_16x16x32_bf16 v[40:43], a[64:67], v[140:143], v[40:43]
    s_add_u32 s54, s50, s28
    ds_read_b128 v[116:119], v4 offset:10240
    s_add_u32 s50, s50, s25
    v_mfma_f32_16x16x32_bf16 v[44:47], a[68:71], v[140:143], v[44:47]
    s_xor_b32 s51, s43, 3
    s_mul_i32 s51, s51, 55296
    s_add_u32 s51, s51, s29
    v_mfma_f32_16x16x32_bf16 v[48:51], a[72:75], v[140:143], v[48:51]
    s_waitcnt lgkmcnt(1)
    s_add_u32 s55, s51, s28
    s_add_u32 s51, s51, s25
    v_mfma_f32_16x16x32_bf16 v[52:55], a[76:79], v[112:115], v[52:55]
    s_add_u32 s60, s82, 0
    buffer_load_dwordx4 a[56:59], v144, s[84:87], s83 offen offset:2560 sc1
    v_mfma_f32_16x16x32_bf16 v[56:59], a[80:83], v[112:115], v[56:59]
    s_add_u32 s65, s73, 0
    s_mov_b64 exec, 1
    buffer_store_dword v23, off, s[92:95], s75 sc1
    s_mov_b64 exec, -1
    v_mfma_f32_16x16x32_bf16 v[60:63], a[84:87], v[112:115], v[60:63]
    s_waitcnt vmcnt(16)
    ds_read_b128 v[120:123], v4 offset:11264
    s_add_u32 s61, s82, 55296
    v_mfma_f32_16x16x32_bf16 v[64:67], a[88:91], v[112:115], v[64:67]
    s_add_u32 s66, s73, 55296
    buffer_load_dwordx4 a[60:63], v144, s[84:87], s83 offen offset:3072 sc1
    v_mfma_f32_16x16x32_bf16 v[68:71], a[92:95], v[112:115], v[68:71]
    s_waitcnt lgkmcnt(1)
    s_add_u32 s62, s82, 110592
    s_add_u32 s67, s73, 110592
    v_mfma_f32_16x16x32_bf16 v[72:75], a[76:79], v[116:119], v[72:75]
    s_add_u32 s63, s82, 165888
    s_add_u32 s68, s73, 165888
    s_add_u32 s64, s82, 221184
    v_mfma_f32_16x16x32_bf16 v[76:79], a[80:83], v[116:119], v[76:79]
    s_add_u32 s69, s73, 221184
    buffer_load_dwordx4 a[64:67], v144, s[84:87], s83 offen offset:3584 sc1
    v_mfma_f32_16x16x32_bf16 v[80:83], a[84:87], v[116:119], v[80:83]
    ds_read_b128 v[124:127], v4 offset:8192
    v_and_b32 v15, 7, v0
    v_mfma_f32_16x16x32_bf16 v[84:87], a[88:91], v[116:119], v[84:87]
    s_lshl_b32 s58, s3, 5
    s_add_u32 s58, s58, s42
    v_lshl_add_u32 v22, v15, 2, s58
    v_mfma_f32_16x16x32_bf16 v[88:91], a[92:95], v[116:119], v[88:91]
    s_waitcnt lgkmcnt(1)
    s_cmp_lt_u32 s3, 2
    s_cselect_b32 s58, 5, 4
    v_min_u32 v15, s58, v15
    v_mfma_f32_16x16x32_bf16 v[92:95], a[76:79], v[120:123], v[92:95]
    s_add_u32 s83, s74, 11776
    buffer_load_dwordx4 a[68:71], v144, s[84:87], s83 offen offset:0 sc1
    v_mfma_f32_16x16x32_bf16 v[96:99], a[80:83], v[120:123], v[96:99]
    s_lshl_b32 s58, s79, 2
    s_add_u32 s58, s58, s42
    v_lshl_add_u32 v23, v15, 2, s58
    v_mfma_f32_16x16x32_bf16 v[100:103], a[84:87], v[120:123], v[100:103]
    s_waitcnt vmcnt(17)
    ds_read_b128 v[128:131], v4 offset:13312
    s_mov_b32 s56, 16384
    v_mfma_f32_16x16x32_bf16 v[104:107], a[88:91], v[120:123], v[104:107]
    buffer_load_dwordx4 a[72:75], v144, s[84:87], s83 offen offset:512 sc1
    v_mfma_f32_16x16x32_bf16 v[108:111], a[92:95], v[120:123], v[108:111]
    s_waitcnt lgkmcnt(1)
    v_add_u32 v18, 4096, v3
    v_mov_b32 v16, s72
    v_mfma_f32_16x16x32_bf16 v[32:35], a[76:79], v[124:127], v[32:35]
    v_mov_b32 v15, s71
    v_cmp_lt_u32 vcc, 1, v0
    v_mfma_f32_16x16x32_bf16 v[36:39], a[80:83], v[124:127], v[36:39]
    s_nop 0
    v_cndmask_b32 v16, v16, v15, vcc
    v_and_b32 v15, 3, v0
    v_mfma_f32_16x16x32_bf16 v[40:43], a[84:87], v[124:127], v[40:43]
    ds_read_b128 v[132:135], v4 offset:17408
    v_lshl_add_u32 v16, v15, 7, v16
    v_mfma_f32_16x16x32_bf16 v[44:47], a[88:91], v[124:127], v[44:47]
    s_lshl_b32 s58, s22, 6
    s_lshl_b32 s59, s3, 4
    s_add_u32 s58, s58, s59
    v_mfma_f32_16x16x32_bf16 v[48:51], a[92:95], v[124:127], v[48:51]
    s_waitcnt lgkmcnt(1)
    v_add_u32 v21, s58, v6
    v_mul_u32_u24 v21, 1280, v21
    v_mfma_f32_16x16x32_bf16 v[52:55], a[96:99], v[128:131], v[52:55]
    buffer_load_dwordx4 a[76:79], v144, s[84:87], s83 offen offset:1024 sc1
    v_mfma_f32_16x16x32_bf16 v[56:59], a[100:103], v[128:131], v[56:59]
    buffer_load_dwordx4 a[80:83], v144, s[84:87], s83 offen offset:1536 sc1
    v_mfma_f32_16x16x32_bf16 v[60:63], a[104:107], v[128:131], v[60:63]
    s_waitcnt vmcnt(18)
    ds_read_b128 v[136:139], v4 offset:14336
    v_lshl_add_u32 v21, v7, 3, v21
    v_mfma_f32_16x16x32_bf16 v[64:67], a[108:111], v[128:131], v[64:67]
    s_lshl_b32 s58, s24, 5
    v_add_u32 v21, s58, v21
    v_mfma_f32_16x16x32_bf16 v[68:71], a[112:115], v[128:131], v[68:71]
    s_waitcnt lgkmcnt(1)
    buffer_load_dwordx4 a[84:87], v144, s[84:87], s83 offen offset:2048 sc1
    v_mfma_f32_16x16x32_bf16 v[52:55], a[116:119], v[132:135], v[52:55]
    v_mfma_f32_16x16x32_bf16 v[56:59], a[120:123], v[132:135], v[56:59]
    v_mfma_f32_16x16x32_bf16 v[60:63], a[124:127], v[132:135], v[60:63]
    buffer_load_dwordx4 a[88:91], v144, s[84:87], s83 offen offset:2560 sc1
    v_mfma_f32_16x16x32_bf16 v[64:67], a[128:131], v[132:135], v[64:67]
    ds_read_b128 v[140:143], v4 offset:18432
    v_mfma_f32_16x16x32_bf16 v[68:71], a[132:135], v[132:135], v[68:71]
    s_waitcnt lgkmcnt(1)
    s_nop 0
    ds_write_b128 v173, v[52:55] offset:0
    v_mfma_f32_16x16x32_bf16 v[72:75], a[96:99], v[136:139], v[72:75]
    buffer_load_dwordx4 a[92:95], v144, s[84:87], s83 offen offset:3072 sc1
    v_mfma_f32_16x16x32_bf16 v[76:79], a[100:103], v[136:139], v[76:79]
    ds_write_b128 v173, v[56:59] offset:1024
    v_mfma_f32_16x16x32_bf16 v[80:83], a[104:107], v[136:139], v[80:83]
    s_waitcnt vmcnt(19)
    ds_write_b128 v173, v[60:63] offset:2048
    v_mfma_f32_16x16x32_bf16 v[84:87], a[108:111], v[136:139], v[84:87]
    ds_write_b128 v173, v[64:67] offset:3072
    v_mfma_f32_16x16x32_bf16 v[88:91], a[112:115], v[136:139], v[88:91]
    s_waitcnt lgkmcnt(4)
    ds_read_b128 v[112:115], v4 offset:15360
    v_mfma_f32_16x16x32_bf16 v[72:75], a[116:119], v[140:143], v[72:75]
    ds_write_b128 v173, v[68:71] offset:4096
    v_mfma_f32_16x16x32_bf16 v[76:79], a[120:123], v[140:143], v[76:79]
    v_mfma_f32_16x16x32_bf16 v[80:83], a[124:127], v[140:143], v[80:83]
    ds_read_b128 v[116:119], v4 offset:19456
    v_mfma_f32_16x16x32_bf16 v[84:87], a[128:131], v[140:143], v[84:87]
    v_mfma_f32_16x16x32_bf16 v[88:91], a[132:135], v[140:143], v[88:91]
    s_waitcnt lgkmcnt(2)
    s_nop 0
    ds_write_b128 v174, v[72:75] offset:5120
    v_mfma_f32_16x16x32_bf16 v[92:95], a[96:99], v[112:115], v[92:95]
    ds_write_b128 v174, v[76:79] offset:6144
    v_mfma_f32_16x16x32_bf16 v[96:99], a[100:103], v[112:115], v[96:99]
    ds_write_b128 v174, v[80:83] offset:7168
    v_mfma_f32_16x16x32_bf16 v[100:103], a[104:107], v[112:115], v[100:103]
    s_waitcnt vmcnt(17)
    ds_write_b128 v174, v[84:87] offset:8192
    v_mfma_f32_16x16x32_bf16 v[104:107], a[108:111], v[112:115], v[104:107]
    ds_read_b128 v[120:123], v4 offset:12288
    v_mfma_f32_16x16x32_bf16 v[108:111], a[112:115], v[112:115], v[108:111]
    s_waitcnt lgkmcnt(5)
    ds_write_b128 v174, v[88:91] offset:9216
    v_mfma_f32_16x16x32_bf16 v[92:95], a[116:119], v[116:119], v[92:95]
    v_mfma_f32_16x16x32_bf16 v[96:99], a[120:123], v[116:119], v[96:99]
    v_mfma_f32_16x16x32_bf16 v[100:103], a[124:127], v[116:119], v[100:103]
    ds_read_b128 v[124:127], v4 offset:16384
    v_mfma_f32_16x16x32_bf16 v[104:107], a[128:131], v[116:119], v[104:107]
    v_mfma_f32_16x16x32_bf16 v[108:111], a[132:135], v[116:119], v[108:111]
    s_waitcnt lgkmcnt(2)
    s_nop 1
    ds_write_b128 v175, v[92:95] offset:10240
    v_mfma_f32_16x16x32_bf16 v[32:35], a[96:99], v[120:123], v[32:35]
    ds_write_b128 v175, v[96:99] offset:11264
    v_mfma_f32_16x16x32_bf16 v[36:39], a[100:103], v[120:123], v[36:39]
    ds_write_b128 v175, v[100:103] offset:12288
    v_mfma_f32_16x16x32_bf16 v[40:43], a[104:107], v[120:123], v[40:43]
    ds_write_b128 v175, v[104:107] offset:13312
    v_mfma_f32_16x16x32_bf16 v[44:47], a[108:111], v[120:123], v[44:47]
    ds_write_b128 v175, v[108:111] offset:14336
    v_mfma_f32_16x16x32_bf16 v[48:51], a[112:115], v[120:123], v[48:51]
    s_waitcnt lgkmcnt(5)
    s_waitcnt lgkmcnt(0)
    s_barrier
    ds_read_b128 v[52:55], v172 offset:0
    ds_read_b128 v[72:75], v172 offset:5120
    ds_read_b128 v[92:95], v172 offset:10240
    ds_read_b128 v[56:59], v172 offset:1024
    ds_read_b128 v[76:79], v172 offset:6144
    ds_read_b128 v[96:99], v172 offset:11264
    ds_read_b128 v[60:63], v172 offset:2048
    ds_read_b128 v[80:83], v172 offset:7168
    ds_read_b128 v[100:103], v172 offset:12288
    ds_read_b128 v[64:67], v172 offset:3072
    ds_read_b128 v[84:87], v172 offset:8192
    ds_read_b128 v[104:107], v172 offset:13312
    ds_read_b128 v[68:71], v172 offset:4096
    ds_read_b128 v[88:91], v172 offset:9216
    ds_read_b128 v[108:111], v172 offset:14336
    v_mfma_f32_16x16x32_bf16 v[32:35], a[116:119], v[124:127], v[32:35]
    v_mfma_f32_16x16x32_bf16 v[36:39], a[120:123], v[124:127], v[36:39]
    v_mfma_f32_16x16x32_bf16 v[40:43], a[124:127], v[124:127], v[40:43]
    v_mfma_f32_16x16x32_bf16 v[44:47], a[128:131], v[124:127], v[44:47]
    v_mfma_f32_16x16x32_bf16 v[48:51], a[132:135], v[124:127], v[48:51]
    s_waitcnt lgkmcnt(12)
    s_nop 2
    v_pk_add_f32 v[32:33], v[32:33], v[52:53]
    v_pk_add_f32 v[72:73], v[72:73], v[92:93]
    v_pk_add_f32 v[34:35], v[34:35], v[54:55]
    v_pk_add_f32 v[74:75], v[74:75], v[94:95]
    v_pk_add_f32 v[32:33], v[32:33], v[72:73]
    v_pk_add_f32 v[34:35], v[34:35], v[74:75]
    v_cvt_pk_bf16_f32 v166, v32, v33
    v_cvt_pk_bf16_f32 v167, v34, v35
    buffer_store_dwordx2 v[166:167], v5, s[8:11], s12 offen sc1
    v_pk_add_f32 v[24:25], v[32:33], v[34:35]
    v_pk_mul_f32 v[26:27], v[32:33], v[32:33]
    v_pk_fma_f32 v[26:27], v[34:35], v[34:35], v[26:27]
    s_waitcnt lgkmcnt(9)
    v_pk_add_f32 v[36:37], v[36:37], v[56:57]
    v_pk_add_f32 v[76:77], v[76:77], v[96:97]
    v_pk_add_f32 v[38:39], v[38:39], v[58:59]
    v_pk_add_f32 v[78:79], v[78:79], v[98:99]
    v_pk_add_f32 v[36:37], v[36:37], v[76:77]
    v_pk_add_f32 v[38:39], v[38:39], v[78:79]
    v_cvt_pk_bf16_f32 v168, v36, v37
    v_cvt_pk_bf16_f32 v169, v38, v39
    buffer_store_dwordx2 v[168:169], v5, s[8:11], s13 offen sc1
    v_pk_add_f32 v[24:25], v[24:25], v[36:37]
    v_pk_fma_f32 v[26:27], v[36:37], v[36:37], v[26:27]
    v_pk_add_f32 v[24:25], v[24:25], v[38:39]
    v_pk_fma_f32 v[26:27], v[38:39], v[38:39], v[26:27]
    s_waitcnt lgkmcnt(6)
    v_pk_add_f32 v[40:41], v[40:41], v[60:61]
    v_pk_add_f32 v[80:81], v[80:81], v[100:101]
    v_pk_add_f32 v[42:43], v[42:43], v[62:63]
    v_pk_add_f32 v[82:83], v[82:83], v[102:103]
    v_pk_add_f32 v[40:41], v[40:41], v[80:81]
    v_pk_add_f32 v[42:43], v[42:43], v[82:83]
    v_cvt_pk_bf16_f32 v170, v40, v41
    v_cvt_pk_bf16_f32 v171, v42, v43
    buffer_store_dwordx2 v[170:171], v5, s[8:11], s14 offen sc1
    v_pk_add_f32 v[24:25], v[24:25], v[40:41]
    v_pk_fma_f32 v[26:27], v[40:41], v[40:41], v[26:27]
    v_pk_add_f32 v[24:25], v[24:25], v[42:43]
    v_pk_fma_f32 v[26:27], v[42:43], v[42:43], v[26:27]
    s_waitcnt lgkmcnt(3)
    v_pk_add_f32 v[44:45], v[44:45], v[64:65]
    v_pk_add_f32 v[84:85], v[84:85], v[104:105]
    v_pk_add_f32 v[46:47], v[46:47], v[66:67]
    v_pk_add_f32 v[86:87], v[86:87], v[106:107]
    v_pk_add_f32 v[44:45], v[44:45], v[84:85]
    v_pk_add_f32 v[46:47], v[46:47], v[86:87]
    v_cvt_pk_bf16_f32 v172, v44, v45
    v_cvt_pk_bf16_f32 v173, v46, v47
    buffer_store_dwordx2 v[172:173], v5, s[8:11], s15 offen sc1
    v_pk_add_f32 v[24:25], v[24:25], v[44:45]
    v_pk_fma_f32 v[26:27], v[44:45], v[44:45], v[26:27]
    v_pk_add_f32 v[24:25], v[24:25], v[46:47]
    v_pk_fma_f32 v[26:27], v[46:47], v[46:47], v[26:27]
    s_waitcnt lgkmcnt(0)
    v_pk_add_f32 v[48:49], v[48:49], v[68:69]
    v_pk_add_f32 v[88:89], v[88:89], v[108:109]
    v_pk_add_f32 v[50:51], v[50:51], v[70:71]
    v_pk_add_f32 v[90:91], v[90:91], v[110:111]
    v_pk_add_f32 v[48:49], v[48:49], v[88:89]
    v_pk_add_f32 v[50:51], v[50:51], v[90:91]
    v_cvt_pk_bf16_f32 v174, v48, v49
    v_cvt_pk_bf16_f32 v175, v50, v51
    buffer_store_dwordx2 v[174:175], v5, s[8:11], s20 offen sc1
    v_pk_add_f32 v[24:25], v[24:25], v[48:49]
    v_pk_fma_f32 v[26:27], v[48:49], v[48:49], v[26:27]
    v_pk_add_f32 v[24:25], v[24:25], v[50:51]
    v_pk_fma_f32 v[26:27], v[50:51], v[50:51], v[26:27]
    v_add_f32 v24, v24, v25
    v_add_f32 v25, v26, v27
    v_mov_b32 v26, v24
    v_mov_b32 v27, v25
    s_nop 0
    v_permlane32_swap_b32 v24, v26
    v_permlane32_swap_b32 v25, v27
    v_pk_add_f32 v[24:25], v[24:25], v[26:27]
    v_mov_b32 v26, v24
    v_mov_b32 v27, v25
    s_nop 0
    v_permlane16_swap_b32 v24, v26
    v_permlane16_swap_b32 v25, v27
    v_pk_add_f32 v[24:25], v[24:25], v[26:27]
    s_mov_b64 exec, 0xffff
    buffer_store_dwordx2 v[24:25], v12, s[44:47], s70 offen sc1
    s_mov_b64 exec, -1
    s_lshl_b32 s75, s21, 2
    s_add_u32 s75, s75, 12288
    s_add_u32 s29, s75, 16384
    v_mov_b32 v11, s88
    s_waitcnt vmcnt(0)
    s_mov_b64 exec, 1
    buffer_store_dword v11, off, s[92:95], s29
    s_mov_b64 exec, -1
mk_c3:
    buffer_load_dword v30, v13, s[92:95], 0 offen sc1
    s_add_u32 s83, s74, 15360
    buffer_load_dwordx4 a[96:99], v144, s[84:87], s83 offen offset:0 sc1
    buffer_load_dwordx4 a[100:103], v144, s[84:87], s83 offen offset:512 sc1
    buffer_load_dwordx4 a[104:107], v144, s[84:87], s83 offen offset:1024 sc1
    buffer_load_dwordx4 a[108:111], v144, s[84:87], s83 offen offset:1536 sc1
    buffer_load_dwordx4 a[112:115], v144, s[84:87], s83 offen offset:2048 sc1
    buffer_load_dwordx4 a[116:119], v144, s[84:87], s83 offen offset:2560 sc1
    buffer_load_dwordx4 a[120:123], v144, s[84:87], s83 offen offset:3072 sc1
    buffer_load_dwordx4 a[124:127], v144, s[84:87], s83 offen offset:3584 sc1
    s_add_u32 s83, s74, 19456
    buffer_load_dwordx4 a[128:131], v144, s[84:87], s83 offen offset:0 sc1
    buffer_load_dwordx4 a[132:135], v144, s[84:87], s83 offen offset:512 sc1
    s_branch mk_sk64
mk_ps70:
    s_mov_b32 s89, 0x40000
    s_mov_b64 s[98:99], vcc
mk_pf73:
    buffer_load_dword v31, v22, s[92:95], s56 offen offset:0 sc1
mk_pl72:
    s_waitcnt vmcnt(0)
    v_cmp_ne_u32 vcc, s88, v31
    s_sub_u32 s89, s89, 1
    s_and_b64 s[98:99], vcc, s[98:99]
    s_cbranch_scc0 mk_pd74
    s_and_b32 s57, s89, 7
    s_cbranch_scc1 mk_pf73
    s_mov_b64 exec, 1
    buffer_store_dword v11, v16, s[92:95], 0 offen sc1
    s_mov_b64 exec, -1
    buffer_load_dword v31, v22, s[92:95], 0 offen offset:0 sc1
    s_cmp_lg_u32 s89, 0
    s_cbranch_scc1 mk_pl72
mk_pd74:
    s_branch mk_pb71
mk_ps75:
    s_mov_b32 s89, 0x40000
    s_mov_b64 s[98:99], vcc
mk_pf78:
    buffer_load_dword v31, v22, s[92:95], s56 offen offset:128 sc1
mk_pl77:
    s_waitcnt vmcnt(0)
    v_cmp_ne_u32 vcc, s88, v31
    s_sub_u32 s89, s89, 1
    s_and_b64 s[98:99], vcc, s[98:99]
    s_cbranch_scc0 mk_pd79
    s_and_b32 s57, s89, 7
    s_cbranch_scc1 mk_pf78
    s_mov_b64 exec, 3
    buffer_store_dword v11, v16, s[92:95], 0 offen sc1
    s_mov_b64 exec, -1
    buffer_load_dword v31, v22, s[92:95], 0 offen offset:128 sc1
    s_cmp_lg_u32 s89, 0
    s_cbranch_scc1 mk_pl77
mk_pd79:
    s_branch mk_pb76
mk_ps80:
    s_mov_b32 s89, 0x40000
    s_mov_b64 s[98:99], vcc
mk_pf83:
    buffer_load_dword v31, v23, s[92:95], s56 offen offset:256 sc1
mk_pl82:
    s_waitcnt vmcnt(0)
    v_cmp_ne_u32 vcc, s88, v31
    s_sub_u32 s89, s89, 1
    s_and_b64 s[98:99], vcc, s[98:99]
    s_cbranch_scc0 mk_pd84
    s_and_b32 s57, s89, 7
    s_cbranch_scc1 mk_pf83
    s_mov_b64 exec, 15
    buffer_store_dword v11, v16, s[92:95], 0 offen sc1
    s_mov_b64 exec, -1
    buffer_load_dword v31, v23, s[92:95], 0 offen offset:256 sc1
    s_cmp_lg_u32 s89, 0
    s_cbranch_scc1 mk_pl82
mk_pd84:
    s_branch mk_pb81
mk_ps85:
    s_mov_b32 s89, 0x40000
    s_mov_b64 s[98:99], vcc
mk_pf88:
    buffer_load_dword v31, v23, s[92:95], s56 offen offset:384 sc1
mk_pl87:
    s_waitcnt vmcnt(0)
    v_cmp_ne_u32 vcc, s88, v31
    s_sub_u32 s89, s89, 1
    s_and_b64 s[98:99], vcc, s[98:99]
    s_cbranch_scc0 mk_pd89
    s_and_b32 s57, s89, 7
    s_cbranch_scc1 mk_pf88
    s_mov_b64 exec, 15
    buffer_store_dword v11, v16, s[92:95], 0 offen sc1
    s_mov_b64 exec, -1
    buffer_load_dword v31, v23, s[92:95], 0 offen offset:384 sc1
    s_cmp_lg_u32 s89, 0
    s_cbranch_scc1 mk_pl87
mk_pd89:
    s_branch mk_pb86
mk_sk64:
    s_waitcnt vmcnt(10)
    v_cmp_ne_u32 vcc, s88, v30
    s_cbranch_vccz mk_eg65
    buffer_load_dword v30, v13, s[92:95], 0 offen sc1
    v_mfma_f32_16x16x32_bf16 v[180:183], v[188:191], a[196:199], 0
    v_mfma_f32_16x16x32_bf16 v[180:183], v[188:191], a[200:203], v[180:183]
    v_mfma_f32_16x16x32_bf16 v[180:183], v[188:191], a[204:207], v[180:183]
    v_mfma_f32_16x16x32_bf16 v[180:183], v[188:191], a[208:211], v[180:183]
    v_mfma_f32_16x16x32_bf16 v[180:183], v[188:191], a[212:215], v[180:183]
    v_mfma_f32_16x16x32_bf16 v[180:183], v[188:191], a[216:219], v[180:183]
    v_mfma_f32_16x16x32_bf16 v[180:183], v[188:191], a[220:223], v[180:183]
    v_mfma_f32_16x16x32_bf16 v[180:183], v[188:191], a[224:227], v[180:183]
    v_mfma_f32_16x16x32_bf16 v[180:183], v[188:191], a[228:231], v[180:183]
    v_mfma_f32_16x16x32_bf16 v[180:183], v[188:191], a[232:235], v[180:183]
    v_mfma_f32_16x16x32_bf16 v[180:183], v[188:191], v[192:195], v[180:183]
    v_mfma_f32_16x16x32_bf16 v[180:183], v[188:191], v[196:199], v[180:183]
    v_mfma_f32_16x16x32_bf16 v[180:183], v[188:191], v[200:203], v[180:183]
    v_mfma_f32_16x16x32_bf16 v[180:183], v[188:191], v[204:207], v[180:183]
    v_mfma_f32_16x16x32_bf16 v[180:183], v[188:191], v[208:211], v[180:183]
    v_mfma_f32_16x16x32_bf16 v[180:183], v[188:191], a[36:39], v[180:183]
    v_mfma_f32_16x16x32_bf16 v[180:183], v[188:191], a[40:43], v[180:183]
    v_mfma_f32_16x16x32_bf16 v[180:183], v[188:191], a[44:47], v[180:183]
    v_mfma_f32_16x16x32_bf16 v[180:183], v[188:191], a[48:51], v[180:183]
    v_mfma_f32_16x16x32_bf16 v[180:183], v[188:191], a[52:55], v[180:183]
    v_mfma_f32_16x16x32_bf16 v[180:183], v[188:191], a[56:59], v[180:183]
    v_mfma_f32_16x16x32_bf16 v[180:183], v[188:191], a[60:63], v[180:183]
    v_mfma_f32_16x16x32_bf16 v[180:183], v[188:191], a[64:67], v[180:183]
    v_mfma_f32_16x16x32_bf16 v[180:183], v[188:191], a[68:71], v[180:183]
    v_mfma_f32_16x16x32_bf16 v[180:183], v[188:191], a[72:75], v[180:183]
    v_mfma_f32_16x16x32_bf16 v[180:183], v[188:191], a[76:79], v[180:183]
    v_mfma_f32_16x16x32_bf16 v[180:183], v[188:191], a[80:83], v[180:183]
    v_mfma_f32_16x16x32_bf16 v[180:183], v[188:191], a[84:87], v[180:183]
    v_mfma_f32_16x16x32_bf16 v[180:183], v[188:191], a[88:91], v[180:183]
    v_mfma_f32_16x16x32_bf16 v[180:183], v[188:191], a[92:95], v[180:183]
    s_mov_b32 s89, 0x40000
    s_mov_b64 s[98:99], -1
mk_pq67:
    s_waitcnt vmcnt(0)
    v_cmp_ne_u32 vcc, s88, v30
    s_sub_u32 s89, s89, 1
    s_and_b64 s[98:99], vcc, s[98:99]
    s_cbranch_scc0 mk_pqd68
    s_and_b32 s28, s89, 7
    s_cbranch_scc1 mk_pqf69
    s_mov_b64 exec, 1
    buffer_store_dword v11, off, s[92:95], s75 sc1
    s_mov_b64 exec, -1
    buffer_load_dword v30, v14, s[92:95], 0 offen sc1
    s_cmp_lg_u32 s89, 0
    s_cbranch_scc1 mk_pq67
    s_branch mk_pqd68
mk_pqf69:
    buffer_load_dword v30, v13, s[92:95], 0 offen sc1
    s_branch mk_pq67
mk_pqd68:
    s_add_u32 m0, s27, 0
    s_add_u32 s28, s26, 0
    buffer_load_dwordx4 v3, s[8:11], s28 offen offset:0 sc1 lds
    buffer_load_dwordx4 v3, s[8:11], s28 offen offset:1024 sc1 lds
    s_add_u32 m0, s27, 20480
    s_add_u32 s28, s26, 20480
    buffer_load_dwordx4 v3, s[8:11], s28 offen offset:0 sc1 lds
    buffer_load_dwordx4 v3, s[8:11], s28 offen offset:1024 sc1 lds
    s_add_u32 m0, s34, 0
    s_add_u32 s28, s35, 0
    buffer_load_dwordx4 v3, s[8:11], s28 offen offset:0 sc1 lds
    buffer_load_dwordx4 v3, s[8:11], s28 offen offset:1024 sc1 lds
    buffer_load_dwordx4 v3, s[8:11], s28 offen offset:2048 sc1 lds
    s_add_u32 m0, s34, 20480
    s_add_u32 s28, s35, 20480
    buffer_load_dwordx4 v3, s[8:11], s28 offen offset:0 sc1 lds
    buffer_load_dwordx4 v3, s[8:11], s28 offen offset:1024 sc1 lds
    buffer_load_dwordx4 v3, s[8:11], s28 offen offset:2048 sc1 lds
    buffer_load_dwordx2 v[112:113], v17, s[44:47], s36 offen offset:0 sc1
    buffer_load_dwordx2 v[114:115], v17, s[44:47], s36 offen offset:512 sc1
    buffer_load_dwordx2 v[116:117], v17, s[44:47], s36 offen offset:1024 sc1
    buffer_load_dwordx2 v[118:119], v17, s[44:47], s36 offen offset:1536 sc1
    buffer_load_dwordx2 v[120:121], v17, s[44:47], s36 offen offset:256 sc1
    buffer_load_dwordx2 v[122:123], v17, s[44:47], s36 offen offset:768 sc1
    buffer_load_dwordx2 v[124:125], v17, s[44:47], s36 offen offset:1280 sc1
    buffer_load_dwordx2 v[126:127], v17, s[44:47], s36 offen offset:1792 sc1
    s_add_u32 m0, s27, 40960
    s_add_u32 s28, s26, 40960
    buffer_load_dwordx4 v3, s[8:11], s28 offen offset:0 sc1 lds
    buffer_load_dwordx4 v3, s[8:11], s28 offen offset:1024 sc1 lds
    s_add_u32 m0, s34, 40960
    s_add_u32 s28, s35, 40960
    buffer_load_dwordx4 v3, s[8:11], s28 offen offset:0 sc1 lds
    buffer_load_dwordx4 v3, s[8:11], s28 offen offset:1024 sc1 lds
    buffer_load_dwordx4 v3, s[8:11], s28 offen offset:2048 sc1 lds
    s_add_u32 m0, s27, 61440
    s_add_u32 s28, s26, 61440
    buffer_load_dwordx4 v3, s[8:11], s28 offen offset:0 sc1 lds
    buffer_load_dwordx4 v3, s[8:11], s28 offen offset:1024 sc1 lds
    s_add_u32 m0, s34, 61440
    s_add_u32 s28, s35, 61440
    buffer_load_dwordx4 v3, s[8:11], s28 offen offset:0 sc1 lds
    buffer_load_dwordx4 v3, s[8:11], s28 offen offset:1024 sc1 lds
    buffer_load_dwordx4 v3, s[8:11], s28 offen offset:2048 sc1 lds
    s_branch mk_ej66
mk_eg65:
    s_add_u32 m0, s27, 0
    s_add_u32 s28, s26, 0
    buffer_load_dwordx4 v3, s[8:11], s28 offen offset:0 sc1 lds
    buffer_load_dwordx4 v3, s[8:11], s28 offen offset:1024 sc1 lds
    s_add_u32 m0, s27, 20480
    s_add_u32 s28, s26, 20480
    buffer_load_dwordx4 v3, s[8:11], s28 offen offset:0 sc1 lds
    buffer_load_dwordx4 v3, s[8:11], s28 offen offset:1024 sc1 lds
    s_add_u32 m0, s34, 0
    s_add_u32 s28, s35, 0
    buffer_load_dwordx4 v3, s[8:11], s28 offen offset:0 sc1 lds
    buffer_load_dwordx4 v3, s[8:11], s28 offen offset:1024 sc1 lds
    buffer_load_dwordx4 v3, s[8:11], s28 offen offset:2048 sc1 lds
    s_add_u32 m0, s34, 20480
    s_add_u32 s28, s35, 20480
    buffer_load_dwordx4 v3, s[8:11], s28 offen offset:0 sc1 lds
    buffer_load_dwordx4 v3, s[8:11], s28 offen offset:1024 sc1 lds
    buffer_load_dwordx4 v3, s[8:11], s28 offen offset:2048 sc1 lds
    buffer_load_dwordx2 v[112:113], v17, s[44:47], s36 offen offset:0 sc1
    buffer_load_dwordx2 v[114:115], v17, s[44:47], s36 offen offset:512 sc1
    buffer_load_dwordx2 v[116:117], v17, s[44:47], s36 offen offset:1024 sc1
    buffer_load_dwordx2 v[118:119], v17, s[44:47], s36 offen offset:1536 sc1
    buffer_load_dwordx2 v[120:121], v17, s[44:47], s36 offen offset:256 sc1
    buffer_load_dwordx2 v[122:123], v17, s[44:47], s36 offen offset:768 sc1
    buffer_load_dwordx2 v[124:125], v17, s[44:47], s36 offen offset:1280 sc1
    buffer_load_dwordx2 v[126:127], v17, s[44:47], s36 offen offset:1792 sc1
    s_add_u32 m0, s27, 40960
    s_add_u32 s28, s26, 40960
    buffer_load_dwordx4 v3, s[8:11], s28 offen offset:0 sc1 lds
    buffer_load_dwordx4 v3, s[8:11], s28 offen offset:1024 sc1 lds
    s_add_u32 m0, s34, 40960
    s_add_u32 s28, s35, 40960
    buffer_load_dwordx4 v3, s[8:11], s28 offen offset:0 sc1 lds
    buffer_load_dwordx4 v3, s[8:11], s28 offen offset:1024 sc1 lds
    buffer_load_dwordx4 v3, s[8:11], s28 offen offset:2048 sc1 lds
    s_add_u32 m0, s27, 61440
    s_add_u32 s28, s26, 61440
    buffer_load_dwordx4 v3, s[8:11], s28 offen offset:0 sc1 lds
    buffer_load_dwordx4 v3, s[8:11], s28 offen offset:1024 sc1 lds
    s_add_u32 m0, s34, 61440
    s_add_u32 s28, s35, 61440
    buffer_load_dwordx4 v3, s[8:11], s28 offen offset:0 sc1 lds
    buffer_load_dwordx4 v3, s[8:11], s28 offen offset:1024 sc1 lds
    buffer_load_dwordx4 v3, s[8:11], s28 offen offset:2048 sc1 lds
    v_mfma_f32_16x16x32_bf16 v[180:183], v[188:191], a[196:199], 0
    v_mfma_f32_16x16x32_bf16 v[180:183], v[188:191], a[200:203], v[180:183]
    v_mfma_f32_16x16x32_bf16 v[180:183], v[188:191], a[204:207], v[180:183]
    v_mfma_f32_16x16x32_bf16 v[180:183], v[188:191], a[208:211], v[180:183]
    v_mfma_f32_16x16x32_bf16 v[180:183], v[188:191], a[212:215], v[180:183]
    v_mfma_f32_16x16x32_bf16 v[180:183], v[188:191], a[216:219], v[180:183]
    v_mfma_f32_16x16x32_bf16 v[180:183], v[188:191], a[220:223], v[180:183]
    v_mfma_f32_16x16x32_bf16 v[180:183], v[188:191], a[224:227], v[180:183]
    v_mfma_f32_16x16x32_bf16 v[180:183], v[188:191], a[228:231], v[180:183]
    v_mfma_f32_16x16x32_bf16 v[180:183], v[188:191], a[232:235], v[180:183]
    v_mfma_f32_16x16x32_bf16 v[180:183], v[188:191], v[192:195], v[180:183]
    v_mfma_f32_16x16x32_bf16 v[180:183], v[188:191], v[196:199], v[180:183]
    v_mfma_f32_16x16x32_bf16 v[180:183], v[188:191], v[200:203], v[180:183]
    v_mfma_f32_16x16x32_bf16 v[180:183], v[188:191], v[204:207], v[180:183]
    v_mfma_f32_16x16x32_bf16 v[180:183], v[188:191], v[208:211], v[180:183]
    v_mfma_f32_16x16x32_bf16 v[180:183], v[188:191], a[36:39], v[180:183]
    v_mfma_f32_16x16x32_bf16 v[180:183], v[188:191], a[40:43], v[180:183]
    v_mfma_f32_16x16x32_bf16 v[180:183], v[188:191], a[44:47], v[180:183]
    v_mfma_f32_16x16x32_bf16 v[180:183], v[188:191], a[48:51], v[180:183]
    v_mfma_f32_16x16x32_bf16 v[180:183], v[188:191], a[52:55], v[180:183]
    v_mfma_f32_16x16x32_bf16 v[180:183], v[188:191], a[56:59], v[180:183]
    v_mfma_f32_16x16x32_bf16 v[180:183], v[188:191], a[60:63], v[180:183]
    v_mfma_f32_16x16x32_bf16 v[180:183], v[188:191], a[64:67], v[180:183]
    v_mfma_f32_16x16x32_bf16 v[180:183], v[188:191], a[68:71], v[180:183]
    v_mfma_f32_16x16x32_bf16 v[180:183], v[188:191], a[72:75], v[180:183]
    v_mfma_f32_16x16x32_bf16 v[180:183], v[188:191], a[76:79], v[180:183]
    v_mfma_f32_16x16x32_bf16 v[180:183], v[188:191], a[80:83], v[180:183]
    v_mfma_f32_16x16x32_bf16 v[180:183], v[188:191], a[84:87], v[180:183]
    v_mfma_f32_16x16x32_bf16 v[180:183], v[188:191], a[88:91], v[180:183]
    v_mfma_f32_16x16x32_bf16 v[180:183], v[188:191], a[92:95], v[180:183]
mk_ej66:
    s_mov_b32 s8, s6
    s_mov_b32 s9, s7
    s_mov_b32 s10, 0x280000
    s_mov_b32 s11, 0x00020000
    s_waitcnt vmcnt(28)
    v_mfma_f32_16x16x32_bf16 v[180:183], v[188:191], a[96:99], v[180:183]
    v_mfma_f32_16x16x32_bf16 v[180:183], v[188:191], a[100:103], v[180:183]
    v_mfma_f32_16x16x32_bf16 v[180:183], v[188:191], a[104:107], v[180:183]
    v_mfma_f32_16x16x32_bf16 v[180:183], v[188:191], a[108:111], v[180:183]
    v_mfma_f32_16x16x32_bf16 v[180:183], v[188:191], a[112:115], v[180:183]
    v_mfma_f32_16x16x32_bf16 v[180:183], v[188:191], a[116:119], v[180:183]
    v_mfma_f32_16x16x32_bf16 v[180:183], v[188:191], a[120:123], v[180:183]
    v_mfma_f32_16x16x32_bf16 v[180:183], v[188:191], a[124:127], v[180:183]
    v_mfma_f32_16x16x32_bf16 v[180:183], v[188:191], a[128:131], v[180:183]
    v_mfma_f32_16x16x32_bf16 v[180:183], v[188:191], a[132:135], v[180:183]
    s_waitcnt vmcnt(24)
    s_barrier
    ds_read_b128 v[96:99], v8 offset:0
    ds_read_b128 v[100:103], v8 offset:512
    ds_read_b128 v[104:107], v8 offset:1024
    ds_read_b128 v[108:111], v8 offset:1536
    ds_read_b128 v[64:67], v8 offset:2048
    ds_read_b128 v[68:71], v8 offset:2560
    s_waitcnt lgkmcnt(5)
    v_mfma_f32_32x32x16_bf16 v[72:87], v[212:215], v[96:99], 0
    s_waitcnt lgkmcnt(4)
    ds_read_b128 v[96:99], v8 offset:3072
    v_mfma_f32_32x32x16_bf16 v[72:87], v[216:219], v[100:103], v[72:87]
    s_waitcnt lgkmcnt(4)
    ds_read_b128 v[100:103], v8 offset:3584
    v_cvt_pk_bf16_f32 v177, v176, v176
    v_lshlrev_b32 v177, 16, v177
    v_sub_f32 v178, v176, v177
    v_cvt_pk_bf16_f32 v176, v176, v178
    v_and_b32 v177, 0xffff0000, v176
    v_mfma_f32_32x32x16_bf16 v[72:87], v[220:223], v[104:107], v[72:87]
    s_waitcnt lgkmcnt(4)
    ds_read_b128 v[104:107], v8 offset:4096
    s_add_u32 m0, s41, 0
    s_nop 0
    buffer_load_dwordx4 v3, s[84:87], s65 offen offset:0 sc1 lds
    v_sub_f32 v178, v178, v177
    v_mfma_f32_32x32x16_bf16 v[72:87], v[224:227], v[108:111], v[72:87]
    s_waitcnt lgkmcnt(4)
    ds_read_b128 v[108:111], v8 offset:4608
    v_mov_b32 v179, 0
    v_cvt_pk_bf16_f32 v177, v178, v179
    v_mov_b32 v178, 0
    v_cvt_pk_bf16_f32 v181, v180, v180
    v_lshlrev_b32 v181, 16, v181
    v_mfma_f32_32x32x16_bf16 v[72:87], v[228:231], v[64:67], v[72:87]
    s_waitcnt lgkmcnt(4)
    ds_read_b128 v[64:67], v8 offset:5120
    buffer_load_dwordx4 v3, s[84:87], s65 offen offset:1024 sc1 lds
    v_sub_f32 v182, v180, v181
    v_cvt_pk_bf16_f32 v180, v180, v182
    v_mfma_f32_32x32x16_bf16 v[72:87], v[232:235], v[68:71], v[72:87]
    s_waitcnt lgkmcnt(4)
    ds_read_b128 v[68:71], v8 offset:5632
    v_and_b32 v181, 0xffff0000, v180
    v_sub_f32 v182, v182, v181
    v_mov_b32 v183, 0
    v_cvt_pk_bf16_f32 v181, v182, v183
    v_mov_b32 v182, 0
    v_mfma_f32_32x32x16_bf16 v[72:87], v[236:239], v[96:99], v[72:87]
    s_waitcnt lgkmcnt(4)
    ds_read_b128 v[96:99], v8 offset:6144
    buffer_load_dwordx4 v3, s[84:87], s65 offen offset:2048 sc1 lds
    v_mfma_f32_32x32x16_bf16 v[72:87], v[240:243], v[100:103], v[72:87]
    s_waitcnt lgkmcnt(4)
    ds_read_b128 v[100:103], v8 offset:6656
    v_mfma_f32_32x32x16_bf16 v[72:87], v[244:247], v[104:107], v[72:87]
    s_waitcnt lgkmcnt(4)
    ds_read_b128 v[104:107], v8 offset:7168
    buffer_load_dwordx4 v3, s[84:87], s65 offen offset:3072 sc1 lds
    v_mfma_f32_32x32x16_bf16 v[72:87], v[248:251], v[108:111], v[72:87]
    s_waitcnt lgkmcnt(4)
    ds_read_b128 v[108:111], v8 offset:7680
    v_mfma_f32_32x32x16_bf16 v[72:87], v[252:255], v[64:67], v[72:87]
    s_waitcnt lgkmcnt(4)
    s_waitcnt vmcnt(22)
    s_barrier
    ds_read_b128 v[64:67], v8 offset:8192
    s_add_u32 m0, s41, 4096
    v_mfma_f32_32x32x16_bf16 v[72:87], a[0:3], v[68:71], v[72:87]
    s_waitcnt lgkmcnt(4)
    buffer_load_dwordx4 v3, s[84:87], s66 offen offset:0 sc1 lds
    ds_read_b128 v[68:71], v8 offset:8704
    v_mfma_f32_32x32x16_bf16 v[72:87], a[4:7], v[96:99], v[72:87]
    s_waitcnt lgkmcnt(4)
    ds_read_b128 v[96:99], v8 offset:9216
    buffer_load_dwordx4 v3, s[84:87], s66 offen offset:1024 sc1 lds
    v_mfma_f32_32x32x16_bf16 v[72:87], a[8:11], v[100:103], v[72:87]
    s_waitcnt lgkmcnt(4)
    ds_read_b128 v[100:103], v8 offset:9728
    v_mfma_f32_32x32x16_bf16 v[72:87], a[12:15], v[104:107], v[72:87]
    s_waitcnt lgkmcnt(4)
    ds_read_b128 v[104:107], v8 offset:10240
    buffer_load_dwordx4 v3, s[84:87], s66 offen offset:2048 sc1 lds
    s_waitcnt vmcnt(17)
    v_add_f32 v112, v112, v114
    v_mfma_f32_32x32x16_bf16 v[72:87], a[16:19], v[108:111], v[72:87]
    s_waitcnt lgkmcnt(4)
    ds_read_b128 v[108:111], v8 offset:10752
    v_add_f32 v116, v116, v118
    v_add_f32 v120, v120, v122
    v_add_f32 v124, v124, v126
    v_add_f32 v113, v113, v115
    v_add_f32 v117, v117, v119
    v_mfma_f32_32x32x16_bf16 v[72:87], a[20:23], v[64:67], v[72:87]
    s_waitcnt lgkmcnt(4)
    ds_read_b128 v[64:67], v8 offset:11264
    buffer_load_dwordx4 v3, s[84:87], s66 offen offset:3072 sc1 lds
    v_add_f32 v121, v121, v123
    v_add_f32 v125, v125, v127
    v_mfma_f32_32x32x16_bf16 v[72:87], a[24:27], v[68:71], v[72:87]
    s_waitcnt lgkmcnt(4)
    ds_read_b128 v[68:71], v8 offset:11776
    v_add_f32 v112, v112, v116
    v_add_f32 v120, v120, v124
    v_add_f32 v113, v113, v117
    v_add_f32 v121, v121, v125
    v_mov_b32 v114, v112
    v_mfma_f32_32x32x16_bf16 v[72:87], a[28:31], v[96:99], v[72:87]
    s_waitcnt lgkmcnt(4)
    ds_read_b128 v[96:99], v8 offset:12288
    s_add_u32 m0, s41, 8192
    s_nop 0
    buffer_load_dwordx4 v3, s[84:87], s67 offen offset:0 sc1 lds
    v_mov_b32 v122, v120
    v_mfma_f32_32x32x16_bf16 v[72:87], a[32:35], v[100:103], v[72:87]
    s_waitcnt lgkmcnt(4)
    ds_read_b128 v[100:103], v8 offset:12800
    v_mov_b32 v115, v113
    v_mov_b32 v123, v121
    v_permlane32_swap_b32 v112, v114
    v_mfma_f32_32x32x16_bf16 v[72:87], a[236:239], v[104:107], v[72:87]
    s_waitcnt lgkmcnt(4)
    ds_read_b128 v[104:107], v8 offset:13312
    buffer_load_dwordx4 v3, s[84:87], s67 offen offset:1024 sc1 lds
    v_permlane32_swap_b32 v120, v122
    v_mfma_f32_32x32x16_bf16 v[72:87], a[240:243], v[108:111], v[72:87]
    s_waitcnt lgkmcnt(4)
    ds_read_b128 v[108:111], v8 offset:13824
    v_permlane32_swap_b32 v113, v115
    v_permlane32_swap_b32 v121, v123
    v_add_f32 v112, v112, v114
    v_mfma_f32_32x32x16_bf16 v[72:87], a[244:247], v[64:67], v[72:87]
    s_waitcnt lgkmcnt(4)
    ds_read_b128 v[64:67], v8 offset:14336
    buffer_load_dwordx4 v3, s[84:87], s67 offen offset:2048 sc1 lds
    v_add_f32 v120, v120, v122
    v_add_f32 v113, v113, v115
    v_mfma_f32_32x32x16_bf16 v[72:87], a[248:251], v[68:71], v[72:87]
    s_waitcnt lgkmcnt(4)
    ds_read_b128 v[68:71], v8 offset:14848
    v_add_f32 v121, v121, v123
    v_mul_f32 v112, 0x3acccccd, v112
    v_mul_f32 v120, 0x3acccccd, v120
    v_mul_f32 v113, 0x3acccccd, v113
    v_mul_f32 v121, 0x3acccccd, v121
    v_mfma_f32_32x32x16_bf16 v[72:87], a[252:255], v[96:99], v[72:87]
    s_waitcnt lgkmcnt(4)
    ds_read_b128 v[96:99], v8 offset:15360
    buffer_load_dwordx4 v3, s[84:87], s67 offen offset:3072 sc1 lds
    v_fma_f32 v113, -v112, v112, v113
    v_fma_f32 v121, -v120, v120, v121
    v_mfma_f32_32x32x16_bf16 v[72:87], a[136:139], v[100:103], v[72:87]
    s_waitcnt lgkmcnt(4)
    ds_read_b128 v[100:103], v8 offset:15872
    v_max_f32 v113, 0, v113
    v_max_f32 v121, 0, v121
    v_cvt_pk_bf16_f32 v184, -v112, -v112
    v_cvt_pk_bf16_f32 v24, -v120, -v120
    v_cvt_pk_bf16_f32 v190, v113, v113
    v_mfma_f32_32x32x16_bf16 v[72:87], a[140:143], v[104:107], v[72:87]
    s_waitcnt lgkmcnt(4)
    ds_read_b128 v[104:107], v8 offset:16384
    s_add_u32 m0, s41, 12288
    s_nop 0
    buffer_load_dwordx4 v3, s[84:87], s68 offen offset:0 sc1 lds
    v_cvt_pk_bf16_f32 v30, v121, v121
    v_mfma_f32_32x32x16_bf16 v[72:87], a[144:147], v[108:111], v[72:87]
    s_waitcnt lgkmcnt(4)
    ds_read_b128 v[108:111], v8 offset:16896
    v_lshlrev_b32 v190, 16, v190
    v_lshlrev_b32 v30, 16, v30
    v_add_f32 v190, 0x3727c5ac, v190
    v_add_f32 v30, 0x3727c5ac, v30
    v_cvt_pk_bf16_f32 v190, v190, v190
    v_mfma_f32_32x32x16_bf16 v[72:87], a[148:151], v[64:67], v[72:87]
    s_waitcnt lgkmcnt(4)
    ds_read_b128 v[64:67], v8 offset:17408
    buffer_load_dwordx4 v3, s[84:87], s68 offen offset:1024 sc1 lds
    v_cvt_pk_bf16_f32 v30, v30, v30
    v_lshlrev_b32 v190, 16, v190
    v_mfma_f32_32x32x16_bf16 v[72:87], a[152:155], v[68:71], v[72:87]
    s_waitcnt lgkmcnt(4)
    ds_read_b128 v[68:71], v8 offset:17920
    v_lshlrev_b32 v30, 16, v30
    v_sqrt_f32 v190, v190
    v_sqrt_f32 v30, v30
    v_mfma_f32_32x32x16_bf16 v[72:87], a[156:159], v[96:99], v[72:87]
    s_waitcnt lgkmcnt(4)
    ds_read_b128 v[96:99], v8 offset:18432
    buffer_load_dwordx4 v3, s[84:87], s68 offen offset:2048 sc1 lds
    v_cvt_pk_bf16_f32 v190, v190, v190
    v_cvt_pk_bf16_f32 v30, v30, v30
    v_mfma_f32_32x32x16_bf16 v[72:87], a[160:163], v[100:103], v[72:87]
    s_waitcnt lgkmcnt(4)
    ds_read_b128 v[100:103], v8 offset:18944
    v_lshlrev_b32 v190, 16, v190
    v_lshlrev_b32 v30, 16, v30
    v_mov_b32 v185, v184
    v_mov_b32 v25, v24
    v_mfma_f32_32x32x16_bf16 v[72:87], a[164:167], v[104:107], v[72:87]
    s_waitcnt lgkmcnt(4)
    ds_read_b128 v[104:107], v8 offset:19456
    buffer_load_dwordx4 v3, s[84:87], s68 offen offset:3072 sc1 lds
    v_rcp_f32 v114, v190
    v_mfma_f32_32x32x16_bf16 v[72:87], a[168:171], v[108:111], v[72:87]
    s_waitcnt lgkmcnt(4)
    ds_read_b128 v[108:111], v8 offset:19968
    v_rcp_f32 v122, v30
    v_mov_b32 v186, v184
    v_mov_b32 v26, v24
    v_mov_b32 v187, v184
    v_mfma_f32_32x32x16_bf16 v[72:87], a[172:175], v[64:67], v[72:87]
    s_waitcnt lgkmcnt(4)
    s_waitcnt vmcnt(16)
    s_barrier
    s_add_u32 m0, s41, 16384
    s_nop 0
    buffer_load_dwordx4 v3, s[84:87], s69 offen offset:0 sc1 lds
    v_mfma_f32_32x32x16_bf16 v[72:87], a[176:179], v[68:71], v[72:87]
    s_waitcnt lgkmcnt(3)
    ds_read_b128 v[64:67], v8 offset:40960
    ds_read_b128 v[68:71], v8 offset:41472
    v_mov_b32 v27, v24
    v_mul_f32 v115, v114, v114
    v_mul_f32 v123, v122, v122
    v_mul_f32 v188, s91, v114
    v_mfma_f32_32x32x16_bf16 v[72:87], a[180:183], v[96:99], v[72:87]
    s_waitcnt lgkmcnt(4)
    buffer_load_dwordx4 v3, s[84:87], s69 offen offset:1024 sc1 lds
    ds_read_b128 v[96:99], v8 offset:41984
    v_mul_f32 v28, s91, v122
    v_mul_f32 v115, v115, v114
    v_mfma_f32_32x32x16_bf16 v[72:87], a[184:187], v[100:103], v[72:87]
    s_waitcnt lgkmcnt(4)
    ds_read_b128 v[100:103], v8 offset:42496
    v_mul_f32 v123, v123, v122
    v_mul_f32 v189, s90, v115
    v_mul_f32 v29, s90, v123
    v_mfma_f32_32x32x16_bf16 v[72:87], a[188:191], v[104:107], v[72:87]
    s_waitcnt lgkmcnt(4)
    buffer_load_dwordx4 v3, s[84:87], s69 offen offset:2048 sc1 lds
    ds_read_b128 v[104:107], v8 offset:43008
    v_mfma_f32_32x32x16_bf16 v[72:87], a[192:195], v[108:111], v[72:87]
    ds_read_b128 v[108:111], v8 offset:43520
    v_mfma_f32_32x32x16_bf16 v[72:87], v[176:179], v[184:187], v[72:87]
    s_waitcnt lgkmcnt(5)
    buffer_load_dwordx4 v3, s[84:87], s69 offen offset:3072 sc1 lds
    v_mfma_f32_32x32x16_bf16 v[32:47], v[212:215], v[64:67], 0
    s_waitcnt lgkmcnt(4)
    ds_read_b128 v[64:67], v8 offset:44032
    s_mov_b64 exec, 1
    buffer_store_dword v11, off, s[92:95], s75 sc1
    s_mov_b64 exec, -1
    v_mfma_f32_32x32x16_bf16 v[32:47], v[216:219], v[68:71], v[32:47]
    s_waitcnt lgkmcnt(4)
    ds_read_b128 v[68:71], v8 offset:44544
    v_mfma_f32_32x32x16_bf16 v[32:47], v[220:223], v[96:99], v[32:47]
    s_waitcnt lgkmcnt(4)
    ds_read_b128 v[96:99], v8 offset:45056
    buffer_load_dwordx4 v[212:215], v3, s[84:87], s60 offen offset:0 sc1
    v_mfma_f32_32x32x16_bf16 v[32:47], v[224:227], v[100:103], v[32:47]
    s_waitcnt lgkmcnt(4)
    ds_read_b128 v[100:103], v8 offset:45568
    v_mul_f32 v56, v72, v72
    v_mul_f32 v57, v73, v73
    v_mul_f32 v58, v74, v74
    v_mul_f32 v59, v75, v75
    v_fma_f32 v56, v56, v189, v188
    v_mfma_f32_32x32x16_bf16 v[32:47], v[228:231], v[104:107], v[32:47]
    s_waitcnt lgkmcnt(4)
    ds_read_b128 v[104:107], v8 offset:46080
    v_fma_f32 v57, v57, v189, v188
    v_fma_f32 v58, v58, v189, v188
    v_fma_f32 v59, v59, v189, v188
    v_mul_f32 v56, v56, v72
    v_mul_f32 v57, v57, v73
    v_mfma_f32_32x32x16_bf16 v[32:47], v[232:235], v[108:111], v[32:47]
    s_waitcnt lgkmcnt(4)
    buffer_load_dwordx4 v[216:219], v3, s[84:87], s61 offen offset:0 sc1
    ds_read_b128 v[108:111], v8 offset:46592
    v_mul_f32 v58, v58, v74
    v_mul_f32 v59, v59, v75
    v_mfma_f32_32x32x16_bf16 v[32:47], v[236:239], v[64:67], v[32:47]
    s_waitcnt lgkmcnt(4)
    ds_read_b128 v[64:67], v8 offset:47104
    v_exp_f32 v56, v56
    v_exp_f32 v57, v57
    v_mfma_f32_32x32x16_bf16 v[32:47], v[240:243], v[68:71], v[32:47]
    s_waitcnt lgkmcnt(4)
    buffer_load_dwordx4 v[220:223], v3, s[84:87], s62 offen offset:0 sc1
    ds_read_b128 v[68:71], v8 offset:47616
    v_exp_f32 v58, v58
    v_mfma_f32_32x32x16_bf16 v[32:47], v[244:247], v[96:99], v[32:47]
    s_waitcnt lgkmcnt(4)
    ds_read_b128 v[96:99], v8 offset:48128
    v_exp_f32 v59, v59
    v_fma_f32 v56, v56, v190, v190
    v_fma_f32 v57, v57, v190, v190
    v_fma_f32 v58, v58, v190, v190
    v_mfma_f32_32x32x16_bf16 v[32:47], v[248:251], v[100:103], v[32:47]
    s_waitcnt lgkmcnt(4)
    buffer_load_dwordx4 v[224:227], v3, s[84:87], s63 offen offset:0 sc1
    ds_read_b128 v[100:103], v8 offset:48640
    v_fma_f32 v59, v59, v190, v190
    v_rcp_f32 v56, v56
    v_rcp_f32 v57, v57
    v_rcp_f32 v58, v58
    v_mfma_f32_32x32x16_bf16 v[32:47], v[252:255], v[104:107], v[32:47]
    s_waitcnt lgkmcnt(4)
    ds_read_b128 v[104:107], v8 offset:49152
    v_rcp_f32 v59, v59
    v_mul_f32 v72, v72, v56
    v_mul_f32 v73, v73, v57
    v_mul_f32 v74, v74, v58
    v_mfma_f32_32x32x16_bf16 v[32:47], a[0:3], v[108:111], v[32:47]
    s_waitcnt lgkmcnt(4)
    buffer_load_dwordx4 v[228:231], v3, s[84:87], s64 offen offset:0 sc1
    ds_read_b128 v[108:111], v8 offset:49664
    v_mul_f32 v75, v75, v59
    v_cvt_pk_bf16_f32 v88, v72, v73
    v_cvt_pk_bf16_f32 v89, v74, v75
    v_mfma_f32_32x32x16_bf16 v[32:47], a[4:7], v[64:67], v[32:47]
    s_waitcnt lgkmcnt(4)
    ds_read_b128 v[64:67], v8 offset:50176
    v_mul_f32 v60, v76, v76
    v_mul_f32 v61, v77, v77
    v_mul_f32 v62, v78, v78
    v_mul_f32 v63, v79, v79
    v_fma_f32 v60, v60, v189, v188
    v_mfma_f32_32x32x16_bf16 v[32:47], a[8:11], v[68:71], v[32:47]
    s_waitcnt lgkmcnt(4)
    buffer_load_dwordx4 v[232:235], v3, s[84:87], s60 offen offset:1024 sc1
    ds_read_b128 v[68:71], v8 offset:50688
    v_fma_f32 v61, v61, v189, v188
    v_fma_f32 v62, v62, v189, v188
    v_mfma_f32_32x32x16_bf16 v[32:47], a[12:15], v[96:99], v[32:47]
    s_waitcnt lgkmcnt(4)
    ds_read_b128 v[96:99], v8 offset:51200
    v_fma_f32 v63, v63, v189, v188
    v_mul_f32 v60, v60, v76
    v_mul_f32 v61, v61, v77
    v_mul_f32 v62, v62, v78
    v_mul_f32 v63, v63, v79
    v_mfma_f32_32x32x16_bf16 v[32:47], a[16:19], v[100:103], v[32:47]
    s_waitcnt lgkmcnt(4)
    buffer_load_dwordx4 v[236:239], v3, s[84:87], s61 offen offset:1024 sc1
    ds_read_b128 v[100:103], v8 offset:51712
    v_exp_f32 v60, v60
    v_exp_f32 v61, v61
    v_exp_f32 v62, v62
    v_mfma_f32_32x32x16_bf16 v[32:47], a[20:23], v[104:107], v[32:47]
    s_waitcnt lgkmcnt(4)
    ds_read_b128 v[104:107], v8 offset:52224
    v_exp_f32 v63, v63
    v_fma_f32 v60, v60, v190, v190
    v_fma_f32 v61, v61, v190, v190
    v_fma_f32 v62, v62, v190, v190
    v_mfma_f32_32x32x16_bf16 v[32:47], a[24:27], v[108:111], v[32:47]
    s_waitcnt lgkmcnt(4)
    buffer_load_dwordx4 v[240:243], v3, s[84:87], s62 offen offset:1024 sc1
    ds_read_b128 v[108:111], v8 offset:52736
    v_fma_f32 v63, v63, v190, v190
    v_rcp_f32 v60, v60
    v_rcp_f32 v61, v61
    v_mfma_f32_32x32x16_bf16 v[32:47], a[28:31], v[64:67], v[32:47]
    s_waitcnt lgkmcnt(4)
    ds_read_b128 v[64:67], v8 offset:53248
    v_rcp_f32 v62, v62
    v_rcp_f32 v63, v63
    v_mul_f32 v76, v76, v60
    v_mul_f32 v77, v77, v61
    v_mfma_f32_32x32x16_bf16 v[32:47], a[32:35], v[68:71], v[32:47]
    s_waitcnt lgkmcnt(4)
    buffer_load_dwordx4 v[244:247], v3, s[84:87], s63 offen offset:1024 sc1
    ds_read_b128 v[68:71], v8 offset:53760
    v_mul_f32 v78, v78, v62
    v_mul_f32 v79, v79, v63
    v_cvt_pk_bf16_f32 v90, v76, v77
    v_mfma_f32_32x32x16_bf16 v[32:47], a[236:239], v[96:99], v[32:47]
    s_waitcnt lgkmcnt(4)
    ds_read_b128 v[96:99], v8 offset:54272
    v_cvt_pk_bf16_f32 v91, v78, v79
    v_mfma_f32_32x32x16_bf16 v[32:47], a[240:243], v[100:103], v[32:47]
    s_waitcnt lgkmcnt(4)
    buffer_store_dwordx4 v[88:91], v20, s[16:19], s37 offen offset:0 sc1
    buffer_load_dwordx4 v[248:251], v3, s[84:87], s64 offen offset:1024 sc1
    ds_read_b128 v[100:103], v8 offset:54784
    v_mul_f32 v56, v80, v80
    v_mul_f32 v57, v81, v81
    v_mul_f32 v58, v82, v82
    v_mul_f32 v59, v83, v83
    v_fma_f32 v56, v56, v189, v188
    v_fma_f32 v57, v57, v189, v188
    v_mfma_f32_32x32x16_bf16 v[32:47], a[244:247], v[104:107], v[32:47]
    s_waitcnt lgkmcnt(4)
    ds_read_b128 v[104:107], v8 offset:55296
    v_fma_f32 v58, v58, v189, v188
    v_fma_f32 v59, v59, v189, v188
    v_mul_f32 v56, v56, v80
    v_mul_f32 v57, v57, v81
    v_mul_f32 v58, v58, v82
    v_mfma_f32_32x32x16_bf16 v[32:47], a[248:251], v[108:111], v[32:47]
    s_waitcnt lgkmcnt(4)
    buffer_load_dwordx4 v[252:255], v3, s[84:87], s60 offen offset:2048 sc1
    ds_read_b128 v[108:111], v8 offset:55808
    v_mul_f32 v59, v59, v83
    v_exp_f32 v56, v56
    v_mfma_f32_32x32x16_bf16 v[32:47], a[252:255], v[64:67], v[32:47]
    s_waitcnt lgkmcnt(4)
    ds_read_b128 v[64:67], v8 offset:56320
    v_exp_f32 v57, v57
    v_exp_f32 v58, v58
    v_exp_f32 v59, v59
    v_fma_f32 v56, v56, v190, v190
    v_mfma_f32_32x32x16_bf16 v[32:47], a[136:139], v[68:71], v[32:47]
    s_waitcnt lgkmcnt(4)
    buffer_load_dwordx4 a[0:3], v3, s[84:87], s61 offen offset:2048 sc1
    ds_read_b128 v[68:71], v8 offset:56832
    v_fma_f32 v57, v57, v190, v190
    v_fma_f32 v58, v58, v190, v190
    v_fma_f32 v59, v59, v190, v190
    v_mfma_f32_32x32x16_bf16 v[32:47], a[140:143], v[96:99], v[32:47]
    s_waitcnt lgkmcnt(4)
    ds_read_b128 v[96:99], v8 offset:57344
    v_rcp_f32 v56, v56
    v_rcp_f32 v57, v57
    v_rcp_f32 v58, v58
    v_rcp_f32 v59, v59
    v_mfma_f32_32x32x16_bf16 v[32:47], a[144:147], v[100:103], v[32:47]
    s_waitcnt lgkmcnt(4)
    buffer_load_dwordx4 a[4:7], v3, s[84:87], s62 offen offset:2048 sc1
    ds_read_b128 v[100:103], v8 offset:57856
    v_mul_f32 v80, v80, v56
    v_mul_f32 v81, v81, v57
    v_mul_f32 v82, v82, v58
    v_mul_f32 v83, v83, v59
    v_mfma_f32_32x32x16_bf16 v[32:47], a[148:151], v[104:107], v[32:47]
    s_waitcnt lgkmcnt(4)
    ds_read_b128 v[104:107], v8 offset:58368
    v_cvt_pk_bf16_f32 v92, v80, v81
    v_cvt_pk_bf16_f32 v93, v82, v83
    v_mul_f32 v60, v84, v84
    v_mul_f32 v61, v85, v85
    v_mul_f32 v62, v86, v86
    v_mfma_f32_32x32x16_bf16 v[32:47], a[152:155], v[108:111], v[32:47]
    s_waitcnt lgkmcnt(4)
    buffer_load_dwordx4 a[8:11], v3, s[84:87], s63 offen offset:2048 sc1
    ds_read_b128 v[108:111], v8 offset:58880
    v_mul_f32 v63, v87, v87
    v_fma_f32 v60, v60, v189, v188
    v_mfma_f32_32x32x16_bf16 v[32:47], a[156:159], v[64:67], v[32:47]
    s_waitcnt lgkmcnt(4)
    ds_read_b128 v[64:67], v8 offset:59392
    v_fma_f32 v61, v61, v189, v188
    v_fma_f32 v62, v62, v189, v188
    v_fma_f32 v63, v63, v189, v188
    v_mul_f32 v60, v60, v84
    v_mul_f32 v61, v61, v85
    v_mfma_f32_32x32x16_bf16 v[32:47], a[160:163], v[68:71], v[32:47]
    s_waitcnt lgkmcnt(4)
    buffer_load_dwordx4 a[12:15], v3, s[84:87], s64 offen offset:2048 sc1
    ds_read_b128 v[68:71], v8 offset:59904
    v_mul_f32 v62, v62, v86
    v_mul_f32 v63, v63, v87
    v_mfma_f32_32x32x16_bf16 v[32:47], a[164:167], v[96:99], v[32:47]
    s_waitcnt lgkmcnt(4)
    ds_read_b128 v[96:99], v8 offset:60416
    v_exp_f32 v60, v60
    v_exp_f32 v61, v61
    v_exp_f32 v62, v62
    v_exp_f32 v63, v63
    v_mfma_f32_32x32x16_bf16 v[32:47], a[168:171], v[100:103], v[32:47]
    s_waitcnt lgkmcnt(4)
    buffer_load_dwordx4 a[16:19], v3, s[84:87], s60 offen offset:3072 sc1
    ds_read_b128 v[100:103], v8 offset:60928
    v_fma_f32 v60, v60, v190, v190
    v_fma_f32 v61, v61, v190, v190
    v_fma_f32 v62, v62, v190, v190
    v_fma_f32 v63, v63, v190, v190
    v_mfma_f32_32x32x16_bf16 v[32:47], a[172:175], v[104:107], v[32:47]
    s_waitcnt lgkmcnt(4)
    ds_read_b128 v[104:107], v8 offset:0
    v_rcp_f32 v60, v60
    v_rcp_f32 v61, v61
    v_rcp_f32 v62, v62
    v_mfma_f32_32x32x16_bf16 v[32:47], a[176:179], v[108:111], v[32:47]
    s_waitcnt lgkmcnt(4)
    buffer_load_dwordx4 a[20:23], v3, s[84:87], s61 offen offset:3072 sc1
    ds_read_b128 v[108:111], v8 offset:512
    v_rcp_f32 v63, v63
    v_mul_f32 v84, v84, v60
    v_mul_f32 v85, v85, v61
    v_mul_f32 v86, v86, v62
    v_mfma_f32_32x32x16_bf16 v[32:47], a[180:183], v[64:67], v[32:47]
    s_waitcnt lgkmcnt(4)
    ds_read_b128 v[64:67], v8 offset:1024
    v_mul_f32 v87, v87, v63
    v_cvt_pk_bf16_f32 v94, v84, v85
    v_cvt_pk_bf16_f32 v95, v86, v87
    v_mfma_f32_32x32x16_bf16 v[32:47], a[184:187], v[68:71], v[32:47]
    s_waitcnt lgkmcnt(4)
    buffer_store_dwordx4 v[92:95], v20, s[16:19], s37 offen offset:512 sc1
    buffer_load_dwordx4 a[24:27], v3, s[84:87], s62 offen offset:3072 sc1
    ds_read_b128 v[68:71], v8 offset:1536
    v_mfma_f32_32x32x16_bf16 v[32:47], a[188:191], v[96:99], v[32:47]
    s_waitcnt lgkmcnt(4)
    ds_read_b128 v[96:99], v8 offset:2048
    v_mfma_f32_32x32x16_bf16 v[32:47], a[192:195], v[100:103], v[32:47]
    buffer_load_dwordx4 a[28:31], v3, s[84:87], s63 offen offset:3072 sc1
    ds_read_b128 v[100:103], v8 offset:2560
    v_mfma_f32_32x32x16_bf16 v[32:47], v[176:179], v[24:27], v[32:47]
    s_waitcnt lgkmcnt(5)
    v_mfma_f32_32x32x16_bf16 v[72:87], a[196:199], v[104:107], 0
    s_waitcnt lgkmcnt(4)
    buffer_load_dwordx4 a[32:35], v3, s[84:87], s64 offen offset:3072 sc1
    ds_read_b128 v[104:107], v8 offset:3072
    v_mfma_f32_32x32x16_bf16 v[72:87], a[200:203], v[108:111], v[72:87]
    s_waitcnt lgkmcnt(4)
    ds_read_b128 v[108:111], v8 offset:3584
    v_mfma_f32_32x32x16_bf16 v[72:87], a[204:207], v[64:67], v[72:87]
    s_waitcnt lgkmcnt(4)
    buffer_load_dwordx4 a[236:239], v18, s[84:87], s60 offen offset:0 sc1
    ds_read_b128 v[64:67], v8 offset:4096
    v_mfma_f32_32x32x16_bf16 v[72:87], a[208:211], v[68:71], v[72:87]
    s_waitcnt lgkmcnt(4)
    ds_read_b128 v[68:71], v8 offset:4608
    v_mul_f32 v56, v32, v32
    v_mul_f32 v57, v33, v33
    v_mul_f32 v58, v34, v34
    v_mul_f32 v59, v35, v35
    v_fma_f32 v56, v56, v29, v28
    v_mfma_f32_32x32x16_bf16 v[72:87], a[212:215], v[96:99], v[72:87]
    s_waitcnt lgkmcnt(4)
    buffer_load_dwordx4 a[240:243], v18, s[84:87], s61 offen offset:0 sc1
    ds_read_b128 v[96:99], v8 offset:5120
    v_fma_f32 v57, v57, v29, v28
    v_fma_f32 v58, v58, v29, v28
    v_mfma_f32_32x32x16_bf16 v[72:87], a[216:219], v[100:103], v[72:87]
    s_waitcnt lgkmcnt(4)
    ds_read_b128 v[100:103], v8 offset:5632
    v_fma_f32 v59, v59, v29, v28
    v_mul_f32 v56, v56, v32
    v_mul_f32 v57, v57, v33
    v_mul_f32 v58, v58, v34
    v_mul_f32 v59, v59, v35
    v_mfma_f32_32x32x16_bf16 v[72:87], a[220:223], v[104:107], v[72:87]
    s_waitcnt lgkmcnt(4)
    buffer_load_dwordx4 a[244:247], v18, s[84:87], s62 offen offset:0 sc1
    ds_read_b128 v[104:107], v8 offset:6144
    v_exp_f32 v56, v56
    v_mfma_f32_32x32x16_bf16 v[72:87], a[224:227], v[108:111], v[72:87]
    s_waitcnt lgkmcnt(4)
    ds_read_b128 v[108:111], v8 offset:6656
    v_exp_f32 v57, v57
    v_exp_f32 v58, v58
    v_mfma_f32_32x32x16_bf16 v[72:87], a[228:231], v[64:67], v[72:87]
    s_waitcnt lgkmcnt(4)
    buffer_load_dwordx4 a[248:251], v18, s[84:87], s63 offen offset:0 sc1
    ds_read_b128 v[64:67], v8 offset:7168
    v_exp_f32 v59, v59
    v_fma_f32 v56, v56, v30, v30
    v_fma_f32 v57, v57, v30, v30
    v_fma_f32 v58, v58, v30, v30
    v_mfma_f32_32x32x16_bf16 v[72:87], a[232:235], v[68:71], v[72:87]
    s_waitcnt lgkmcnt(4)
    ds_read_b128 v[68:71], v8 offset:7680
    v_fma_f32 v59, v59, v30, v30
    v_rcp_f32 v56, v56
    v_rcp_f32 v57, v57
    v_rcp_f32 v58, v58
    v_mfma_f32_32x32x16_bf16 v[72:87], v[192:195], v[96:99], v[72:87]
    s_waitcnt lgkmcnt(4)
    buffer_load_dwordx4 a[252:255], v18, s[84:87], s64 offen offset:0 sc1
    ds_read_b128 v[96:99], v8 offset:8192
    v_rcp_f32 v59, v59
    v_mul_f32 v32, v32, v56
    v_mul_f32 v33, v33, v57
    v_mfma_f32_32x32x16_bf16 v[72:87], v[196:199], v[100:103], v[72:87]
    s_waitcnt lgkmcnt(4)
    ds_read_b128 v[100:103], v8 offset:8704
    v_mul_f32 v34, v34, v58
    v_mul_f32 v35, v35, v59
    v_cvt_pk_bf16_f32 v48, v32, v33
    v_cvt_pk_bf16_f32 v49, v34, v35
    v_mul_f32 v60, v36, v36
    v_mfma_f32_32x32x16_bf16 v[72:87], v[200:203], v[104:107], v[72:87]
    s_waitcnt lgkmcnt(4)
    buffer_load_dwordx4 a[136:139], v18, s[84:87], s60 offen offset:1024 sc1
    ds_read_b128 v[104:107], v8 offset:9216
    v_mul_f32 v61, v37, v37
    v_mul_f32 v62, v38, v38
    v_mul_f32 v63, v39, v39
    v_mfma_f32_32x32x16_bf16 v[72:87], v[204:207], v[108:111], v[72:87]
    s_waitcnt lgkmcnt(4)
    ds_read_b128 v[108:111], v8 offset:9728
    v_fma_f32 v60, v60, v29, v28
    v_fma_f32 v61, v61, v29, v28
    v_fma_f32 v62, v62, v29, v28
    v_fma_f32 v63, v63, v29, v28
    v_mul_f32 v60, v60, v36
    v_mfma_f32_32x32x16_bf16 v[72:87], v[208:211], v[64:67], v[72:87]
    s_waitcnt lgkmcnt(4)
    buffer_load_dwordx4 a[140:143], v18, s[84:87], s61 offen offset:1024 sc1
    ds_read_b128 v[64:67], v8 offset:10240
    v_mul_f32 v61, v61, v37
    v_mul_f32 v62, v62, v38
    v_mfma_f32_32x32x16_bf16 v[72:87], a[36:39], v[68:71], v[72:87]
    s_waitcnt lgkmcnt(4)
    ds_read_b128 v[68:71], v8 offset:10752
    v_mul_f32 v63, v63, v39
    v_exp_f32 v60, v60
    v_exp_f32 v61, v61
    v_exp_f32 v62, v62
    v_mfma_f32_32x32x16_bf16 v[72:87], a[40:43], v[96:99], v[72:87]
    s_waitcnt lgkmcnt(4)
    s_waitcnt vmcnt(10)
    s_mov_b64 exec, 1
    buffer_store_dword v11, v16, s[92:95], s56 offen
    s_mov_b64 exec, -1
    ds_read_b128 v[96:99], v8 offset:11264
    v_exp_f32 v63, v63
    v_fma_f32 v60, v60, v30, v30
    v_fma_f32 v61, v61, v30, v30
    v_mfma_f32_32x32x16_bf16 v[72:87], a[44:47], v[100:103], v[72:87]
    s_waitcnt lgkmcnt(4)
    buffer_load_dwordx4 a[144:147], v18, s[84:87], s62 offen offset:1024 sc1
    ds_read_b128 v[100:103], v8 offset:11776
    v_fma_f32 v62, v62, v30, v30
    v_fma_f32 v63, v63, v30, v30
    v_rcp_f32 v60, v60
    v_rcp_f32 v61, v61
    v_mfma_f32_32x32x16_bf16 v[72:87], a[48:51], v[104:107], v[72:87]
    s_waitcnt lgkmcnt(4)
    buffer_load_dwordx4 a[148:151], v18, s[84:87], s63 offen offset:1024 sc1
    ds_read_b128 v[104:107], v8 offset:12288
    v_rcp_f32 v62, v62
    v_rcp_f32 v63, v63
    v_mul_f32 v36, v36, v60
    v_mul_f32 v37, v37, v61
    v_mfma_f32_32x32x16_bf16 v[72:87], a[52:55], v[108:111], v[72:87]
    s_waitcnt lgkmcnt(4)
    ds_read_b128 v[108:111], v8 offset:12800
    v_mul_f32 v38, v38, v62
    v_mul_f32 v39, v39, v63
    v_cvt_pk_bf16_f32 v50, v36, v37
    v_cvt_pk_bf16_f32 v51, v38, v39
    v_mfma_f32_32x32x16_bf16 v[72:87], a[56:59], v[64:67], v[72:87]
    s_waitcnt lgkmcnt(4)
    buffer_store_dwordx4 v[48:51], v20, s[16:19], s38 offen offset:0 sc1
    buffer_load_dwordx4 a[152:155], v18, s[84:87], s64 offen offset:1024 sc1
    ds_read_b128 v[64:67], v8 offset:13312
    v_mul_f32 v56, v40, v40
    v_mul_f32 v57, v41, v41
    v_mfma_f32_32x32x16_bf16 v[72:87], a[60:63], v[68:71], v[72:87]
    s_waitcnt lgkmcnt(4)
    ds_read_b128 v[68:71], v8 offset:13824
    v_mul_f32 v58, v42, v42
    v_mul_f32 v59, v43, v43
    v_fma_f32 v56, v56, v29, v28
    v_fma_f32 v57, v57, v29, v28
    v_fma_f32 v58, v58, v29, v28
    v_mfma_f32_32x32x16_bf16 v[72:87], a[64:67], v[96:99], v[72:87]
    s_waitcnt lgkmcnt(4)
    buffer_load_dwordx4 a[156:159], v18, s[84:87], s60 offen offset:2048 sc1
    ds_read_b128 v[96:99], v8 offset:14336
    v_fma_f32 v59, v59, v29, v28
    v_mul_f32 v56, v56, v40
    v_mfma_f32_32x32x16_bf16 v[72:87], a[68:71], v[100:103], v[72:87]
    s_waitcnt lgkmcnt(4)
    ds_read_b128 v[100:103], v8 offset:14848
    v_mul_f32 v57, v57, v41
    v_mul_f32 v58, v58, v42
    v_mul_f32 v59, v59, v43
    v_exp_f32 v56, v56
    v_mfma_f32_32x32x16_bf16 v[72:87], a[72:75], v[104:107], v[72:87]
    s_waitcnt lgkmcnt(4)
    buffer_load_dwordx4 a[160:163], v18, s[84:87], s61 offen offset:2048 sc1
    ds_read_b128 v[104:107], v8 offset:15360
    v_exp_f32 v57, v57
    v_exp_f32 v58, v58
    v_exp_f32 v59, v59
    v_fma_f32 v56, v56, v30, v30
    v_mfma_f32_32x32x16_bf16 v[72:87], a[76:79], v[108:111], v[72:87]
    s_waitcnt lgkmcnt(4)
    ds_read_b128 v[108:111], v8 offset:15872
    v_fma_f32 v57, v57, v30, v30
    v_fma_f32 v58, v58, v30, v30
    v_fma_f32 v59, v59, v30, v30
    v_rcp_f32 v56, v56
    v_mfma_f32_32x32x16_bf16 v[72:87], a[80:83], v[64:67], v[72:87]
    s_waitcnt lgkmcnt(4)
    buffer_load_dwordx4 a[164:167], v18, s[84:87], s62 offen offset:2048 sc1
    ds_read_b128 v[64:67], v8 offset:16384
    v_rcp_f32 v57, v57
    v_rcp_f32 v58, v58
    v_rcp_f32 v59, v59
    v_mfma_f32_32x32x16_bf16 v[72:87], a[84:87], v[68:71], v[72:87]
    s_waitcnt lgkmcnt(4)
    ds_read_b128 v[68:71], v8 offset:16896
    v_mul_f32 v40, v40, v56
    v_mul_f32 v41, v41, v57
    v_mul_f32 v42, v42, v58
    v_mul_f32 v43, v43, v59
    v_cvt_pk_bf16_f32 v52, v40, v41
    v_mfma_f32_32x32x16_bf16 v[72:87], a[88:91], v[96:99], v[72:87]
    s_waitcnt lgkmcnt(4)
    buffer_load_dwordx4 a[168:171], v18, s[84:87], s63 offen offset:2048 sc1
    ds_read_b128 v[96:99], v8 offset:17408
    v_cvt_pk_bf16_f32 v53, v42, v43
    v_mul_f32 v60, v44, v44
    v_mfma_f32_32x32x16_bf16 v[72:87], a[92:95], v[100:103], v[72:87]
    s_waitcnt lgkmcnt(4)
    ds_read_b128 v[100:103], v8 offset:17920
    v_mul_f32 v61, v45, v45
    v_mul_f32 v62, v46, v46
    v_mul_f32 v63, v47, v47
    v_fma_f32 v60, v60, v29, v28
    v_fma_f32 v61, v61, v29, v28
    v_mfma_f32_32x32x16_bf16 v[72:87], a[96:99], v[104:107], v[72:87]
    s_waitcnt lgkmcnt(4)
    buffer_load_dword v31, v22, s[92:95], s56 offen offset:0 sc1
    buffer_load_dwordx4 a[172:175], v18, s[84:87], s64 offen offset:2048 sc1
    v_fma_f32 v62, v62, v29, v28
    v_fma_f32 v63, v63, v29, v28
    v_mul_f32 v60, v60, v44
    v_mfma_f32_32x32x16_bf16 v[72:87], a[100:103], v[108:111], v[72:87]
    s_waitcnt lgkmcnt(3)
    ds_read_b128 v[104:107], v8 offset:18432
    ds_read_b128 v[108:111], v8 offset:18944
    v_mul_f32 v61, v61, v45
    v_mul_f32 v62, v62, v46
    v_mul_f32 v63, v63, v47
    v_mfma_f32_32x32x16_bf16 v[72:87], a[104:107], v[64:67], v[72:87]
    s_waitcnt lgkmcnt(4)
    buffer_load_dwordx4 a[176:179], v18, s[84:87], s60 offen offset:3072 sc1
    ds_read_b128 v[64:67], v8 offset:19456
    v_exp_f32 v60, v60
    v_exp_f32 v61, v61
    v_exp_f32 v62, v62
    v_exp_f32 v63, v63
    v_mfma_f32_32x32x16_bf16 v[72:87], a[108:111], v[68:71], v[72:87]
    s_waitcnt lgkmcnt(4)
    ds_read_b128 v[68:71], v8 offset:19968
    v_fma_f32 v60, v60, v30, v30
    v_fma_f32 v61, v61, v30, v30
    v_fma_f32 v62, v62, v30, v30
    v_fma_f32 v63, v63, v30, v30
    v_mfma_f32_32x32x16_bf16 v[72:87], a[112:115], v[96:99], v[72:87]
    s_waitcnt lgkmcnt(4)
    buffer_load_dwordx4 a[180:183], v18, s[84:87], s61 offen offset:3072 sc1
    ds_read_b128 v[96:99], v8 offset:40960
    v_rcp_f32 v60, v60
    v_rcp_f32 v61, v61
    v_rcp_f32 v62, v62
    v_mfma_f32_32x32x16_bf16 v[72:87], a[116:119], v[100:103], v[72:87]
    s_waitcnt lgkmcnt(4)
    ds_read_b128 v[100:103], v8 offset:41472
    v_rcp_f32 v63, v63
    v_mul_f32 v44, v44, v60
    v_mul_f32 v45, v45, v61
    v_mul_f32 v46, v46, v62
    v_mfma_f32_32x32x16_bf16 v[72:87], a[120:123], v[104:107], v[72:87]
    s_waitcnt lgkmcnt(4)
    buffer_load_dwordx4 a[184:187], v18, s[84:87], s62 offen offset:3072 sc1
    ds_read_b128 v[104:107], v8 offset:41984
    v_mul_f32 v47, v47, v63
    v_cvt_pk_bf16_f32 v54, v44, v45
    v_cvt_pk_bf16_f32 v55, v46, v47
    v_mfma_f32_32x32x16_bf16 v[72:87], a[124:127], v[108:111], v[72:87]
    s_waitcnt lgkmcnt(4)
    buffer_store_dwordx4 v[52:55], v20, s[16:19], s38 offen offset:512 sc1
    ds_read_b128 v[108:111], v8 offset:42496
    v_mfma_f32_32x32x16_bf16 v[72:87], a[128:131], v[64:67], v[72:87]
    s_waitcnt lgkmcnt(4)
    buffer_load_dwordx4 a[188:191], v18, s[84:87], s63 offen offset:3072 sc1
    ds_read_b128 v[64:67], v8 offset:43008
    v_mfma_f32_32x32x16_bf16 v[72:87], a[132:135], v[68:71], v[72:87]
    ds_read_b128 v[68:71], v8 offset:43520
    v_mfma_f32_32x32x16_bf16 v[72:87], v[180:183], v[184:187], v[72:87]
    s_waitcnt lgkmcnt(5)
    buffer_load_dwordx4 a[192:195], v18, s[84:87], s64 offen offset:3072 sc1
    v_mfma_f32_32x32x16_bf16 v[32:47], a[196:199], v[96:99], 0
    s_waitcnt lgkmcnt(4)
    ds_read_b128 v[96:99], v8 offset:44032
    v_mfma_f32_32x32x16_bf16 v[32:47], a[200:203], v[100:103], v[32:47]
    s_waitcnt lgkmcnt(4)
    ds_read_b128 v[100:103], v8 offset:44544
    v_mfma_f32_32x32x16_bf16 v[32:47], a[204:207], v[104:107], v[32:47]
    s_waitcnt lgkmcnt(4)
    ds_read_b128 v[104:107], v8 offset:45056
    v_mfma_f32_32x32x16_bf16 v[32:47], a[208:211], v[108:111], v[32:47]
    s_waitcnt lgkmcnt(4)
    ds_read_b128 v[108:111], v8 offset:45568
    v_mul_f32 v56, v72, v72
    v_mul_f32 v57, v73, v73
    v_mul_f32 v58, v74, v74
    v_mul_f32 v59, v75, v75
    v_fma_f32 v56, v56, v189, v188
    v_mfma_f32_32x32x16_bf16 v[32:47], a[212:215], v[64:67], v[32:47]
    s_waitcnt lgkmcnt(4)
    ds_read_b128 v[64:67], v8 offset:46080
    v_fma_f32 v57, v57, v189, v188
    v_fma_f32 v58, v58, v189, v188
    v_fma_f32 v59, v59, v189, v188
    v_mul_f32 v56, v56, v72
    v_mul_f32 v57, v57, v73
    v_mfma_f32_32x32x16_bf16 v[32:47], a[216:219], v[68:71], v[32:47]
    s_waitcnt lgkmcnt(4)
    ds_read_b128 v[68:71], v8 offset:46592
    v_mul_f32 v58, v58, v74
    v_mul_f32 v59, v59, v75
    v_exp_f32 v56, v56
    v_mfma_f32_32x32x16_bf16 v[32:47], a[220:223], v[96:99], v[32:47]
    s_waitcnt lgkmcnt(4)
    ds_read_b128 v[96:99], v8 offset:47104
    s_waitcnt vmcnt(7)
    v_cmp_ne_u32 vcc, s88, v31
    s_cbranch_vccnz mk_ps70
mk_pb71:
    v_mfma_f32_32x32x16_bf16 v[32:47], a[224:227], v[100:103], v[32:47]
    s_waitcnt lgkmcnt(4)
    buffer_load_dwordx4 v[148:151], v3, s[16:19], s48 offen offset:0 sc1
    ds_read_b128 v[100:103], v8 offset:47616
    v_exp_f32 v57, v57
    v_exp_f32 v58, v58
    v_mfma_f32_32x32x16_bf16 v[32:47], a[228:231], v[104:107], v[32:47]
    s_waitcnt lgkmcnt(4)
    buffer_load_dwordx4 v[152:155], v3, s[16:19], s49 offen offset:0 sc1
    ds_read_b128 v[104:107], v8 offset:48128
    v_exp_f32 v59, v59
    v_fma_f32 v56, v56, v190, v190
    v_fma_f32 v57, v57, v190, v190
    v_fma_f32 v58, v58, v190, v190
    v_mfma_f32_32x32x16_bf16 v[32:47], a[232:235], v[108:111], v[32:47]
    s_waitcnt lgkmcnt(4)
    ds_read_b128 v[108:111], v8 offset:48640
    v_fma_f32 v59, v59, v190, v190
    v_rcp_f32 v56, v56
    v_rcp_f32 v57, v57
    v_rcp_f32 v58, v58
    v_mfma_f32_32x32x16_bf16 v[32:47], v[192:195], v[64:67], v[32:47]
    s_waitcnt lgkmcnt(4)
    buffer_load_dwordx4 v[128:131], v3, s[16:19], s48 offen offset:1024 sc1
    ds_read_b128 v[64:67], v8 offset:49152
    v_rcp_f32 v59, v59
    v_mul_f32 v72, v72, v56
    v_mul_f32 v73, v73, v57
    v_mfma_f32_32x32x16_bf16 v[32:47], v[196:199], v[68:71], v[32:47]
    s_waitcnt lgkmcnt(4)
    ds_read_b128 v[68:71], v8 offset:49664
    v_mul_f32 v74, v74, v58
    v_mul_f32 v75, v75, v59
    v_cvt_pk_bf16_f32 v88, v72, v73
    v_cvt_pk_bf16_f32 v89, v74, v75
    v_mul_f32 v60, v76, v76
    v_mfma_f32_32x32x16_bf16 v[32:47], v[200:203], v[96:99], v[32:47]
    s_waitcnt lgkmcnt(4)
    buffer_load_dwordx4 v[132:135], v3, s[16:19], s49 offen offset:1024 sc1
    ds_read_b128 v[96:99], v8 offset:50176
    v_mul_f32 v61, v77, v77
    v_mul_f32 v62, v78, v78
    v_mul_f32 v63, v79, v79
    v_mfma_f32_32x32x16_bf16 v[32:47], v[204:207], v[100:103], v[32:47]
    s_waitcnt lgkmcnt(4)
    ds_read_b128 v[100:103], v8 offset:50688
    v_fma_f32 v60, v60, v189, v188
    v_fma_f32 v61, v61, v189, v188
    v_fma_f32 v62, v62, v189, v188
    v_fma_f32 v63, v63, v189, v188
    v_mul_f32 v60, v60, v76
    v_mfma_f32_32x32x16_bf16 v[32:47], v[208:211], v[104:107], v[32:47]
    s_waitcnt lgkmcnt(4)
    buffer_load_dwordx4 v[136:139], v3, s[16:19], s48 offen offset:2048 sc1
    ds_read_b128 v[104:107], v8 offset:51200
    v_mul_f32 v61, v61, v77
    v_mul_f32 v62, v62, v78
    v_mfma_f32_32x32x16_bf16 v[32:47], a[36:39], v[108:111], v[32:47]
    s_waitcnt lgkmcnt(4)
    ds_read_b128 v[108:111], v8 offset:51712
    v_mul_f32 v63, v63, v79
    v_exp_f32 v60, v60
    v_exp_f32 v61, v61
    v_exp_f32 v62, v62
    v_mfma_f32_32x32x16_bf16 v[32:47], a[40:43], v[64:67], v[32:47]
    s_waitcnt lgkmcnt(4)
    s_waitcnt vmcnt(7)
    s_mov_b64 exec, 2
    buffer_store_dword v11, v16, s[92:95], s56 offen
    s_mov_b64 exec, -1
    ds_read_b128 v[64:67], v8 offset:52224
    v_exp_f32 v63, v63
    v_fma_f32 v60, v60, v190, v190
    v_fma_f32 v61, v61, v190, v190
    v_mfma_f32_32x32x16_bf16 v[32:47], a[44:47], v[68:71], v[32:47]
    s_waitcnt lgkmcnt(4)
    buffer_load_dwordx4 v[140:143], v3, s[16:19], s49 offen offset:2048 sc1
    ds_read_b128 v[68:71], v8 offset:52736
    v_fma_f32 v62, v62, v190, v190
    v_fma_f32 v63, v63, v190, v190
    v_rcp_f32 v60, v60
    v_rcp_f32 v61, v61
    v_mfma_f32_32x32x16_bf16 v[32:47], a[48:51], v[96:99], v[32:47]
    s_waitcnt lgkmcnt(4)
    buffer_load_dwordx4 v[112:115], v3, s[16:19], s48 offen offset:3072 sc1
    ds_read_b128 v[96:99], v8 offset:53248
    v_rcp_f32 v62, v62
    v_rcp_f32 v63, v63
    v_mul_f32 v76, v76, v60
    v_mul_f32 v77, v77, v61
    v_mfma_f32_32x32x16_bf16 v[32:47], a[52:55], v[100:103], v[32:47]
    s_waitcnt lgkmcnt(4)
    ds_read_b128 v[100:103], v8 offset:53760
    v_mul_f32 v78, v78, v62
    v_mul_f32 v79, v79, v63
    v_cvt_pk_bf16_f32 v90, v76, v77
    v_cvt_pk_bf16_f32 v91, v78, v79
    v_mfma_f32_32x32x16_bf16 v[32:47], a[56:59], v[104:107], v[32:47]
    s_waitcnt lgkmcnt(4)
    buffer_store_dwordx4 v[88:91], v20, s[16:19], s39 offen offset:0 sc1
    buffer_load_dwordx4 v[116:119], v3, s[16:19], s49 offen offset:3072 sc1
    ds_read_b128 v[104:107], v8 offset:54272
    v_mul_f32 v56, v80, v80
    v_mul_f32 v57, v81, v81
    v_mfma_f32_32x32x16_bf16 v[32:47], a[60:63], v[108:111], v[32:47]
    s_waitcnt lgkmcnt(4)
    ds_read_b128 v[108:111], v8 offset:54784
    v_mul_f32 v58, v82, v82
    v_mul_f32 v59, v83, v83
    v_fma_f32 v56, v56, v189, v188
    v_fma_f32 v57, v57, v189, v188
    v_fma_f32 v58, v58, v189, v188
    v_mfma_f32_32x32x16_bf16 v[32:47], a[64:67], v[64:67], v[32:47]
    s_waitcnt lgkmcnt(4)
    ds_read_b128 v[64:67], v8 offset:55296
    v_fma_f32 v59, v59, v189, v188
    v_mul_f32 v56, v56, v80
    v_mul_f32 v57, v57, v81
    v_mul_f32 v58, v58, v82
    v_mul_f32 v59, v59, v83
    v_mfma_f32_32x32x16_bf16 v[32:47], a[68:71], v[68:71], v[32:47]
    s_waitcnt lgkmcnt(4)
    buffer_load_dwordx4 v[120:123], v18, s[16:19], s48 offen offset:0 sc1
    ds_read_b128 v[68:71], v8 offset:55808
    v_exp_f32 v56, v56
    v_mfma_f32_32x32x16_bf16 v[32:47], a[72:75], v[96:99], v[32:47]
    s_waitcnt lgkmcnt(4)
    ds_read_b128 v[96:99], v8 offset:56320
    v_exp_f32 v57, v57
    v_exp_f32 v58, v58
    v_exp_f32 v59, v59
    v_fma_f32 v56, v56, v190, v190
    v_mfma_f32_32x32x16_bf16 v[32:47], a[76:79], v[100:103], v[32:47]
    s_waitcnt lgkmcnt(4)
    buffer_load_dwordx4 v[124:127], v18, s[16:19], s49 offen offset:0 sc1
    ds_read_b128 v[100:103], v8 offset:56832
    v_fma_f32 v57, v57, v190, v190
    v_fma_f32 v58, v58, v190, v190
    v_fma_f32 v59, v59, v190, v190
    v_mfma_f32_32x32x16_bf16 v[32:47], a[80:83], v[104:107], v[32:47]
    s_waitcnt lgkmcnt(4)
    ds_read_b128 v[104:107], v8 offset:57344
    v_rcp_f32 v56, v56
    v_rcp_f32 v57, v57
    v_rcp_f32 v58, v58
    v_rcp_f32 v59, v59
    v_mfma_f32_32x32x16_bf16 v[32:47], a[84:87], v[108:111], v[32:47]
    s_waitcnt lgkmcnt(4)
    buffer_load_dwordx4 a[196:199], v18, s[16:19], s48 offen offset:1024 sc1
    ds_read_b128 v[108:111], v8 offset:57856
    v_mul_f32 v80, v80, v56
    v_mul_f32 v81, v81, v57
    v_mul_f32 v82, v82, v58
    v_mul_f32 v83, v83, v59
    v_mfma_f32_32x32x16_bf16 v[32:47], a[88:91], v[64:67], v[32:47]
    s_waitcnt lgkmcnt(4)
    ds_read_b128 v[64:67], v8 offset:58368
    v_cvt_pk_bf16_f32 v92, v80, v81
    v_cvt_pk_bf16_f32 v93, v82, v83
    v_mul_f32 v60, v84, v84
    v_mul_f32 v61, v85, v85
    v_mul_f32 v62, v86, v86
    v_mfma_f32_32x32x16_bf16 v[32:47], a[92:95], v[68:71], v[32:47]
    s_waitcnt lgkmcnt(4)
    buffer_load_dwordx4 a[200:203], v18, s[16:19], s49 offen offset:1024 sc1
    ds_read_b128 v[68:71], v8 offset:58880
    v_mul_f32 v63, v87, v87
    v_fma_f32 v60, v60, v189, v188
    v_mfma_f32_32x32x16_bf16 v[32:47], a[96:99], v[96:99], v[32:47]
    s_waitcnt lgkmcnt(4)
    buffer_load_dword v31, v22, s[92:95], s56 offen offset:128 sc1
    ds_read_b128 v[96:99], v8 offset:59392
    v_fma_f32 v61, v61, v189, v188
    v_fma_f32 v62, v62, v189, v188
    v_fma_f32 v63, v63, v189, v188
    v_mul_f32 v60, v60, v84
    v_mfma_f32_32x32x16_bf16 v[32:47], a[100:103], v[100:103], v[32:47]
    s_waitcnt lgkmcnt(4)
    buffer_load_dwordx4 a[204:207], v18, s[16:19], s48 offen offset:2048 sc1
    ds_read_b128 v[100:103], v8 offset:59904
    v_mul_f32 v61, v61, v85
    v_mul_f32 v62, v62, v86
    v_mul_f32 v63, v63, v87
    v_mfma_f32_32x32x16_bf16 v[32:47], a[104:107], v[104:107], v[32:47]
    s_waitcnt lgkmcnt(4)
    ds_read_b128 v[104:107], v8 offset:60416
    v_exp_f32 v60, v60
    v_exp_f32 v61, v61
    v_exp_f32 v62, v62
    v_exp_f32 v63, v63
    v_mfma_f32_32x32x16_bf16 v[32:47], a[108:111], v[108:111], v[32:47]
    s_waitcnt lgkmcnt(4)
    buffer_load_dwordx4 a[208:211], v18, s[16:19], s49 offen offset:2048 sc1
    ds_read_b128 v[108:111], v8 offset:60928
    v_fma_f32 v60, v60, v190, v190
    v_fma_f32 v61, v61, v190, v190
    v_fma_f32 v62, v62, v190, v190
    v_fma_f32 v63, v63, v190, v190
    v_mfma_f32_32x32x16_bf16 v[32:47], a[112:115], v[64:67], v[32:47]
    s_waitcnt lgkmcnt(4)
    v_rcp_f32 v60, v60
    v_rcp_f32 v61, v61
    v_rcp_f32 v62, v62
    v_mfma_f32_32x32x16_bf16 v[32:47], a[116:119], v[68:71], v[32:47]
    s_waitcnt lgkmcnt(3)
    buffer_load_dwordx4 a[212:215], v18, s[16:19], s48 offen offset:3072 sc1
    v_rcp_f32 v63, v63
    v_mul_f32 v84, v84, v60
    v_mul_f32 v85, v85, v61
    v_mul_f32 v86, v86, v62
    v_mfma_f32_32x32x16_bf16 v[32:47], a[120:123], v[96:99], v[32:47]
    s_waitcnt lgkmcnt(2)
    v_mul_f32 v87, v87, v63
    v_cvt_pk_bf16_f32 v94, v84, v85
    v_cvt_pk_bf16_f32 v95, v86, v87
    v_mfma_f32_32x32x16_bf16 v[32:47], a[124:127], v[100:103], v[32:47]
    s_waitcnt lgkmcnt(1)
    buffer_store_dwordx4 v[92:95], v20, s[16:19], s39 offen offset:512 sc1
    buffer_load_dwordx4 a[216:219], v18, s[16:19], s49 offen offset:3072 sc1
    v_mfma_f32_32x32x16_bf16 v[32:47], a[128:131], v[104:107], v[32:47]
    s_waitcnt lgkmcnt(0)
    v_mfma_f32_32x32x16_bf16 v[32:47], a[132:135], v[108:111], v[32:47]
    v_mfma_f32_32x32x16_bf16 v[32:47], v[180:183], v[24:27], v[32:47]
    s_nop 11
    v_pk_mul_f32 v[56:57], v[32:33], v[32:33]
    v_pk_mul_f32 v[58:59], v[34:35], v[34:35]
    v_pk_fma_f32 v[56:57], v[56:57], v[28:29], v[28:29] op_sel:[0,1,0] op_sel_hi:[1,1,0]
    v_pk_fma_f32 v[58:59], v[58:59], v[28:29], v[28:29] op_sel:[0,1,0] op_sel_hi:[1,1,0]
    v_pk_mul_f32 v[56:57], v[56:57], v[32:33]
    v_pk_mul_f32 v[58:59], v[58:59], v[34:35]
    v_exp_f32 v56, v56
    v_exp_f32 v57, v57
    v_exp_f32 v58, v58
    v_exp_f32 v59, v59
    v_pk_fma_f32 v[56:57], v[56:57], v[30:31], v[30:31] op_sel_hi:[1,0,0]
    v_pk_fma_f32 v[58:59], v[58:59], v[30:31], v[30:31] op_sel_hi:[1,0,0]
    v_rcp_f32 v56, v56
    v_rcp_f32 v57, v57
    v_rcp_f32 v58, v58
    v_rcp_f32 v59, v59
    v_pk_mul_f32 v[32:33], v[32:33], v[56:57]
    v_pk_mul_f32 v[34:35], v[34:35], v[58:59]
    v_cvt_pk_bf16_f32 v48, v32, v33
    v_cvt_pk_bf16_f32 v49, v34, v35
    s_waitcnt vmcnt(5)
    v_cmp_ne_u32 vcc, s88, v31
    s_cbranch_vccnz mk_ps75
mk_pb76:
    v_pk_mul_f32 v[60:61], v[36:37], v[36:37]
    v_pk_mul_f32 v[62:63], v[38:39], v[38:39]
    v_pk_fma_f32 v[60:61], v[60:61], v[28:29], v[28:29] op_sel:[0,1,0] op_sel_hi:[1,1,0]
    v_pk_fma_f32 v[62:63], v[62:63], v[28:29], v[28:29] op_sel:[0,1,0] op_sel_hi:[1,1,0]
    buffer_load_dwordx4 a[220:223], v3, s[16:19], s50 offen offset:0 sc1
    v_pk_mul_f32 v[60:61], v[60:61], v[36:37]
    v_pk_mul_f32 v[62:63], v[62:63], v[38:39]
    v_exp_f32 v60, v60
    v_exp_f32 v61, v61
    v_exp_f32 v62, v62
    v_exp_f32 v63, v63
    v_pk_fma_f32 v[60:61], v[60:61], v[30:31], v[30:31] op_sel_hi:[1,0,0]
    v_pk_fma_f32 v[62:63], v[62:63], v[30:31], v[30:31] op_sel_hi:[1,0,0]
    v_rcp_f32 v60, v60
    v_rcp_f32 v61, v61
    v_rcp_f32 v62, v62
    v_rcp_f32 v63, v63
    buffer_load_dwordx4 a[224:227], v3, s[16:19], s51 offen offset:0 sc1
    v_pk_mul_f32 v[36:37], v[36:37], v[60:61]
    v_pk_mul_f32 v[38:39], v[38:39], v[62:63]
    v_cvt_pk_bf16_f32 v50, v36, v37
    v_cvt_pk_bf16_f32 v51, v38, v39
    buffer_store_dwordx4 v[48:51], v20, s[16:19], s40 offen offset:0 sc1
    v_pk_mul_f32 v[56:57], v[40:41], v[40:41]
    v_pk_mul_f32 v[58:59], v[42:43], v[42:43]
    v_pk_fma_f32 v[56:57], v[56:57], v[28:29], v[28:29] op_sel:[0,1,0] op_sel_hi:[1,1,0]
    v_pk_fma_f32 v[58:59], v[58:59], v[28:29], v[28:29] op_sel:[0,1,0] op_sel_hi:[1,1,0]
    v_pk_mul_f32 v[56:57], v[56:57], v[40:41]
    v_pk_mul_f32 v[58:59], v[58:59], v[42:43]
    v_exp_f32 v56, v56
    buffer_load_dwordx4 a[228:231], v3, s[16:19], s50 offen offset:1024 sc1
    v_exp_f32 v57, v57
    v_exp_f32 v58, v58
    v_exp_f32 v59, v59
    v_pk_fma_f32 v[56:57], v[56:57], v[30:31], v[30:31] op_sel_hi:[1,0,0]
    v_pk_fma_f32 v[58:59], v[58:59], v[30:31], v[30:31] op_sel_hi:[1,0,0]
    v_rcp_f32 v56, v56
    v_rcp_f32 v57, v57
    v_rcp_f32 v58, v58
    v_rcp_f32 v59, v59
    v_pk_mul_f32 v[40:41], v[40:41], v[56:57]
    v_pk_mul_f32 v[42:43], v[42:43], v[58:59]
    v_cvt_pk_bf16_f32 v52, v40, v41
    buffer_load_dwordx4 a[232:235], v3, s[16:19], s51 offen offset:1024 sc1
    v_cvt_pk_bf16_f32 v53, v42, v43
    v_pk_mul_f32 v[60:61], v[44:45], v[44:45]
    v_pk_mul_f32 v[62:63], v[46:47], v[46:47]
    v_pk_fma_f32 v[60:61], v[60:61], v[28:29], v[28:29] op_sel:[0,1,0] op_sel_hi:[1,1,0]
    v_pk_fma_f32 v[62:63], v[62:63], v[28:29], v[28:29] op_sel:[0,1,0] op_sel_hi:[1,1,0]
    v_pk_mul_f32 v[60:61], v[60:61], v[44:45]
    v_pk_mul_f32 v[62:63], v[62:63], v[46:47]
    v_exp_f32 v60, v60
    v_exp_f32 v61, v61
    v_exp_f32 v62, v62
    v_exp_f32 v63, v63
    v_pk_fma_f32 v[60:61], v[60:61], v[30:31], v[30:31] op_sel_hi:[1,0,0]
    buffer_load_dwordx4 v[192:195], v3, s[16:19], s50 offen offset:2048 sc1
    v_pk_fma_f32 v[62:63], v[62:63], v[30:31], v[30:31] op_sel_hi:[1,0,0]
    v_rcp_f32 v60, v60
    v_rcp_f32 v61, v61
    v_rcp_f32 v62, v62
    v_rcp_f32 v63, v63
    v_pk_mul_f32 v[44:45], v[44:45], v[60:61]
    v_pk_mul_f32 v[46:47], v[46:47], v[62:63]
    v_cvt_pk_bf16_f32 v54, v44, v45
    v_cvt_pk_bf16_f32 v55, v46, v47
    buffer_store_dwordx4 v[52:55], v20, s[16:19], s40 offen offset:512 sc1
    s_nop 0
    buffer_load_dwordx4 v[196:199], v3, s[16:19], s51 offen offset:2048 sc1
    v_mfma_f32_16x16x32_bf16 v[72:75], v[212:215], v[148:151], 0
    s_waitcnt vmcnt(9)
    s_mov_b64 exec, 4
    buffer_store_dword v11, v16, s[92:95], s56 offen
    s_mov_b64 exec, -1
    v_mfma_f32_16x16x32_bf16 v[76:79], v[216:219], v[148:151], 0
    v_mfma_f32_16x16x32_bf16 v[80:83], v[220:223], v[148:151], 0
    buffer_load_dwordx4 v[200:203], v3, s[16:19], s50 offen offset:3072 sc1
    v_mfma_f32_16x16x32_bf16 v[84:87], v[224:227], v[148:151], 0
    v_mfma_f32_16x16x32_bf16 v[88:91], v[228:231], v[148:151], 0
    v_mfma_f32_16x16x32_bf16 v[92:95], v[212:215], v[152:155], 0
    buffer_load_dwordx4 v[204:207], v3, s[16:19], s51 offen offset:3072 sc1
    v_mfma_f32_16x16x32_bf16 v[96:99], v[216:219], v[152:155], 0
    v_mfma_f32_16x16x32_bf16 v[100:103], v[220:223], v[152:155], 0
    v_mfma_f32_16x16x32_bf16 v[104:107], v[224:227], v[152:155], 0
    v_mfma_f32_16x16x32_bf16 v[108:111], v[228:231], v[152:155], 0
    buffer_load_dwordx4 v[208:211], v18, s[16:19], s50 offen offset:0 sc1
    v_mfma_f32_16x16x32_bf16 v[72:75], v[232:235], v[128:131], v[72:75]
    v_mfma_f32_16x16x32_bf16 v[76:79], v[236:239], v[128:131], v[76:79]
    v_mfma_f32_16x16x32_bf16 v[80:83], v[240:243], v[128:131], v[80:83]
    buffer_load_dwordx4 a[36:39], v18, s[16:19], s51 offen offset:0 sc1
    v_mfma_f32_16x16x32_bf16 v[84:87], v[244:247], v[128:131], v[84:87]
    v_mfma_f32_16x16x32_bf16 v[88:91], v[248:251], v[128:131], v[88:91]
    v_mfma_f32_16x16x32_bf16 v[92:95], v[232:235], v[132:135], v[92:95]
    buffer_load_dwordx4 a[40:43], v18, s[16:19], s50 offen offset:1024 sc1
    v_mfma_f32_16x16x32_bf16 v[96:99], v[236:239], v[132:135], v[96:99]
    v_mfma_f32_16x16x32_bf16 v[100:103], v[240:243], v[132:135], v[100:103]
    v_mfma_f32_16x16x32_bf16 v[104:107], v[244:247], v[132:135], v[104:107]
    buffer_load_dwordx4 a[44:47], v18, s[16:19], s51 offen offset:1024 sc1
    v_mfma_f32_16x16x32_bf16 v[108:111], v[248:251], v[132:135], v[108:111]
    v_mfma_f32_16x16x32_bf16 v[72:75], v[252:255], v[136:139], v[72:75]
    v_mfma_f32_16x16x32_bf16 v[76:79], a[0:3], v[136:139], v[76:79]
    buffer_load_dwordx4 a[48:51], v18, s[16:19], s50 offen offset:2048 sc1
    v_mfma_f32_16x16x32_bf16 v[80:83], a[4:7], v[136:139], v[80:83]
    v_mfma_f32_16x16x32_bf16 v[84:87], a[8:11], v[136:139], v[84:87]
    v_mfma_f32_16x16x32_bf16 v[88:91], a[12:15], v[136:139], v[88:91]
    buffer_load_dwordx4 a[52:55], v18, s[16:19], s51 offen offset:2048 sc1
    v_mfma_f32_16x16x32_bf16 v[92:95], v[252:255], v[140:143], v[92:95]
    v_mfma_f32_16x16x32_bf16 v[96:99], a[0:3], v[140:143], v[96:99]
    v_mfma_f32_16x16x32_bf16 v[100:103], a[4:7], v[140:143], v[100:103]
    buffer_load_dwordx4 a[56:59], v18, s[16:19], s50 offen offset:3072 sc1
    v_mfma_f32_16x16x32_bf16 v[104:107], a[8:11], v[140:143], v[104:107]
    buffer_load_dword v31, v23, s[92:95], s56 offen offset:256 sc1
    v_mfma_f32_16x16x32_bf16 v[108:111], a[12:15], v[140:143], v[108:111]
    v_mfma_f32_16x16x32_bf16 v[72:75], a[16:19], v[112:115], v[72:75]
    buffer_load_dwordx4 a[60:63], v18, s[16:19], s51 offen offset:3072 sc1
    v_mfma_f32_16x16x32_bf16 v[76:79], a[20:23], v[112:115], v[76:79]
    v_mfma_f32_16x16x32_bf16 v[80:83], a[24:27], v[112:115], v[80:83]
    buffer_load_dwordx4 a[96:99], v18, s[84:87], s65 offen offset:0 sc1
    v_mfma_f32_16x16x32_bf16 v[84:87], a[28:31], v[112:115], v[84:87]
    v_mfma_f32_16x16x32_bf16 v[88:91], a[32:35], v[112:115], v[88:91]
    v_mfma_f32_16x16x32_bf16 v[92:95], a[16:19], v[116:119], v[92:95]
    buffer_load_dwordx4 a[100:103], v18, s[84:87], s66 offen offset:0 sc1
    v_mfma_f32_16x16x32_bf16 v[96:99], a[20:23], v[116:119], v[96:99]
    v_mfma_f32_16x16x32_bf16 v[100:103], a[24:27], v[116:119], v[100:103]
    v_mfma_f32_16x16x32_bf16 v[104:107], a[28:31], v[116:119], v[104:107]
    buffer_load_dwordx4 a[104:107], v18, s[84:87], s67 offen offset:0 sc1
    v_mfma_f32_16x16x32_bf16 v[108:111], a[32:35], v[116:119], v[108:111]
    v_mfma_f32_16x16x32_bf16 v[72:75], a[236:239], v[120:123], v[72:75]
    v_mfma_f32_16x16x32_bf16 v[76:79], a[240:243], v[120:123], v[76:79]
    buffer_load_dwordx4 a[108:111], v18, s[84:87], s68 offen offset:0 sc1
    v_mfma_f32_16x16x32_bf16 v[80:83], a[244:247], v[120:123], v[80:83]
    v_mfma_f32_16x16x32_bf16 v[84:87], a[248:251], v[120:123], v[84:87]
    v_mfma_f32_16x16x32_bf16 v[88:91], a[252:255], v[120:123], v[88:91]
    s_waitcnt vmcnt(17)
    s_mov_b64 exec, 8
    buffer_store_dword v11, v16, s[92:95], s56 offen
    s_mov_b64 exec, -1
    v_mfma_f32_16x16x32_bf16 v[92:95], a[236:239], v[124:127], v[92:95]
    buffer_load_dwordx4 a[112:115], v18, s[84:87], s69 offen offset:0 sc1
    v_mfma_f32_16x16x32_bf16 v[96:99], a[240:243], v[124:127], v[96:99]
    v_mfma_f32_16x16x32_bf16 v[100:103], a[244:247], v[124:127], v[100:103]
    buffer_load_dwordx4 a[116:119], v10, s[84:87], s65 offen offset:1024 sc1
    v_mfma_f32_16x16x32_bf16 v[104:107], a[248:251], v[124:127], v[104:107]
    v_mfma_f32_16x16x32_bf16 v[108:111], a[252:255], v[124:127], v[108:111]
    v_mfma_f32_16x16x32_bf16 v[72:75], a[136:139], a[196:199], v[72:75]
    buffer_load_dwordx4 a[120:123], v10, s[84:87], s66 offen offset:1024 sc1
    v_mfma_f32_16x16x32_bf16 v[76:79], a[140:143], a[196:199], v[76:79]
    v_mfma_f32_16x16x32_bf16 v[80:83], a[144:147], a[196:199], v[80:83]
    v_mfma_f32_16x16x32_bf16 v[84:87], a[148:151], a[196:199], v[84:87]
    buffer_load_dwordx4 a[124:127], v10, s[84:87], s67 offen offset:1024 sc1
    v_mfma_f32_16x16x32_bf16 v[88:91], a[152:155], a[196:199], v[88:91]
    v_mfma_f32_16x16x32_bf16 v[92:95], a[136:139], a[200:203], v[92:95]
    v_mfma_f32_16x16x32_bf16 v[96:99], a[140:143], a[200:203], v[96:99]
    buffer_load_dwordx4 a[128:131], v10, s[84:87], s68 offen offset:1024 sc1
    v_mfma_f32_16x16x32_bf16 v[100:103], a[144:147], a[200:203], v[100:103]
    v_mfma_f32_16x16x32_bf16 v[104:107], a[148:151], a[200:203], v[104:107]
    buffer_load_dwordx4 a[132:135], v10, s[84:87], s69 offen offset:1024 sc1
    v_mfma_f32_16x16x32_bf16 v[108:111], a[152:155], a[200:203], v[108:111]
    v_mfma_f32_16x16x32_bf16 v[72:75], a[156:159], a[204:207], v[72:75]
    s_waitcnt vmcnt(12)
    v_cmp_ne_u32 vcc, s88, v31
    s_cbranch_vccnz mk_ps80
mk_pb81:
    v_mfma_f32_16x16x32_bf16 v[76:79], a[160:163], a[204:207], v[76:79]
    buffer_load_dwordx4 a[64:67], v3, s[16:19], s52 offen offset:0 sc1
    v_mfma_f32_16x16x32_bf16 v[80:83], a[164:167], a[204:207], v[80:83]
    v_mfma_f32_16x16x32_bf16 v[84:87], a[168:171], a[204:207], v[84:87]
    v_mfma_f32_16x16x32_bf16 v[88:91], a[172:175], a[204:207], v[88:91]
    buffer_load_dwordx4 a[68:71], v3, s[16:19], s52 offen offset:1024 sc1
    v_mfma_f32_16x16x32_bf16 v[92:95], a[156:159], a[208:211], v[92:95]
    v_mfma_f32_16x16x32_bf16 v[96:99], a[160:163], a[208:211], v[96:99]
    v_mfma_f32_16x16x32_bf16 v[100:103], a[164:167], a[208:211], v[100:103]
    v_mfma_f32_16x16x32_bf16 v[104:107], a[168:171], a[208:211], v[104:107]
    buffer_load_dwordx4 a[72:75], v3, s[16:19], s52 offen offset:2048 sc1
    v_mfma_f32_16x16x32_bf16 v[108:111], a[172:175], a[208:211], v[108:111]
    v_mfma_f32_16x16x32_bf16 v[72:75], a[176:179], a[212:215], v[72:75]
    v_mfma_f32_16x16x32_bf16 v[76:79], a[180:183], a[212:215], v[76:79]
    v_mfma_f32_16x16x32_bf16 v[80:83], a[184:187], a[212:215], v[80:83]
    buffer_load_dwordx4 a[76:79], v3, s[16:19], s52 offen offset:3072 sc1
    v_mfma_f32_16x16x32_bf16 v[84:87], a[188:191], a[212:215], v[84:87]
    buffer_load_dword v31, v23, s[92:95], s56 offen offset:384 sc1
    v_mfma_f32_16x16x32_bf16 v[88:91], a[192:195], a[212:215], v[88:91]
    v_mfma_f32_16x16x32_bf16 v[92:95], a[176:179], a[216:219], v[92:95]
    v_mfma_f32_16x16x32_bf16 v[96:99], a[180:183], a[216:219], v[96:99]
    buffer_load_dwordx4 a[80:83], v18, s[16:19], s52 offen offset:0 sc1
    v_mfma_f32_16x16x32_bf16 v[100:103], a[184:187], a[216:219], v[100:103]
    v_mfma_f32_16x16x32_bf16 v[104:107], a[188:191], a[216:219], v[104:107]
    v_mfma_f32_16x16x32_bf16 v[108:111], a[192:195], a[216:219], v[108:111]
    v_mfma_f32_16x16x32_bf16 v[32:35], v[212:215], a[220:223], 0
    buffer_load_dwordx4 a[84:87], v10, s[16:19], s52 offen offset:1024 sc1
    v_mfma_f32_16x16x32_bf16 v[36:39], v[216:219], a[220:223], 0
    v_mfma_f32_16x16x32_bf16 v[40:43], v[220:223], a[220:223], 0
    v_mfma_f32_16x16x32_bf16 v[44:47], v[224:227], a[220:223], 0
    v_mfma_f32_16x16x32_bf16 v[48:51], v[228:231], a[220:223], 0
    buffer_load_dwordx4 a[88:91], v3, s[16:19], s53 offen offset:0 sc1
    v_mfma_f32_16x16x32_bf16 v[52:55], v[212:215], a[224:227], 0
    v_mfma_f32_16x16x32_bf16 v[56:59], v[216:219], a[224:227], 0
    v_mfma_f32_16x16x32_bf16 v[60:63], v[220:223], a[224:227], 0
    v_mfma_f32_16x16x32_bf16 v[64:67], v[224:227], a[224:227], 0
    buffer_load_dwordx4 a[92:95], v3, s[16:19], s53 offen offset:1024 sc1
    v_mfma_f32_16x16x32_bf16 v[68:71], v[228:231], a[224:227], 0
    v_mfma_f32_16x16x32_bf16 v[32:35], v[232:235], a[228:231], v[32:35]
    ds_read_b128 v[212:215], v9 offset:0
    v_mfma_f32_16x16x32_bf16 v[36:39], v[236:239], a[228:231], v[36:39]
    v_mfma_f32_16x16x32_bf16 v[40:43], v[240:243], a[228:231], v[40:43]
    buffer_load_dwordx4 v[176:179], v3, s[16:19], s53 offen offset:2048 sc1
    v_mfma_f32_16x16x32_bf16 v[44:47], v[244:247], a[228:231], v[44:47]
    ds_read_b128 v[216:219], v9 offset:4096
    v_mfma_f32_16x16x32_bf16 v[48:51], v[248:251], a[228:231], v[48:51]
    ds_read_b128 v[220:223], v9 offset:8192
    v_mfma_f32_16x16x32_bf16 v[52:55], v[232:235], a[232:235], v[52:55]
    v_mfma_f32_16x16x32_bf16 v[56:59], v[236:239], a[232:235], v[56:59]
    buffer_load_dwordx4 v[180:183], v3, s[16:19], s53 offen offset:3072 sc1
    v_mfma_f32_16x16x32_bf16 v[60:63], v[240:243], a[232:235], v[60:63]
    ds_read_b128 v[224:227], v9 offset:12288
    v_mfma_f32_16x16x32_bf16 v[64:67], v[244:247], a[232:235], v[64:67]
    ds_read_b128 v[228:231], v9 offset:16384
    v_mfma_f32_16x16x32_bf16 v[68:71], v[248:251], a[232:235], v[68:71]
    v_mfma_f32_16x16x32_bf16 v[32:35], v[252:255], v[192:195], v[32:35]
    buffer_load_dwordx4 v[184:187], v18, s[16:19], s53 offen offset:0 sc1
    v_mfma_f32_16x16x32_bf16 v[36:39], a[0:3], v[192:195], v[36:39]
    ds_read_b128 v[232:235], v9 offset:1024
    v_mfma_f32_16x16x32_bf16 v[40:43], a[4:7], v[192:195], v[40:43]
    ds_read_b128 v[236:239], v9 offset:5120
    v_mfma_f32_16x16x32_bf16 v[44:47], a[8:11], v[192:195], v[44:47]
    v_mfma_f32_16x16x32_bf16 v[48:51], a[12:15], v[192:195], v[48:51]
    buffer_load_dwordx4 v[188:191], v10, s[16:19], s53 offen offset:1024 sc1
    v_mfma_f32_16x16x32_bf16 v[52:55], v[252:255], v[196:199], v[52:55]
    ds_read_b128 v[240:243], v9 offset:9216
    s_waitcnt vmcnt(8)
    v_cmp_ne_u32 vcc, s88, v31
    s_cbranch_vccnz mk_ps85
mk_pb86:
    v_mfma_f32_16x16x32_bf16 v[56:59], a[0:3], v[196:199], v[56:59]
    buffer_load_dwordx4 v[148:151], v3, s[16:19], s55 offen offset:0 sc1
    v_mfma_f32_16x16x32_bf16 v[60:63], a[4:7], v[196:199], v[60:63]
    ds_read_b128 v[244:247], v9 offset:13312
    v_mfma_f32_16x16x32_bf16 v[64:67], a[8:11], v[196:199], v[64:67]
    ds_read_b128 v[248:251], v9 offset:17408
    v_mfma_f32_16x16x32_bf16 v[68:71], a[12:15], v[196:199], v[68:71]
    buffer_load_dwordx4 v[152:155], v3, s[16:19], s55 offen offset:1024 sc1
    v_mfma_f32_16x16x32_bf16 v[32:35], a[16:19], v[200:203], v[32:35]
    ds_read_b128 v[252:255], v9 offset:2048
    v_mfma_f32_16x16x32_bf16 v[36:39], a[20:23], v[200:203], v[36:39]
    v_mfma_f32_16x16x32_bf16 v[40:43], a[24:27], v[200:203], v[40:43]
    ds_read_b128 a[0:3], v9 offset:6144
    v_mfma_f32_16x16x32_bf16 v[44:47], a[28:31], v[200:203], v[44:47]
    v_mfma_f32_16x16x32_bf16 v[48:51], a[32:35], v[200:203], v[48:51]
    buffer_load_dwordx4 v[128:131], v3, s[16:19], s55 offen offset:2048 sc1
    v_mfma_f32_16x16x32_bf16 v[52:55], a[16:19], v[204:207], v[52:55]
    ds_read_b128 a[4:7], v9 offset:10240
    v_mfma_f32_16x16x32_bf16 v[56:59], a[20:23], v[204:207], v[56:59]
    ds_read_b128 a[8:11], v9 offset:14336
    v_mfma_f32_16x16x32_bf16 v[60:63], a[24:27], v[204:207], v[60:63]
    v_mfma_f32_16x16x32_bf16 v[64:67], a[28:31], v[204:207], v[64:67]
    ds_read_b128 a[12:15], v9 offset:18432
    v_mfma_f32_16x16x32_bf16 v[68:71], a[32:35], v[204:207], v[68:71]
    buffer_load_dwordx4 v[132:135], v3, s[16:19], s55 offen offset:3072 sc1
    v_mfma_f32_16x16x32_bf16 v[32:35], a[236:239], v[208:211], v[32:35]
    ds_read_b128 a[16:19], v9 offset:3072
    v_mfma_f32_16x16x32_bf16 v[36:39], a[240:243], v[208:211], v[36:39]
    v_mfma_f32_16x16x32_bf16 v[40:43], a[244:247], v[208:211], v[40:43]
    ds_read_b128 a[20:23], v9 offset:7168
    v_mfma_f32_16x16x32_bf16 v[44:47], a[248:251], v[208:211], v[44:47]
    buffer_load_dwordx4 v[136:139], v18, s[16:19], s55 offen offset:0 sc1
    v_mfma_f32_16x16x32_bf16 v[48:51], a[252:255], v[208:211], v[48:51]
    ds_read_b128 a[24:27], v9 offset:11264
    v_mfma_f32_16x16x32_bf16 v[52:55], a[236:239], a[36:39], v[52:55]
    v_mfma_f32_16x16x32_bf16 v[56:59], a[240:243], a[36:39], v[56:59]
    ds_read_b128 a[28:31], v9 offset:15360
    v_mfma_f32_16x16x32_bf16 v[60:63], a[244:247], a[36:39], v[60:63]
    v_mfma_f32_16x16x32_bf16 v[64:67], a[248:251], a[36:39], v[64:67]
    buffer_load_dwordx4 v[140:143], v10, s[16:19], s55 offen offset:1024 sc1
    v_mfma_f32_16x16x32_bf16 v[68:71], a[252:255], a[36:39], v[68:71]
    ds_read_b128 a[32:35], v9 offset:19456
    v_mfma_f32_16x16x32_bf16 v[32:35], a[136:139], a[40:43], v[32:35]
    v_mfma_f32_16x16x32_bf16 v[36:39], a[140:143], a[40:43], v[36:39]
    v_mfma_f32_16x16x32_bf16 v[40:43], a[144:147], a[40:43], v[40:43]
    v_mfma_f32_16x16x32_bf16 v[44:47], a[148:151], a[40:43], v[44:47]
    buffer_load_dwordx4 v[112:115], v3, s[16:19], s54 offen offset:0 sc1
    v_mfma_f32_16x16x32_bf16 v[48:51], a[152:155], a[40:43], v[48:51]
    v_mfma_f32_16x16x32_bf16 v[52:55], a[136:139], a[44:47], v[52:55]
    v_mfma_f32_16x16x32_bf16 v[56:59], a[140:143], a[44:47], v[56:59]
    v_mfma_f32_16x16x32_bf16 v[60:63], a[144:147], a[44:47], v[60:63]
    v_mfma_f32_16x16x32_bf16 v[64:67], a[148:151], a[44:47], v[64:67]
    buffer_load_dwordx4 v[116:119], v3, s[16:19], s54 offen offset:1024 sc1
    v_mfma_f32_16x16x32_bf16 v[68:71], a[152:155], a[44:47], v[68:71]
    v_mfma_f32_16x16x32_bf16 v[32:35], a[156:159], a[48:51], v[32:35]
    v_mfma_f32_16x16x32_bf16 v[36:39], a[160:163], a[48:51], v[36:39]
    v_mfma_f32_16x16x32_bf16 v[40:43], a[164:167], a[48:51], v[40:43]
    buffer_load_dwordx4 v[120:123], v3, s[16:19], s54 offen offset:2048 sc1
    v_mfma_f32_16x16x32_bf16 v[44:47], a[168:171], a[48:51], v[44:47]
    v_mfma_f32_16x16x32_bf16 v[48:51], a[172:175], a[48:51], v[48:51]
    v_mfma_f32_16x16x32_bf16 v[52:55], a[156:159], a[52:55], v[52:55]
    v_mfma_f32_16x16x32_bf16 v[56:59], a[160:163], a[52:55], v[56:59]
    v_mfma_f32_16x16x32_bf16 v[60:63], a[164:167], a[52:55], v[60:63]
    buffer_load_dwordx4 v[124:127], v3, s[16:19], s54 offen offset:3072 sc1
    v_mfma_f32_16x16x32_bf16 v[64:67], a[168:171], a[52:55], v[64:67]
    v_mfma_f32_16x16x32_bf16 v[68:71], a[172:175], a[52:55], v[68:71]
    v_mfma_f32_16x16x32_bf16 v[32:35], a[176:179], a[56:59], v[32:35]
    v_mfma_f32_16x16x32_bf16 v[36:39], a[180:183], a[56:59], v[36:39]
    v_mfma_f32_16x16x32_bf16 v[40:43], a[184:187], a[56:59], v[40:43]
    buffer_load_dwordx4 a[196:199], v18, s[16:19], s54 offen offset:0 sc1
    v_mfma_f32_16x16x32_bf16 v[44:47], a[188:191], a[56:59], v[44:47]
    v_mfma_f32_16x16x32_bf16 v[48:51], a[192:195], a[56:59], v[48:51]
    v_mfma_f32_16x16x32_bf16 v[52:55], a[176:179], a[60:63], v[52:55]
    v_mfma_f32_16x16x32_bf16 v[56:59], a[180:183], a[60:63], v[56:59]
    buffer_load_dwordx4 a[200:203], v10, s[16:19], s54 offen offset:1024 sc1
    v_mfma_f32_16x16x32_bf16 v[60:63], a[184:187], a[60:63], v[60:63]
    v_mfma_f32_16x16x32_bf16 v[64:67], a[188:191], a[60:63], v[64:67]
    v_mfma_f32_16x16x32_bf16 v[68:71], a[192:195], a[60:63], v[68:71]
    s_waitcnt lgkmcnt(15)
    v_mfma_f32_16x16x32_bf16 v[72:75], v[212:215], a[64:67], v[72:75]
    s_lshr_b32 s26, s3, 1
    s_mul_i32 s26, s26, 10240
    s_xor_b32 s27, s3, 1
    v_mfma_f32_16x16x32_bf16 v[76:79], v[216:219], a[64:67], v[76:79]
    s_mul_i32 s27, s27, 20480
    s_add_u32 s27, s27, s26
    s_add_u32 s27, s27, 87040
    v_mfma_f32_16x16x32_bf16 v[80:83], v[220:223], a[64:67], v[80:83]
    v_add_u32 v12, s27, v3
    s_xor_b32 s27, s3, 2
    v_mfma_f32_16x16x32_bf16 v[84:87], v[224:227], a[64:67], v[84:87]
    s_mul_i32 s27, s27, 20480
    s_add_u32 s27, s27, s26
    s_add_u32 s27, s27, 81920
    v_mfma_f32_16x16x32_bf16 v[88:91], v[228:231], a[64:67], v[88:91]
    s_waitcnt lgkmcnt(14)
    v_add_u32 v13, s27, v3
    s_xor_b32 s27, s3, 3
    v_mfma_f32_16x16x32_bf16 v[72:75], v[232:235], a[68:71], v[72:75]
    s_waitcnt lgkmcnt(13)
    s_mul_i32 s27, s27, 20480
    s_add_u32 s27, s27, s26
    v_mfma_f32_16x16x32_bf16 v[76:79], v[236:239], a[68:71], v[76:79]
    s_waitcnt lgkmcnt(12)
    s_add_u32 s27, s27, 87040
    v_add_u32 v14, s27, v3
    v_mfma_f32_16x16x32_bf16 v[80:83], v[240:243], a[68:71], v[80:83]
    s_waitcnt lgkmcnt(11)
    v_mfma_f32_16x16x32_bf16 v[84:87], v[244:247], a[68:71], v[84:87]
    s_waitcnt lgkmcnt(10)
    v_mfma_f32_16x16x32_bf16 v[88:91], v[248:251], a[68:71], v[88:91]
    s_waitcnt lgkmcnt(9)
    v_mfma_f32_16x16x32_bf16 v[72:75], v[252:255], a[72:75], v[72:75]
    s_waitcnt lgkmcnt(8)
    v_mfma_f32_16x16x32_bf16 v[76:79], a[0:3], a[72:75], v[76:79]
    s_waitcnt lgkmcnt(7)
    v_mfma_f32_16x16x32_bf16 v[80:83], a[4:7], a[72:75], v[80:83]
    s_waitcnt lgkmcnt(6)
    v_mfma_f32_16x16x32_bf16 v[84:87], a[8:11], a[72:75], v[84:87]
    s_waitcnt lgkmcnt(5)
    v_mfma_f32_16x16x32_bf16 v[88:91], a[12:15], a[72:75], v[88:91]
    s_waitcnt lgkmcnt(4)
    v_mfma_f32_16x16x32_bf16 v[72:75], a[16:19], a[76:79], v[72:75]
    s_waitcnt lgkmcnt(3)
    v_mfma_f32_16x16x32_bf16 v[76:79], a[20:23], a[76:79], v[76:79]
    s_waitcnt lgkmcnt(2)
    v_mfma_f32_16x16x32_bf16 v[80:83], a[24:27], a[76:79], v[80:83]
    s_waitcnt lgkmcnt(1)
    v_mfma_f32_16x16x32_bf16 v[84:87], a[28:31], a[76:79], v[84:87]
    s_waitcnt lgkmcnt(0)
    v_mfma_f32_16x16x32_bf16 v[88:91], a[32:35], a[76:79], v[88:91]
    s_waitcnt vmcnt(19)
    v_mfma_f32_16x16x32_bf16 v[72:75], a[96:99], a[80:83], v[72:75]
    v_mfma_f32_16x16x32_bf16 v[76:79], a[100:103], a[80:83], v[76:79]
    v_mfma_f32_16x16x32_bf16 v[80:83], a[104:107], a[80:83], v[80:83]
    v_mfma_f32_16x16x32_bf16 v[84:87], a[108:111], a[80:83], v[84:87]
    v_mfma_f32_16x16x32_bf16 v[88:91], a[112:115], a[80:83], v[88:91]
    s_waitcnt vmcnt(18)
    v_mfma_f32_16x16x32_bf16 v[72:75], a[116:119], a[84:87], v[72:75]
    v_mfma_f32_16x16x32_bf16 v[76:79], a[120:123], a[84:87], v[76:79]
    v_mfma_f32_16x16x32_bf16 v[80:83], a[124:127], a[84:87], v[80:83]
    v_mfma_f32_16x16x32_bf16 v[84:87], a[128:131], a[84:87], v[84:87]
    v_mfma_f32_16x16x32_bf16 v[88:91], a[132:135], a[84:87], v[88:91]
    s_waitcnt vmcnt(17)
    v_mfma_f32_16x16x32_bf16 v[92:95], v[212:215], a[88:91], v[92:95]
    v_mfma_f32_16x16x32_bf16 v[96:99], v[216:219], a[88:91], v[96:99]
    v_mfma_f32_16x16x32_bf16 v[100:103], v[220:223], a[88:91], v[100:103]
    v_mfma_f32_16x16x32_bf16 v[104:107], v[224:227], a[88:91], v[104:107]
    ds_write_b128 v9, v[72:75] offset:0
    v_mfma_f32_16x16x32_bf16 v[108:111], v[228:231], a[88:91], v[108:111]
    s_waitcnt vmcnt(16)
    v_mfma_f32_16x16x32_bf16 v[92:95], v[232:235], a[92:95], v[92:95]
    v_mfma_f32_16x16x32_bf16 v[96:99], v[236:239], a[92:95], v[96:99]
    v_mfma_f32_16x16x32_bf16 v[100:103], v[240:243], a[92:95], v[100:103]
    v_mfma_f32_16x16x32_bf16 v[104:107], v[244:247], a[92:95], v[104:107]
    ds_write_b128 v9, v[76:79] offset:1024
    v_mfma_f32_16x16x32_bf16 v[108:111], v[248:251], a[92:95], v[108:111]
    s_waitcnt vmcnt(15)
    v_mfma_f32_16x16x32_bf16 v[92:95], v[252:255], v[176:179], v[92:95]
    v_mfma_f32_16x16x32_bf16 v[96:99], a[0:3], v[176:179], v[96:99]
    v_mfma_f32_16x16x32_bf16 v[100:103], a[4:7], v[176:179], v[100:103]
    v_mfma_f32_16x16x32_bf16 v[104:107], a[8:11], v[176:179], v[104:107]
    ds_write_b128 v9, v[80:83] offset:2048
    v_mfma_f32_16x16x32_bf16 v[108:111], a[12:15], v[176:179], v[108:111]
    s_waitcnt vmcnt(14)
    v_mfma_f32_16x16x32_bf16 v[92:95], a[16:19], v[180:183], v[92:95]
    v_mfma_f32_16x16x32_bf16 v[96:99], a[20:23], v[180:183], v[96:99]
    v_mfma_f32_16x16x32_bf16 v[100:103], a[24:27], v[180:183], v[100:103]
    v_mfma_f32_16x16x32_bf16 v[104:107], a[28:31], v[180:183], v[104:107]
    ds_write_b128 v9, v[84:87] offset:3072
    v_mfma_f32_16x16x32_bf16 v[108:111], a[32:35], v[180:183], v[108:111]
    s_waitcnt vmcnt(13)
    v_mfma_f32_16x16x32_bf16 v[92:95], a[96:99], v[184:187], v[92:95]
    v_mfma_f32_16x16x32_bf16 v[96:99], a[100:103], v[184:187], v[96:99]
    v_mfma_f32_16x16x32_bf16 v[100:103], a[104:107], v[184:187], v[100:103]
    v_mfma_f32_16x16x32_bf16 v[104:107], a[108:111], v[184:187], v[104:107]
    ds_write_b128 v9, v[88:91] offset:4096
    v_mfma_f32_16x16x32_bf16 v[108:111], a[112:115], v[184:187], v[108:111]
    s_waitcnt vmcnt(12)
    v_mfma_f32_16x16x32_bf16 v[92:95], a[116:119], v[188:191], v[92:95]
    v_mfma_f32_16x16x32_bf16 v[96:99], a[120:123], v[188:191], v[96:99]
    v_mfma_f32_16x16x32_bf16 v[100:103], a[124:127], v[188:191], v[100:103]
    v_mfma_f32_16x16x32_bf16 v[104:107], a[128:131], v[188:191], v[104:107]
    v_mfma_f32_16x16x32_bf16 v[108:111], a[132:135], v[188:191], v[108:111]
    s_waitcnt vmcnt(11)
    v_mfma_f32_16x16x32_bf16 v[52:55], v[212:215], v[148:151], v[52:55]
    v_mfma_f32_16x16x32_bf16 v[56:59], v[216:219], v[148:151], v[56:59]
    v_mfma_f32_16x16x32_bf16 v[60:63], v[220:223], v[148:151], v[60:63]
    v_mfma_f32_16x16x32_bf16 v[64:67], v[224:227], v[148:151], v[64:67]
    ds_write_b128 v9, v[92:95] offset:5120
    v_mfma_f32_16x16x32_bf16 v[68:71], v[228:231], v[148:151], v[68:71]
    s_waitcnt vmcnt(10)
    v_mfma_f32_16x16x32_bf16 v[52:55], v[232:235], v[152:155], v[52:55]
    v_mfma_f32_16x16x32_bf16 v[56:59], v[236:239], v[152:155], v[56:59]
    v_mfma_f32_16x16x32_bf16 v[60:63], v[240:243], v[152:155], v[60:63]
    v_mfma_f32_16x16x32_bf16 v[64:67], v[244:247], v[152:155], v[64:67]
    ds_write_b128 v9, v[96:99] offset:6144
    v_mfma_f32_16x16x32_bf16 v[68:71], v[248:251], v[152:155], v[68:71]
    s_waitcnt vmcnt(9)
    v_mfma_f32_16x16x32_bf16 v[52:55], v[252:255], v[128:131], v[52:55]
    v_mfma_f32_16x16x32_bf16 v[56:59], a[0:3], v[128:131], v[56:59]
    v_mfma_f32_16x16x32_bf16 v[60:63], a[4:7], v[128:131], v[60:63]
    v_mfma_f32_16x16x32_bf16 v[64:67], a[8:11], v[128:131], v[64:67]
    ds_write_b128 v9, v[100:103] offset:7168
    v_mfma_f32_16x16x32_bf16 v[68:71], a[12:15], v[128:131], v[68:71]
    s_waitcnt vmcnt(8)
    v_mfma_f32_16x16x32_bf16 v[52:55], a[16:19], v[132:135], v[52:55]
    v_mfma_f32_16x16x32_bf16 v[56:59], a[20:23], v[132:135], v[56:59]
    v_mfma_f32_16x16x32_bf16 v[60:63], a[24:27], v[132:135], v[60:63]
    v_mfma_f32_16x16x32_bf16 v[64:67], a[28:31], v[132:135], v[64:67]
    ds_write_b128 v9, v[104:107] offset:8192
    v_mfma_f32_16x16x32_bf16 v[68:71], a[32:35], v[132:135], v[68:71]
    s_waitcnt vmcnt(7)
    v_mfma_f32_16x16x32_bf16 v[52:55], a[96:99], v[136:139], v[52:55]
    v_mfma_f32_16x16x32_bf16 v[56:59], a[100:103], v[136:139], v[56:59]
    v_mfma_f32_16x16x32_bf16 v[60:63], a[104:107], v[136:139], v[60:63]
    v_mfma_f32_16x16x32_bf16 v[64:67], a[108:111], v[136:139], v[64:67]
    ds_write_b128 v9, v[108:111] offset:9216
    v_mfma_f32_16x16x32_bf16 v[68:71], a[112:115], v[136:139], v[68:71]
    s_waitcnt vmcnt(6)
    v_mfma_f32_16x16x32_bf16 v[52:55], a[116:119], v[140:143], v[52:55]
    v_mfma_f32_16x16x32_bf16 v[56:59], a[120:123], v[140:143], v[56:59]
    v_mfma_f32_16x16x32_bf16 v[60:63], a[124:127], v[140:143], v[60:63]
    v_mfma_f32_16x16x32_bf16 v[64:67], a[128:131], v[140:143], v[64:67]
    v_mfma_f32_16x16x32_bf16 v[68:71], a[132:135], v[140:143], v[68:71]
    s_waitcnt vmcnt(5)
    v_mfma_f32_16x16x32_bf16 v[32:35], v[212:215], v[112:115], v[32:35]
    v_mfma_f32_16x16x32_bf16 v[36:39], v[216:219], v[112:115], v[36:39]
    v_mfma_f32_16x16x32_bf16 v[40:43], v[220:223], v[112:115], v[40:43]
    v_mfma_f32_16x16x32_bf16 v[44:47], v[224:227], v[112:115], v[44:47]
    ds_write_b128 v9, v[52:55] offset:15360
    v_mfma_f32_16x16x32_bf16 v[48:51], v[228:231], v[112:115], v[48:51]
    s_waitcnt vmcnt(4)
    v_mfma_f32_16x16x32_bf16 v[32:35], v[232:235], v[116:119], v[32:35]
    v_mfma_f32_16x16x32_bf16 v[36:39], v[236:239], v[116:119], v[36:39]
    v_mfma_f32_16x16x32_bf16 v[40:43], v[240:243], v[116:119], v[40:43]
    v_mfma_f32_16x16x32_bf16 v[44:47], v[244:247], v[116:119], v[44:47]
    ds_write_b128 v9, v[56:59] offset:16384
    v_mfma_f32_16x16x32_bf16 v[48:51], v[248:251], v[116:119], v[48:51]
    s_waitcnt vmcnt(3)
    v_mfma_f32_16x16x32_bf16 v[32:35], v[252:255], v[120:123], v[32:35]
    v_mfma_f32_16x16x32_bf16 v[36:39], a[0:3], v[120:123], v[36:39]
    v_mfma_f32_16x16x32_bf16 v[40:43], a[4:7], v[120:123], v[40:43]
    v_mfma_f32_16x16x32_bf16 v[44:47], a[8:11], v[120:123], v[44:47]
    ds_write_b128 v9, v[60:63] offset:17408
    v_mfma_f32_16x16x32_bf16 v[48:51], a[12:15], v[120:123], v[48:51]
    s_waitcnt vmcnt(2)
    v_mfma_f32_16x16x32_bf16 v[32:35], a[16:19], v[124:127], v[32:35]
    v_mfma_f32_16x16x32_bf16 v[36:39], a[20:23], v[124:127], v[36:39]
    v_mfma_f32_16x16x32_bf16 v[40:43], a[24:27], v[124:127], v[40:43]
    v_mfma_f32_16x16x32_bf16 v[44:47], a[28:31], v[124:127], v[44:47]
    ds_write_b128 v9, v[64:67] offset:18432
    v_mfma_f32_16x16x32_bf16 v[48:51], a[32:35], v[124:127], v[48:51]
    s_waitcnt vmcnt(1)
    v_mfma_f32_16x16x32_bf16 v[32:35], a[96:99], a[196:199], v[32:35]
    s_mov_b64 exec, 15
    buffer_store_dword v11, v16, s[92:95], 0 offen sc1
    s_mov_b64 exec, -1
    v_mfma_f32_16x16x32_bf16 v[36:39], a[100:103], a[196:199], v[36:39]
    v_mfma_f32_16x16x32_bf16 v[40:43], a[104:107], a[196:199], v[40:43]
    v_mfma_f32_16x16x32_bf16 v[44:47], a[108:111], a[196:199], v[44:47]
    ds_write_b128 v9, v[68:71] offset:19456
    v_mfma_f32_16x16x32_bf16 v[48:51], a[112:115], a[196:199], v[48:51]
    s_waitcnt vmcnt(1)
    v_mfma_f32_16x16x32_bf16 v[32:35], a[116:119], a[200:203], v[32:35]
    v_mfma_f32_16x16x32_bf16 v[36:39], a[120:123], a[200:203], v[36:39]
    v_mfma_f32_16x16x32_bf16 v[40:43], a[124:127], a[200:203], v[40:43]
    v_mfma_f32_16x16x32_bf16 v[44:47], a[128:131], a[200:203], v[44:47]
    v_mfma_f32_16x16x32_bf16 v[48:51], a[132:135], a[200:203], v[48:51]
    s_cmp_lt_u32 s3, 2
    s_cbranch_scc0 mk_fa90
    s_nop 1
    ds_write_b128 v9, v[32:35] offset:10240
    ds_write_b128 v9, v[36:39] offset:11264
    ds_write_b128 v9, v[40:43] offset:12288
    ds_write_b128 v9, v[44:47] offset:13312
    ds_write_b128 v9, v[48:51] offset:14336
mk_fa90:
    s_waitcnt lgkmcnt(0)
    s_barrier
    s_cbranch_scc0 mk_fb91
    ds_read_b128 v[32:35], v13 offset:0
    ds_read_b128 v[36:39], v13 offset:1024
    ds_read_b128 v[40:43], v13 offset:2048
    ds_read_b128 v[44:47], v13 offset:3072
    ds_read_b128 v[48:51], v13 offset:4096
    s_branch mk_fc92
mk_fb91:
    ds_read_b128 v[72:75], v13 offset:0
    ds_read_b128 v[76:79], v13 offset:1024
    ds_read_b128 v[80:83], v13 offset:2048
    ds_read_b128 v[84:87], v13 offset:3072
    ds_read_b128 v[88:91], v13 offset:4096
mk_fc92:
    ds_read_b128 v[92:95], v12 offset:0
    ds_read_b128 v[52:55], v14 offset:0
    ds_read_b128 v[96:99], v12 offset:1024
    ds_read_b128 v[56:59], v14 offset:1024
    ds_read_b128 v[100:103], v12 offset:2048
    ds_read_b128 v[60:63], v14 offset:2048
    ds_read_b128 v[104:107], v12 offset:3072
    ds_read_b128 v[64:67], v14 offset:3072
    ds_read_b128 v[108:111], v12 offset:4096
    ds_read_b128 v[68:71], v14 offset:4096
    s_waitcnt lgkmcnt(8)
    v_pk_add_f32 v[32:33], v[32:33], v[52:53]
    v_pk_add_f32 v[72:73], v[72:73], v[92:93]
    v_pk_add_f32 v[34:35], v[34:35], v[54:55]
    v_pk_add_f32 v[74:75], v[74:75], v[94:95]
    v_pk_add_f32 v[32:33], v[32:33], v[72:73]
    v_pk_add_f32 v[34:35], v[34:35], v[74:75]
    v_cvt_pk_bf16_f32 v28, v32, v33
    v_cvt_pk_bf16_f32 v29, v34, v35
    v_lshlrev_b32 v32, 16, v28
    v_and_b32 v33, 0xffff0000, v28
    v_lshlrev_b32 v34, 16, v29
    v_and_b32 v35, 0xffff0000, v29
    v_lshlrev_b32 v24, 16, v166
    v_and_b32 v25, 0xffff0000, v166
    v_lshlrev_b32 v26, 16, v167
    v_and_b32 v27, 0xffff0000, v167
    v_pk_add_f32 v[32:33], v[32:33], v[24:25]
    v_pk_add_f32 v[34:35], v[34:35], v[26:27]
    v_cvt_pk_bf16_f32 v28, v32, v33
    v_cvt_pk_bf16_f32 v29, v34, v35
    v_lshlrev_b32 v32, 16, v28
    v_and_b32 v33, 0xffff0000, v28
    v_lshlrev_b32 v34, 16, v29
    v_and_b32 v35, 0xffff0000, v29
    v_lshlrev_b32 v24, 16, v156
    v_and_b32 v25, 0xffff0000, v156
    v_lshlrev_b32 v26, 16, v157
    v_and_b32 v27, 0xffff0000, v157
    v_pk_add_f32 v[32:33], v[32:33], v[24:25]
    v_pk_add_f32 v[34:35], v[34:35], v[26:27]
    v_cvt_pk_bf16_f32 v32, v32, v33
    v_cvt_pk_bf16_f32 v33, v34, v35
    buffer_store_dwordx2 v[32:33], v21, s[8:11], 0 offen offset:0
    s_waitcnt lgkmcnt(6)
    v_pk_add_f32 v[36:37], v[36:37], v[56:57]
    v_pk_add_f32 v[76:77], v[76:77], v[96:97]
    v_pk_add_f32 v[38:39], v[38:39], v[58:59]
    v_pk_add_f32 v[78:79], v[78:79], v[98:99]
    v_pk_add_f32 v[36:37], v[36:37], v[76:77]
    v_pk_add_f32 v[38:39], v[38:39], v[78:79]
    v_cvt_pk_bf16_f32 v28, v36, v37
    v_cvt_pk_bf16_f32 v29, v38, v39
    v_lshlrev_b32 v36, 16, v28
    v_and_b32 v37, 0xffff0000, v28
    v_lshlrev_b32 v38, 16, v29
    v_and_b32 v39, 0xffff0000, v29
    v_lshlrev_b32 v24, 16, v168
    v_and_b32 v25, 0xffff0000, v168
    v_lshlrev_b32 v26, 16, v169
    v_and_b32 v27, 0xffff0000, v169
    v_pk_add_f32 v[36:37], v[36:37], v[24:25]
    v_pk_add_f32 v[38:39], v[38:39], v[26:27]
    v_cvt_pk_bf16_f32 v28, v36, v37
    v_cvt_pk_bf16_f32 v29, v38, v39
    v_lshlrev_b32 v36, 16, v28
    v_and_b32 v37, 0xffff0000, v28
    v_lshlrev_b32 v38, 16, v29
    v_and_b32 v39, 0xffff0000, v29
    v_lshlrev_b32 v24, 16, v158
    v_and_b32 v25, 0xffff0000, v158
    v_lshlrev_b32 v26, 16, v159
    v_and_b32 v27, 0xffff0000, v159
    v_pk_add_f32 v[36:37], v[36:37], v[24:25]
    v_pk_add_f32 v[38:39], v[38:39], v[26:27]
    v_cvt_pk_bf16_f32 v36, v36, v37
    v_cvt_pk_bf16_f32 v37, v38, v39
    buffer_store_dwordx2 v[36:37], v21, s[8:11], 0 offen offset:32
    s_waitcnt lgkmcnt(4)
    v_pk_add_f32 v[40:41], v[40:41], v[60:61]
    v_pk_add_f32 v[80:81], v[80:81], v[100:101]
    v_pk_add_f32 v[42:43], v[42:43], v[62:63]
    v_pk_add_f32 v[82:83], v[82:83], v[102:103]
    v_pk_add_f32 v[40:41], v[40:41], v[80:81]
    v_pk_add_f32 v[42:43], v[42:43], v[82:83]
    v_cvt_pk_bf16_f32 v28, v40, v41
    v_cvt_pk_bf16_f32 v29, v42, v43
    v_lshlrev_b32 v40, 16, v28
    v_and_b32 v41, 0xffff0000, v28
    v_lshlrev_b32 v42, 16, v29
    v_and_b32 v43, 0xffff0000, v29
    v_lshlrev_b32 v24, 16, v170
    v_and_b32 v25, 0xffff0000, v170
    v_lshlrev_b32 v26, 16, v171
    v_and_b32 v27, 0xffff0000, v171
    v_pk_add_f32 v[40:41], v[40:41], v[24:25]
    v_pk_add_f32 v[42:43], v[42:43], v[26:27]
    v_cvt_pk_bf16_f32 v28, v40, v41
    v_cvt_pk_bf16_f32 v29, v42, v43
    v_lshlrev_b32 v40, 16, v28
    v_and_b32 v41, 0xffff0000, v28
    v_lshlrev_b32 v42, 16, v29
    v_and_b32 v43, 0xffff0000, v29
    v_lshlrev_b32 v24, 16, v160
    v_and_b32 v25, 0xffff0000, v160
    v_lshlrev_b32 v26, 16, v161
    v_and_b32 v27, 0xffff0000, v161
    v_pk_add_f32 v[40:41], v[40:41], v[24:25]
    v_pk_add_f32 v[42:43], v[42:43], v[26:27]
    v_cvt_pk_bf16_f32 v40, v40, v41
    v_cvt_pk_bf16_f32 v41, v42, v43
    buffer_store_dwordx2 v[40:41], v21, s[8:11], 0 offen offset:64
    s_waitcnt lgkmcnt(2)
    v_pk_add_f32 v[44:45], v[44:45], v[64:65]
    v_pk_add_f32 v[84:85], v[84:85], v[104:105]
    v_pk_add_f32 v[46:47], v[46:47], v[66:67]
    v_pk_add_f32 v[86:87], v[86:87], v[106:107]
    v_pk_add_f32 v[44:45], v[44:45], v[84:85]
    v_pk_add_f32 v[46:47], v[46:47], v[86:87]
    v_cvt_pk_bf16_f32 v28, v44, v45
    v_cvt_pk_bf16_f32 v29, v46, v47
    v_lshlrev_b32 v44, 16, v28
    v_and_b32 v45, 0xffff0000, v28
    v_lshlrev_b32 v46, 16, v29
    v_and_b32 v47, 0xffff0000, v29
    v_lshlrev_b32 v24, 16, v172
    v_and_b32 v25, 0xffff0000, v172
    v_lshlrev_b32 v26, 16, v173
    v_and_b32 v27, 0xffff0000, v173
    v_pk_add_f32 v[44:45], v[44:45], v[24:25]
    v_pk_add_f32 v[46:47], v[46:47], v[26:27]
    v_cvt_pk_bf16_f32 v28, v44, v45
    v_cvt_pk_bf16_f32 v29, v46, v47
    v_lshlrev_b32 v44, 16, v28
    v_and_b32 v45, 0xffff0000, v28
    v_lshlrev_b32 v46, 16, v29
    v_and_b32 v47, 0xffff0000, v29
    v_lshlrev_b32 v24, 16, v162
    v_and_b32 v25, 0xffff0000, v162
    v_lshlrev_b32 v26, 16, v163
    v_and_b32 v27, 0xffff0000, v163
    v_pk_add_f32 v[44:45], v[44:45], v[24:25]
    v_pk_add_f32 v[46:47], v[46:47], v[26:27]
    v_cvt_pk_bf16_f32 v44, v44, v45
    v_cvt_pk_bf16_f32 v45, v46, v47
    buffer_store_dwordx2 v[44:45], v21, s[8:11], 0 offen offset:96
    s_waitcnt lgkmcnt(0)
    v_pk_add_f32 v[48:49], v[48:49], v[68:69]
    v_pk_add_f32 v[88:89], v[88:89], v[108:109]
    v_pk_add_f32 v[50:51], v[50:51], v[70:71]
    v_pk_add_f32 v[90:91], v[90:91], v[110:111]
    v_pk_add_f32 v[48:49], v[48:49], v[88:89]
    v_pk_add_f32 v[50:51], v[50:51], v[90:91]
    v_cvt_pk_bf16_f32 v28, v48, v49
    v_cvt_pk_bf16_f32 v29, v50, v51
    v_lshlrev_b32 v48, 16, v28
    v_and_b32 v49, 0xffff0000, v28
    v_lshlrev_b32 v50, 16, v29
    v_and_b32 v51, 0xffff0000, v29
    v_lshlrev_b32 v24, 16, v174
    v_and_b32 v25, 0xffff0000, v174
    v_lshlrev_b32 v26, 16, v175
    v_and_b32 v27, 0xffff0000, v175
    v_pk_add_f32 v[48:49], v[48:49], v[24:25]
    v_pk_add_f32 v[50:51], v[50:51], v[26:27]
    v_cvt_pk_bf16_f32 v28, v48, v49
    v_cvt_pk_bf16_f32 v29, v50, v51
    v_lshlrev_b32 v48, 16, v28
    v_and_b32 v49, 0xffff0000, v28
    v_lshlrev_b32 v50, 16, v29
    v_and_b32 v51, 0xffff0000, v29
    v_lshlrev_b32 v24, 16, v164
    v_and_b32 v25, 0xffff0000, v164
    v_lshlrev_b32 v26, 16, v165
    v_and_b32 v27, 0xffff0000, v165
    v_pk_add_f32 v[48:49], v[48:49], v[24:25]
    v_pk_add_f32 v[50:51], v[50:51], v[26:27]
    v_cvt_pk_bf16_f32 v48, v48, v49
    v_cvt_pk_bf16_f32 v49, v50, v51
    buffer_store_dwordx2 v[48:49], v21, s[8:11], 0 offen offset:128
    s_or_b32 s28, s2, s3
    s_cmp_lg_u32 s28, 0
    s_cbranch_scc1 mk_nz93
    v_mov_b32 v4, s88
    s_mov_b32 s28, 40896
    s_mov_b64 exec, 1
    buffer_store_dword v4, off, s[92:95], s28 sc1
    s_mov_b64 exec, -1
mk_nz93:
mk_exit:
    s_endpgm
.section .rodata,"a"
.p2align 6
.amdhsa_kernel mk_kernel
  .amdhsa_next_free_vgpr 512
  .amdhsa_next_free_sgpr 102
  .amdhsa_accum_offset 256
  .amdhsa_group_segment_fixed_size 0
  .amdhsa_kernarg_size 120
  .amdhsa_user_sgpr_count 2
  .amdhsa_user_sgpr_kernarg_segment_ptr 1
  .amdhsa_system_sgpr_workgroup_id_x 1
.end_amdhsa_kernel
.p2align 8
mk_tbl:
.long 97976,28152,63064,11264,94232,24408,59320,11272,90488,20664,55576,12800,86744,16920,51832,12808
.long 97968,28144,63056,11280,94224,24400,59312,11288,90480,20656,55568,12816,86736,16912,51824,12824
.long 97960,28136,63048,11296,94216,24392,59304,11304,90472,20648,55560,12832,86728,16904,51816,12840
.long 97952,28128,63040,11312,94208,24384,59296,11320,90464,20640,55552,12848,86720,16896,51808,12856
.long 97992,28168,63080,11392,94248,24424,59336,11400,90504,20680,55592,12928,86760,16936,51848,12936
.long 97984,28160,63072,11408,94240,24416,59328,11416,90496,20672,55584,12944,86752,16928,51840,12952
.long 97976,28152,63064,11424,94232,24408,59320,11432,90488,20664,55576,12960,86744,16920,51832,12968
.long 97968,28144,63056,11440,94224,24400,59312,11448,90480,20656,55568,12976,86736,16912,51824,12984
.long 98152,28328,63240,29784,94408,24584,59496,29792,90664,20840,55752,31320,86920,17096,52008,31328
.long 98144,28320,63232,29800,94400,24576,59488,29808,90656,20832,55744,31336,86912,17088,52000,31344
.long 98136,28312,63224,29816,94392,24568,59480,29824,90648,20824,55736,31352,86904,17080,51992,31360
.long 98128,28304,63216,29832,94384,24560,59472,29840,90640,20816,55728,31368,86896,17072,51984,31376
.long 98168,28344,63256,29912,94424,24600,59512,29920,90680,20856,55768,31448,86936,17112,52024,31456
.long 98160,28336,63248,29928,94416,24592,59504,29936,90672,20848,55760,31464,86928,17104,52016,31472
.long 98152,28328,63240,29944,94408,24584,59496,29952,90664,20840,55752,31480,86920,17096,52008,31488
.long 98144,28320,63232,29960,94400,24576,59488,29968,90656,20832,55744,31496,86912,17088,52000,31504
.long 18552,81088,88376,120736,18560,81096,88384,120752,18568,82624,88392,120768,18576,82632,88400,120784
.long 18584,81104,88408,120800,18592,81112,88416,120816,18600,82640,88424,120832,18608,82648,88432,120848
.long 18616,81120,88440,120864,18624,81128,88448,120880,18632,82656,88456,120896,18640,82664,88464,120912
.long 18648,81136,88472,120928,18656,81144,88480,120944,18664,82672,88488,120960,18672,82680,88496,120976
.long 18808,81216,88632,123808,18816,81224,88640,123824,18824,82752,88648,123840,18832,82760,88656,123856
.long 18840,81232,88664,123872,18848,81240,88672,123888,18856,82768,88680,123904,18864,82776,88688,123920
.long 18872,81248,88696,123936,18880,81256,88704,123952,18888,82784,88712,123968,18896,82792,88720,123984
.long 18904,81264,88728,124000,18912,81272,88736,124016,18920,82800,88744,124032,18928,82808,88752,124048
.long 22280,99608,92104,122272,22288,99616,92112,122288,22296,101144,92120,122304,22304,101152,92128,122320
.long 22312,99624,92136,122336,22320,99632,92144,122352,22328,101160,92152,122368,22336,101168,92160,122384
.long 22344,99640,92168,122400,22352,99648,92176,122416,22360,101176,92184,122432,22368,101184,92192,122448
.long 22376,99656,92200,122464,22384,99664,92208,122480,22392,101192,92216,122496,22400,101200,92224,122512
.long 22536,99736,92360,125344,22544,99744,92368,125360,22552,101272,92376,125376,22560,101280,92384,125392
.long 22568,99752,92392,125408,22576,99760,92400,125424,22584,101288,92408,125440,22592,101296,92416,125456
.long 22600,99768,92424,125472,22608,99776,92432,125488,22616,101304,92440,125504,22624,101312,92448,125520
.long 22632,99784,92456,125536,22640,99792,92464,125552,22648,101320,92472,125568,22656,101328,92480,125584
.long 126880,104736,104736,0,126912,104752,104752,16,126944,104768,104768,32,126976,104784,104784,48
.long 127008,104800,104800,64,127040,104816,104816,80,127072,104832,104832,96,127104,104848,104848,112
.long 127136,104864,104864,81920,127168,104880,104880,81936,127200,104896,104896,81952,127232,104912,104912,81968
.long 127264,104928,104928,81984,127296,104944,104944,82000,127328,104960,104960,82016,127360,104976,104976,82032
.long 128928,105008,104992,163840,128960,105024,105008,163856,128992,105040,105024,163872,129024,105056,105040,163888
.long 129056,105072,105056,163904,129088,105088,105072,163920,129120,105104,105088,163936,129152,105120,105104,163952
.long 129184,105136,105120,245760,129216,105152,105136,245776,129248,105168,105152,245792,129280,105184,105168,245808
.long 129312,105200,105184,245824,129344,105216,105200,245840,129376,105232,105216,245856,129408,105248,105232,245872
.long 126896,105280,105248,327680,126928,105296,105264,327696,126960,105312,105280,327712,126992,105328,105296,327728
.long 127024,105344,105312,327744,127056,105360,105328,327760,127088,105376,105344,327776,127120,105392,105360,327792
.long 127152,105408,105376,409600,127184,105424,105392,409616,127216,105440,105408,409632,127248,105456,105424,409648
.long 127280,105472,105440,409664,127312,105488,105456,409680,127344,105504,105472,409696,127376,105520,105488,409712
.long 128944,105552,105504,491520,128976,105568,105520,491536,129008,105584,105536,491552,129040,105600,105552,491568
.long 129072,105616,105568,491584,129104,105632,105584,491600,129136,105648,105600,491616,129168,105664,105616,491632
.long 129200,105680,105632,573440,129232,105696,105648,573456,129264,105712,105664,573472,129296,105728,105680,573488
.long 129328,105744,105696,573504,129360,105760,105712,573520,129392,105776,105728,573536,129424,105792,105744,573552
.long 126944,126944,126944,126944,120320,120304,120288,120272,120192,120176,120160,120144,120048,120032,120016,120000
.long 119920,119904,119888,119872,119776,119760,119744,119728,119648,119632,119616,119600,119504,119488,119472,119456
.long 119376,119360,119344,119328,119232,119216,119200,119184,119104,119088,119072,119056,118960,118944,118928,118912
.long 118832,118816,118800,118784,118688,118672,118656,118640,118560,118544,118528,118512,118416,118400,118384,118368
.long 118288,118272,118256,118240,118144,118128,118112,118096,118016,118000,117984,117968,117872,117856,117840,117824
.long 117744,117728,117712,117696,117600,117584,117568,117552,117472,117456,117440,117424,117328,117312,117296,117280
.long 117200,117184,117168,117152,117056,117040,117024,117008,116928,116912,116896,116880,116784,116768,116752,116736
.long 116656,116640,116624,116608,116512,116496,116480,116464,116384,116368,116352,116336,116240,116224,116208,116192
.long 116112,116096,116080,116064,126944,126944,126944,126944,122496,122464,122432,122400,122224,122192,122160,122128
.long 121952,121920,121888,121856,121680,121648,121616,121584,121408,121376,121344,121312,121136,121104,121072,121040
.long 120864,120832,120800,120768,120592,120560,120528,120496,126944,126944,126944,126944,122528,122480,122448,122416
.long 122256,122208,122176,122144,121984,121936,121904,121872,121712,121664,121632,121600,121440,121392,121360,121328
.long 121168,121120,121088,121056,120896,120848,120816,120784,120624,120576,120544,120512,126944,126944,126944,126944
.long 124672,124640,124608,124576,124400,124368,124336,124304,124128,124096,124064,124032,123856,123824,123792,123760
.long 123584,123552,123520,123488,123312,123280,123248,123216,123040,123008,122976,122944,122768,122736,122704,122672
.long 126944,126944,126944,126944,124704,124656,124624,124592,124432,124384,124352,124320,124160,124112,124080,124048
.long 126944,126944,120352,120352,120256,120240,120224,120208,120128,120112,120096,120080,119984,119968,119952,119936
.long 119856,119840,119824,119808,119712,119696,119680,119664,119584,119568,119552,119536,119440,119424,119408,119392
.long 119312,119296,119280,119264,119168,119152,119136,119120,119040,119024,119008,118992,118896,118880,118864,118848
.long 118768,118752,118736,118720,118624,118608,118592,118576,118496,118480,118464,118448,118352,118336,118320,118304
.long 118224,118208,118192,118176,118080,118064,118048,118032,117952,117936,117920,117904,117808,117792,117776,117760
.long 117680,117664,117648,117632,117536,117520,117504,117488,117408,117392,117376,117360,117264,117248,117232,117216
.long 117136,117120,117104,117088,116992,116976,116960,116944,116864,116848,116832,116816,116720,116704,116688,116672
.long 116592,116576,116560,116544,116448,116432,116416,116400,116320,116304,116288,116272,116176,116160,116144,116128
.long 116048,116032,116016,116000,126944,126944,126944,122528,122368,122336,122304,122272,122096,122064,122032,122000
.long 121824,121792,121760,121728,121552,121520,121488,121456,121280,121248,121216,121184,121008,120976,120944,120912
.long 120736,120704,120672,120640,120464,120432,120400,120368,126944,126944,126944,126944,122384,122352,122320,122288
.long 122112,122080,122048,122016,121840,121808,121776,121744,121568,121536,121504,121472,121296,121264,121232,121200
.long 121024,120992,120960,120928,120752,120720,120688,120656,120480,120448,120416,120384,126944,126944,126944,124704
.long 124544,124512,124480,124448,124272,124240,124208,124176,124000,123968,123936,123904,123728,123696,123664,123632
.long 123456,123424,123392,123360,123184,123152,123120,123088,122912,122880,122848,122816,122640,122608,122576,122544
.long 126944,126944,126944,126944,124560,124528,124496,124464,124288,124256,124224,124192,124016,123984,123952,123920
.long 120320,120304,120288,16944,120192,120176,120160,16960,120048,120032,120016,16976,119920,119904,119888,16992
.long 119776,119760,119744,17008,119648,119632,119616,17024,119504,119488,119472,17040,119376,119360,119344,17056
.long 119232,119216,119200,17072,119104,119088,119072,17088,118960,118944,118928,17104,118832,118816,118800,17120
.long 118688,118672,118656,17136,118560,118544,118528,17152,118416,118400,118384,17168,118288,118272,118256,17184
.long 118144,118128,118112,17200,118016,118000,117984,17216,117872,117856,117840,17232,117744,117728,117712,17248
.long 117600,117584,117568,17264,117472,117456,117440,17280,117328,117312,117296,17296,117200,117184,117168,17312
.long 117056,117040,117024,17328,116928,116912,116896,17344,116784,116768,116752,17360,116656,116640,116624,17376
.long 116512,116496,116480,17392,116384,116368,116352,17408,116240,116224,116208,17424,116112,116096,116080,17440
.long 126944,126944,126944,17456,122496,122464,122432,17504,122224,122192,122160,17520,121952,121920,121888,17536
.long 121680,121648,121616,17552,121408,121376,121344,17568,121136,121104,121072,17584,120864,120832,120800,17600
.long 120592,120560,120528,17616,126944,126944,126944,17632,122528,122480,122448,17680,122256,122208,122176,17696
.long 121984,121936,121904,17712,121712,121664,121632,17728,121440,121392,121360,17744,121168,121120,121088,17760
.long 120896,120848,120816,17776,120624,120576,120544,17792,126944,126944,126944,17808,124672,124640,124608,17856
.long 124400,124368,124336,17872,124128,124096,124064,17888,123856,123824,123792,17904,123584,123552,123520,17920
.long 123312,123280,123248,17936,123040,123008,122976,17952,122768,122736,122704,17968,126944,126944,126944,17984
.long 124704,124656,124624,18032,124432,124384,124352,18048,124160,124112,124080,18064,123888,123840,123808,18080
.long 0,864,6652,864,16,880,6668,896,32,896,6684,928,48,912,6700,960
.long 128,928,6716,992,144,944,6732,1024,160,960,6748,1056,176,976,6764,1088
.long 64,992,6780,1152,80,1008,6796,1184,96,1024,6812,1216,112,1040,6828,1248
.long 192,1056,6844,1280,208,1072,6860,1312,224,1088,6876,1344,240,1104,6892,1376
.long 20480,1152,6908,1440,20496,1168,6924,1472,20512,1184,6940,1504,20528,1200,6956,1536
.long 20608,1216,6972,1568,20624,1232,6988,1600,20640,1248,7004,1632,20656,1264,7020,1664
.long 20544,1280,7036,1728,20560,1296,7052,1760,20576,1312,7068,1792,20592,1328,7084,1824
.long 20672,1344,7100,1856,20688,1360,7116,1888,20704,1376,7132,1920,20720,1392,7148,1952
.long 256,1440,7164,800,272,1456,7180,864,288,1472,7196,896,304,1488,7212,928
.long 384,1504,7228,960,400,1520,7244,992,416,1536,7260,1024,432,1552,7276,1056
.long 320,1568,7292,1088,336,1584,7308,1152,352,1600,7324,1184,368,1616,7340,1216
.long 448,1632,7356,1248,464,1648,7372,1280,480,1664,7388,1312,496,1680,7404,1344
.long 20736,1728,7420,1376,20752,1744,7436,1440,20768,1760,7452,1472,20784,1776,7468,1504
.long 20864,1792,7484,1536,20880,1808,7500,1568,20896,1824,7516,1600,20912,1840,7532,1632
.long 20800,1856,7548,1664,20816,1872,7564,1728,20832,1888,7580,1760,20848,1904,7596,1792
.long 20928,1920,7612,1824,20944,1936,7628,1856,20960,1952,7644,1888,20976,1968,7660,1920
.long 5632,4294965808,4294965856,20480,5664,4294965856,4294965872,20496,5696,4294965872,4294965888,20512,5728,4294965888,4294965904,20528
.long 5760,4294965904,4294965920,20544,5792,4294965920,4294965936,20560,5824,4294965936,4294965952,20576,5856,4294965952,4294965968,20592
.long 5888,4294965968,4294965984,20608,5920,4294965984,4294966000,20624,5952,4294966000,4294966016,20640,5984,4294966016,4294966032,20656
.long 6016,4294966032,4294966048,20672,6048,4294966048,4294966064,20688,6080,4294966064,4294966080,20704,6112,4294966080,4294966096,20720
.long 6144,4294966096,4294966144,20736,6176,4294966144,4294966160,20752,6208,4294966160,4294966176,20768,6240,4294966176,4294966192,20784
.long 6272,4294966192,4294966208,20800,6304,4294966208,4294966224,20816,6336,4294966224,4294966240,20832,6368,4294966240,4294966256,20848
.long 6400,4294966256,4294966272,20864,6432,4294966272,4294966288,20880,6464,4294966288,4294966304,20896,6496,4294966304,4294966320,20912
.long 6528,4294966320,4294966336,20928,6560,4294966336,4294966352,20944,6592,4294966352,4294966368,20960,6624,4294966368,4294966384,20976
.long 5648,4294966384,4294966432,3648,5680,4294966432,4294966448,3664,5712,4294966448,4294966464,3680,5744,4294966464,4294966480,3696
.long 5776,4294966480,4294966496,3712,5808,4294966496,4294966512,3728,5840,4294966512,4294966528,3744,5872,4294966528,4294966544,3760
.long 5904,4294966544,4294966560,3776,5936,4294966560,4294966576,3792,5968,4294966576,4294966592,3808,6000,4294966592,4294966608,3824
.long 6032,4294966608,4294966624,3840,6064,4294966624,4294966640,3856,6096,4294966640,4294966656,3872,6128,4294966656,4294966672,3888
.long 6160,4294966672,4294966720,3904,6192,4294966720,4294966736,3920,6224,4294966736,4294966752,3936,6256,4294966752,4294966768,3952
.long 6288,4294966768,4294966784,3968,6320,4294966784,4294966800,3984,6352,4294966800,4294966816,4000,6384,4294966816,4294966832,4016
.long 6416,4294966832,4294966848,4032,6448,4294966848,4294966864,4048,6480,4294966864,4294966880,4064,6512,4294966880,4294966896,4080
.long 6544,4294966896,4294966912,4080,6576,4294966912,4294966928,4080,6608,4294966928,4294966944,4080,6640,4294966944,4294966960,4080
.long 97976,28152,63064,6136,94232,24408,59320,7032,90488,20664,55576,7928,86744,16920,51832,8824
.long 97968,28144,63056,6144,94224,24400,59312,7040,90480,20656,55568,7936,86736,16912,51824,8832
.long 97960,28136,63048,6152,94216,24392,59304,7048,90472,20648,55560,7944,86728,16904,51816,8840
.long 97952,28128,63040,6160,94208,24384,59296,7056,90464,20640,55552,7952,86720,16896,51808,8848
.long 97992,28168,63080,6200,94248,24424,59336,7096,90504,20680,55592,7992,86760,16936,51848,8888
.long 97984,28160,63072,6208,94240,24416,59328,7104,90496,20672,55584,8000,86752,16928,51840,8896
.long 97976,28152,63064,6216,94232,24408,59320,7112,90488,20664,55576,8008,86744,16920,51832,8904
.long 97968,28144,63056,6224,94224,24400,59312,7120,90480,20656,55568,8016,86736,16912,51824,8912
.long 98152,28328,63240,11776,94408,24584,59496,12672,90664,20840,55752,13568,86920,17096,52008,14464
.long 98144,28320,63232,11784,94400,24576,59488,12680,90656,20832,55744,13576,86912,17088,52000,14472
.long 98136,28312,63224,11792,94392,24568,59480,12688,90648,20824,55736,13584,86904,17080,51992,14480
.long 98128,28304,63216,11800,94384,24560,59472,12696,90640,20816,55728,13592,86896,17072,51984,14488
.long 98168,28344,63256,11840,94424,24600,59512,12736,90680,20856,55768,13632,86936,17112,52024,14528
.long 98160,28336,63248,11848,94416,24592,59504,12744,90672,20848,55760,13640,86928,17104,52016,14536
.long 98152,28328,63240,11856,94408,24584,59496,12752,90664,20840,55752,13648,86920,17096,52008,14544
.long 98144,28320,63232,11864,94400,24576,59488,12760,90656,20832,55744,13656,86912,17088,52000,14552
.long 6136,75960,75960,113440,7032,76856,76856,117088,7928,77752,77752,113456,8824,78648,78648,117104
.long 6144,75968,75968,113472,7040,76864,76864,117120,7936,77760,77760,113488,8832,78656,78656,117136
.long 6152,75976,75976,113504,7048,76872,76872,117152,7944,77768,77768,113520,8840,78664,78664,117168
.long 6160,75984,75984,113536,7056,76880,76880,117184,7952,77776,77776,113552,8848,78672,78672,117200
.long 6200,76024,76024,114336,7096,76920,76920,117984,7992,77816,77816,114352,8888,78712,78712,118000
.long 6208,76032,76032,114368,7104,76928,76928,118016,8000,77824,77824,114384,8896,78720,78720,118032
.long 6216,76040,76040,114400,7112,76936,76936,118048,8008,77832,77832,114416,8904,78728,78728,118064
.long 6224,76048,76048,114432,7120,76944,76944,118080,8016,77840,77840,114448,8912,78736,78736,118096
.long 11776,81600,81600,115232,12672,82496,82496,118880,13568,83392,83392,115248,14464,84288,84288,118896
.long 11784,81608,81608,115264,12680,82504,82504,118912,13576,83400,83400,115280,14472,84296,84296,118928
.long 11792,81616,81616,115296,12688,82512,82512,118944,13584,83408,83408,115312,14480,84304,84304,118960
.long 11800,81624,81624,115328,12696,82520,82520,118976,13592,83416,83416,115344,14488,84312,84312,118992
.long 11840,81664,81664,116128,12736,82560,82560,119776,13632,83456,83456,116144,14528,84352,84352,119792
.long 11848,81672,81672,116160,12744,82568,82568,119808,13640,83464,83464,116176,14536,84360,84360,119824
.long 11856,81680,81680,116192,12752,82576,82576,119840,13648,83472,83472,116208,14544,84368,84368,119856
.long 11864,81688,81688,116224,12760,82584,82584,119872,13656,83480,83480,116240,14552,84376,84376,119888
.long 0,105824,105760,655360,0,105840,105776,655376,0,105856,105792,655392,0,105872,105808,655408
.long 0,105888,105824,655424,0,105904,105840,655440,0,105920,105856,655456,0,105936,105872,655472
.long 0,105952,105888,737280,0,105968,105904,737296,0,105984,105920,737312,0,106000,105936,737328
.long 0,106016,105952,737344,0,106032,105968,737360,0,106048,105984,737376,0,106064,106000,737392
.long 0,106096,106016,819200,0,106112,106032,819216,0,106128,106048,819232,0,106144,106064,819248
.long 0,106160,106080,819264,0,106176,106096,819280,0,106192,106112,819296,0,106208,106128,819312
.long 0,106224,106144,901120,0,106240,106160,901136,0,106256,106176,901152,0,106272,106192,901168
.long 0,106288,106208,901184,0,106304,106224,901200,0,106320,106240,901216,0,106336,106256,901232
.long 0,106368,106272,983040,0,106384,106288,983056,0,106400,106304,983072,0,106416,106320,983088
.long 0,106432,106336,983104,0,106448,106352,983120,0,106464,106368,983136,0,106480,106384,983152
.long 0,106496,106400,1064960,0,106512,106416,1064976,0,106528,106432,1064992,0,106544,106448,1065008
.long 0,106560,106464,1065024,0,106576,106480,1065040,0,106592,106496,1065056,0,106608,106512,1065072
.long 0,106640,106528,1146880,0,106656,106544,1146896,0,106672,106560,1146912,0,106688,106576,1146928
.long 0,106704,106592,1146944,0,106720,106608,1146960,0,106736,106624,1146976,0,106752,106640,1146992
.long 0,106768,106656,1228800,0,106784,106672,1228816,0,106800,106688,1228832,0,106816,106704,1228848
.long 0,106832,106720,1228864,0,106848,106736,1228880,0,106864,106752,1228896,0,106880,106768,1228912
.long 123888,123840,123808,123776,123616,123568,123536,123504,123344,123296,123264,123232,123072,123024,122992,122960
.long 122800,122752,122720,122688,126848,126816,126784,126752,126576,126544,126512,126480,126304,126272,126240,126208
.long 126032,126000,125968,125936,125760,125728,125696,125664,125488,125456,125424,125392,125216,125184,125152,125120
.long 124944,124912,124880,124848,126880,126832,126800,126768,126608,126560,126528,126496,126336,126288,126256,126224
.long 126064,126016,125984,125952,125792,125744,125712,125680,125520,125472,125440,125408,125248,125200,125168,125136
.long 124976,124928,124896,124864,138208,138208,138208,138208,131584,131568,131552,131536,131456,131440,131424,131408
.long 131312,131296,131280,131264,131184,131168,131152,131136,131040,131024,131008,130992,130912,130896,130880,130864
.long 130768,130752,130736,130720,130640,130624,130608,130592,130496,130480,130464,130448,130368,130352,130336,130320
.long 130224,130208,130192,130176,130096,130080,130064,130048,129952,129936,129920,129904,129824,129808,129792,129776
.long 129680,129664,129648,129632,129552,129536,129520,129504,129408,129392,129376,129360,129280,129264,129248,129232
.long 129136,129120,129104,129088,129008,128992,128976,128960,128864,128848,128832,128816,128736,128720,128704,128688
.long 128592,128576,128560,128544,128464,128448,128432,128416,128320,128304,128288,128272,128192,128176,128160,128144
.long 128048,128032,128016,128000,127920,127904,127888,127872,127776,127760,127744,127728,127648,127632,127616,127600
.long 127504,127488,127472,127456,127376,127360,127344,127328,138208,138208,138208,138208,133760,133728,133696,133664
.long 133488,133456,133424,133392,133216,133184,133152,133120,132944,132912,132880,132848,132672,132640,132608,132576
.long 132400,132368,132336,132304,132128,132096,132064,132032,131856,131824,131792,131760,138208,138208,138208,138208
.long 123744,123712,123680,123648,123472,123440,123408,123376,123200,123168,123136,123104,122928,122896,122864,122832
.long 122656,122624,122592,122560,126720,126688,126656,126624,126448,126416,126384,126352,126176,126144,126112,126080
.long 125904,125872,125840,125808,125632,125600,125568,125536,125360,125328,125296,125264,125088,125056,125024,124992
.long 124816,124784,124752,124720,126736,126704,126672,126640,126464,126432,126400,126368,126192,126160,126128,126096
.long 125920,125888,125856,125824,125648,125616,125584,125552,125376,125344,125312,125280,125104,125072,125040,125008
.long 124832,124800,124768,124736,138208,138208,131616,131616,131520,131504,131488,131472,131392,131376,131360,131344
.long 131248,131232,131216,131200,131120,131104,131088,131072,130976,130960,130944,130928,130848,130832,130816,130800
.long 130704,130688,130672,130656,130576,130560,130544,130528,130432,130416,130400,130384,130304,130288,130272,130256
.long 130160,130144,130128,130112,130032,130016,130000,129984,129888,129872,129856,129840,129760,129744,129728,129712
.long 129616,129600,129584,129568,129488,129472,129456,129440,129344,129328,129312,129296,129216,129200,129184,129168
.long 129072,129056,129040,129024,128944,128928,128912,128896,128800,128784,128768,128752,128672,128656,128640,128624
.long 128528,128512,128496,128480,128400,128384,128368,128352,128256,128240,128224,128208,128128,128112,128096,128080
.long 127984,127968,127952,127936,127856,127840,127824,127808,127712,127696,127680,127664,127584,127568,127552,127536
.long 127440,127424,127408,127392,127312,127296,127280,127264,138208,138208,138208,133792,133632,133600,133568,133536
.long 133360,133328,133296,133264,133088,133056,133024,132992,132816,132784,132752,132720,132544,132512,132480,132448
.long 132272,132240,132208,132176,132000,131968,131936,131904,131728,131696,131664,131632,138208,138208,138208,138208
.long 123616,123568,123536,18096,123344,123296,123264,18112,123072,123024,122992,18128,122800,122752,122720,18144
.long 126944,126944,126944,18160,126576,126544,126512,18224,126304,126272,126240,18240,126032,126000,125968,18256
.long 125760,125728,125696,18272,125488,125456,125424,18288,125216,125184,125152,18304,124944,124912,124880,18320
.long 126944,126944,126944,18336,126608,126560,126528,18400,126336,126288,126256,18416,126064,126016,125984,18432
.long 125792,125744,125712,18448,125520,125472,125440,18464,125248,125200,125168,18480,124976,124928,124896,18496
.long 126944,126944,126944,18512,131584,131568,131552,51856,131456,131440,131424,51872,131312,131296,131280,51888
.long 131184,131168,131152,51904,131040,131024,131008,51920,130912,130896,130880,51936,130768,130752,130736,51952
.long 130640,130624,130608,51968,130496,130480,130464,51984,130368,130352,130336,52000,130224,130208,130192,52016
.long 130096,130080,130064,52032,129952,129936,129920,52048,129824,129808,129792,52064,129680,129664,129648,52080
.long 129552,129536,129520,52096,129408,129392,129376,52112,129280,129264,129248,52128,129136,129120,129104,52144
.long 129008,128992,128976,52160,128864,128848,128832,52176,128736,128720,128704,52192,128592,128576,128560,52208
.long 128464,128448,128432,52224,128320,128304,128288,52240,128192,128176,128160,52256,128048,128032,128016,52272
.long 127920,127904,127888,52288,127776,127760,127744,52304,127648,127632,127616,52320,127504,127488,127472,52336
.long 127376,127360,127344,52352,138208,138208,138208,52368,133760,133728,133696,52416,133488,133456,133424,52432
.long 133216,133184,133152,52448,132944,132912,132880,52464,132672,132640,132608,52480,132400,132368,132336,52496
.long 132128,132096,132064,52512,131856,131824,131792,52528,138208,138208,138208,52544,133792,133744,133712,52592
.long 0,2016,7676,2016,16,2032,7692,2048,32,2048,7708,2080,48,2064,7724,2112
.long 128,2080,7740,2144,144,2096,7756,2176,160,2112,7772,2208,176,2128,7788,2240
.long 64,2144,7804,2304,80,2160,7820,2336,96,2176,7836,2368,112,2192,7852,2400
.long 192,2208,7868,2432,208,2224,7884,2464,224,2240,7900,2496,240,2256,7916,2528
.long 20480,2304,7932,2592,20496,2320,7948,2624,20512,2336,7964,2656,20528,2352,7980,2688
.long 20608,2368,7996,2720,20624,2384,8012,2752,20640,2400,8028,2784,20656,2416,8044,2816
.long 20544,2432,8060,2880,20560,2448,8076,2912,20576,2464,8092,2944,20592,2480,8108,2976
.long 20672,2496,8124,3008,20688,2512,8140,3040,20704,2528,8156,3072,20720,2544,8172,3104
.long 256,2592,8188,1952,272,2608,8204,2016,288,2624,8220,2048,304,2640,8236,2080
.long 384,2656,8252,2112,400,2672,8268,2144,416,2688,8284,2176,432,2704,8300,2208
.long 320,2720,8316,2240,336,2736,8332,2304,352,2752,8348,2336,368,2768,8364,2368
.long 448,2784,8380,2400,464,2800,8396,2432,480,2816,8412,2464,496,2832,8428,2496
.long 20736,2880,8444,2528,20752,2896,8460,2592,20768,2912,8476,2624,20784,2928,8492,2656
.long 20864,2944,8508,2688,20880,2960,8524,2720,20896,2976,8540,2752,20912,2992,8556,2784
.long 20800,3008,8572,2816,20816,3024,8588,2880,20832,3040,8604,2912,20848,3056,8620,2944
.long 20928,3072,8636,2976,20944,3088,8652,3008,20960,3104,8668,3040,20976,3120,8684,3072
.long 6656,4294966960,4294967008,20992,6688,4294967008,4294967024,21008,6720,4294967024,4294967040,21024,6752,4294967040,4294967056,21040
.long 6784,4294967056,4294967072,21056,6816,4294967072,4294967088,21072,6848,4294967088,4294967104,21088,6880,4294967104,4294967120,21104
.long 6912,4294967120,4294967136,21120,6944,4294967136,4294967152,21136,6976,4294967152,4294967168,21152,7008,4294967168,4294967184,21168
.long 7040,4294967184,4294967200,21184,7072,4294967200,4294967216,21200,7104,4294967216,4294967232,21216,7136,4294967232,4294967248,21232
.long 7168,4294967248,0,21248,7200,0,16,21264,7232,16,32,21280,7264,32,48,21296
.long 7296,48,64,21312,7328,64,80,21328,7360,80,96,21344,7392,96,112,21360
.long 7424,112,128,21376,7456,128,144,21392,7488,144,160,21408,7520,160,176,21424
.long 7552,176,192,21440,7584,192,208,21456,7616,208,224,21472,7648,224,240,21488
.long 6672,240,288,3648,6704,288,304,3664,6736,304,320,3680,6768,320,336,3696
.long 6800,336,352,3712,6832,352,368,3728,6864,368,384,3744,6896,384,400,3760
.long 6928,400,416,3776,6960,416,432,3792,6992,432,448,3808,7024,448,464,3824
.long 7056,464,480,3840,7088,480,496,3856,7120,496,512,3872,7152,512,528,3888
.long 7184,528,576,3904,7216,576,592,3920,7248,592,608,3936,7280,608,624,3952
.long 7312,624,640,3968,7344,640,656,3984,7376,656,672,4000,7408,672,688,4016
.long 7440,688,704,4032,7472,704,720,4048,7504,720,736,4064,7536,736,752,4080
.long 7568,752,768,4080,7600,768,784,4080,7632,784,800,4080,7664,800,816,4080
.long 97976,28152,63064,128,94232,24408,59320,416,90488,20664,55576,704,86744,16920,51832,992
.long 97968,28144,63056,1280,94224,24400,59312,1568,90480,20656,55568,1856,86736,16912,51824,2144
.long 97960,28136,63048,2432,94216,24392,59304,2720,90472,20648,55560,3008,86728,16904,51816,3296
.long 97952,28128,63040,3584,94208,24384,59296,3872,90464,20640,55552,4160,86720,16896,51808,4448
.long 97992,28168,63080,144,94248,24424,59336,432,90504,20680,55592,720,86760,16936,51848,1008
.long 97984,28160,63072,1296,94240,24416,59328,1584,90496,20672,55584,1872,86752,16928,51840,2160
.long 97976,28152,63064,2448,94232,24408,59320,2736,90488,20664,55576,3024,86744,16920,51832,3312
.long 97968,28144,63056,3600,94224,24400,59312,3888,90480,20656,55568,4176,86736,16912,51824,4464
.long 98008,28184,63096,160,94264,24440,59352,448,90520,20696,55608,736,86776,16952,51864,1024
.long 98000,28176,63088,1312,94256,24432,59344,1600,90512,20688,55600,1888,86768,16944,51856,2176
.long 97992,28168,63080,2464,94248,24424,59336,2752,90504,20680,55592,3040,86760,16936,51848,3328
.long 97984,28160,63072,3616,94240,24416,59328,3904,90496,20672,55584,4192,86752,16928,51840,4480
.long 98024,28200,63112,176,94280,24456,59368,464,90536,20712,55624,752,86792,16968,51880,1040
.long 98016,28192,63104,1328,94272,24448,59360,1616,90528,20704,55616,1904,86784,16960,51872,2192
.long 98008,28184,63096,2480,94264,24440,59352,2768,90520,20696,55608,3056,86776,16952,51864,3344
.long 98000,28176,63088,3632,94256,24432,59344,3920,90512,20688,55600,4208,86768,16944,51856,4496
.long 96,69952,69920,104736,384,70240,70208,105008,672,70528,70496,105280,960,70816,70784,105552
.long 1248,71104,71072,105824,1536,71392,71360,106096,1824,71680,71648,106368,2112,71968,71936,106640
.long 2400,72256,72224,106912,2688,72544,72512,107184,2976,72832,72800,107456,3264,73120,73088,107728
.long 3552,73408,73376,108000,3840,73696,73664,108272,4128,73984,73952,108544,4416,74272,74240,108816
.long 112,69968,69936,109088,400,70256,70224,109360,688,70544,70512,109632,976,70832,70800,109904
.long 1264,71120,71088,110176,1552,71408,71376,110448,1840,71696,71664,110720,2128,71984,71952,110992
.long 2416,72272,72240,111264,2704,72560,72528,111536,2992,72848,72816,111808,3280,73136,73104,112080
.long 3568,73424,73392,112352,3856,73712,73680,112624,4144,74000,73968,112896,4432,74288,74256,113168
.long 160,69984,69984,104752,448,70272,70272,105024,736,70560,70560,105296,1024,70848,70848,105568
.long 1312,71136,71136,105840,1600,71424,71424,106112,1888,71712,71712,106384,2176,72000,72000,106656
.long 2464,72288,72288,106928,2752,72576,72576,107200,3040,72864,72864,107472,3328,73152,73152,107744
.long 3616,73440,73440,108016,3904,73728,73728,108288,4192,74016,74016,108560,4480,74304,74304,108832
.long 176,70000,70000,109104,464,70288,70288,109376,752,70576,70576,109648,1040,70864,70864,109920
.long 1328,71152,71152,110192,1616,71440,71440,110464,1904,71728,71728,110736,2192,72016,72016,111008
.long 2480,72304,72304,111280,2768,72592,72592,111552,3056,72880,72880,111824,3344,73168,73168,112096
.long 3632,73456,73456,112368,3920,73744,73744,112640,4208,74032,74032,112912,4496,74320,74320,113184
.long 0,106912,106784,1310720,0,106928,106800,1310736,0,106944,106816,1310752,0,106960,106832,1310768
.long 0,106976,106848,1310784,0,106992,106864,1310800,0,107008,106880,1310816,0,107024,106896,1310832
.long 0,107040,106912,1392640,0,107056,106928,1392656,0,107072,106944,1392672,0,107088,106960,1392688
.long 0,107104,106976,1392704,0,107120,106992,1392720,0,107136,107008,1392736,0,107152,107024,1392752
.long 0,107184,107040,1474560,0,107200,107056,1474576,0,107216,107072,1474592,0,107232,107088,1474608
.long 0,107248,107104,1474624,0,107264,107120,1474640,0,107280,107136,1474656,0,107296,107152,1474672
.long 0,107312,107168,1556480,0,107328,107184,1556496,0,107344,107200,1556512,0,107360,107216,1556528
.long 0,107376,107232,1556544,0,107392,107248,1556560,0,107408,107264,1556576,0,107424,107280,1556592
.long 0,107456,107296,1638400,0,107472,107312,1638416,0,107488,107328,1638432,0,107504,107344,1638448
.long 0,107520,107360,1638464,0,107536,107376,1638480,0,107552,107392,1638496,0,107568,107408,1638512
.long 0,107584,107424,1720320,0,107600,107440,1720336,0,107616,107456,1720352,0,107632,107472,1720368
.long 0,107648,107488,1720384,0,107664,107504,1720400,0,107680,107520,1720416,0,107696,107536,1720432
.long 0,107728,107552,1802240,0,107744,107568,1802256,0,107760,107584,1802272,0,107776,107600,1802288
.long 0,107792,107616,1802304,0,107808,107632,1802320,0,107824,107648,1802336,0,107840,107664,1802352
.long 0,107856,107680,1884160,0,107872,107696,1884176,0,107888,107712,1884192,0,107904,107728,1884208
.long 0,107920,107744,1884224,0,107936,107760,1884240,0,107952,107776,1884256,0,107968,107792,1884272
.long 133792,133744,133712,133680,133520,133472,133440,133408,133248,133200,133168,133136,132976,132928,132896,132864
.long 132704,132656,132624,132592,132432,132384,132352,132320,132160,132112,132080,132048,131888,131840,131808,131776
.long 138208,138208,138208,138208,135936,135904,135872,135840,135664,135632,135600,135568,135392,135360,135328,135296
.long 135120,135088,135056,135024,134848,134816,134784,134752,134576,134544,134512,134480,134304,134272,134240,134208
.long 134032,134000,133968,133936,138208,138208,138208,138208,135968,135920,135888,135856,135696,135648,135616,135584
.long 135424,135376,135344,135312,135152,135104,135072,135040,134880,134832,134800,134768,134608,134560,134528,134496
.long 134336,134288,134256,134224,134064,134016,133984,133952,138112,138080,138048,138016,137840,137808,137776,137744
.long 137568,137536,137504,137472,137296,137264,137232,137200,137024,136992,136960,136928,136752,136720,136688,136656
.long 136480,136448,136416,136384,136208,136176,136144,136112,138144,138096,138064,138032,137872,137824,137792,137760
.long 137600,137552,137520,137488,137328,137280,137248,137216,137056,137008,136976,136944,136784,136736,136704,136672
.long 136512,136464,136432,136400,136240,136192,136160,136128,115680,115680,115680,115680,109056,109040,109024,109008
.long 108928,108912,108896,108880,108784,108768,108752,108736,108656,108640,108624,108608,108512,108496,108480,108464
.long 108384,108368,108352,108336,108240,108224,108208,108192,108112,108096,108080,108064,107968,107952,107936,107920
.long 107840,107824,107808,107792,107696,107680,107664,107648,107568,107552,107536,107520,107424,107408,107392,107376
.long 107296,107280,107264,107248,107152,107136,107120,107104,107024,107008,106992,106976,106880,106864,106848,106832
.long 106752,106736,106720,106704,106608,106592,106576,106560,106480,106464,106448,106432,106336,106320,106304,106288
.long 133648,133616,133584,133552,133376,133344,133312,133280,133104,133072,133040,133008,132832,132800,132768,132736
.long 132560,132528,132496,132464,132288,132256,132224,132192,132016,131984,131952,131920,131744,131712,131680,131648
.long 138208,138208,138208,135968,135808,135776,135744,135712,135536,135504,135472,135440,135264,135232,135200,135168
.long 134992,134960,134928,134896,134720,134688,134656,134624,134448,134416,134384,134352,134176,134144,134112,134080
.long 133904,133872,133840,133808,138208,138208,138208,138208,135824,135792,135760,135728,135552,135520,135488,135456
.long 135280,135248,135216,135184,135008,134976,134944,134912,134736,134704,134672,134640,134464,134432,134400,134368
.long 134192,134160,134128,134096,133920,133888,133856,133824,137984,137952,137920,137888,137712,137680,137648,137616
.long 137440,137408,137376,137344,137168,137136,137104,137072,136896,136864,136832,136800,136624,136592,136560,136528
.long 136352,136320,136288,136256,136080,136048,136016,135984,138000,137968,137936,137904,137728,137696,137664,137632
.long 137456,137424,137392,137360,137184,137152,137120,137088,136912,136880,136848,136816,136640,136608,136576,136544
.long 136368,136336,136304,136272,136096,136064,136032,136000,115680,115680,109088,109088,108992,108976,108960,108944
.long 108864,108848,108832,108816,108720,108704,108688,108672,108592,108576,108560,108544,108448,108432,108416,108400
.long 108320,108304,108288,108272,108176,108160,108144,108128,108048,108032,108016,108000,107904,107888,107872,107856
.long 107776,107760,107744,107728,107632,107616,107600,107584,107504,107488,107472,107456,107360,107344,107328,107312
.long 107232,107216,107200,107184,107088,107072,107056,107040,106960,106944,106928,106912,106816,106800,106784,106768
.long 106688,106672,106656,106640,106544,106528,106512,106496,106416,106400,106384,106368,106272,106256,106240,106224
.long 133520,133472,133440,52608,133248,133200,133168,52624,132976,132928,132896,52640,132704,132656,132624,52656
.long 132432,132384,132352,52672,132160,132112,132080,52688,131888,131840,131808,52704,138208,138208,138208,52720
.long 135936,135904,135872,52768,135664,135632,135600,52784,135392,135360,135328,52800,135120,135088,135056,52816
.long 134848,134816,134784,52832,134576,134544,134512,52848,134304,134272,134240,52864,134032,134000,133968,52880
.long 138208,138208,138208,52896,135968,135920,135888,52944,135696,135648,135616,52960,135424,135376,135344,52976
.long 135152,135104,135072,52992,134880,134832,134800,53008,134608,134560,134528,53024,134336,134288,134256,53040
.long 134064,134016,133984,53056,138208,138208,138208,53072,137840,137808,137776,53136,137568,137536,137504,53152
.long 137296,137264,137232,53168,137024,136992,136960,53184,136752,136720,136688,53200,136480,136448,136416,53216
.long 136208,136176,136144,53232,138208,138208,138208,53248,137872,137824,137792,53312,137600,137552,137520,53328
.long 137328,137280,137248,53344,137056,137008,136976,53360,136784,136736,136704,53376,136512,136464,136432,53392
.long 136240,136192,136160,53408,138208,138208,138208,53424,109056,109040,109024,86768,108928,108912,108896,86784
.long 108784,108768,108752,86800,108656,108640,108624,86816,108512,108496,108480,86832,108384,108368,108352,86848
.long 108240,108224,108208,86864,108112,108096,108080,86880,107968,107952,107936,86896,107840,107824,107808,86912
.long 107696,107680,107664,86928,107568,107552,107536,86944,107424,107408,107392,86960,107296,107280,107264,86976
.long 107152,107136,107120,86992,107024,107008,106992,87008,106880,106864,106848,87024,106752,106736,106720,87040
.long 106608,106592,106576,87056,106480,106464,106448,87072,106336,106320,106304,87088,106208,106192,106176,87104
.long 0,3168,8700,3168,16,3184,8716,3200,32,3200,8732,3232,48,3216,8748,3264
.long 128,3232,8764,3296,144,3248,8780,3328,160,3264,8796,3360,176,3280,8812,3392
.long 64,3296,8828,3456,80,3312,8844,3488,96,3328,8860,3520,112,3344,8876,3552
.long 192,3360,8892,3584,208,3376,8908,3616,224,3392,8924,3648,240,3408,8940,3680
.long 20480,3456,8956,3744,20496,3472,8972,3776,20512,3488,8988,3808,20528,3504,9004,3840
.long 20608,3520,9020,3872,20624,3536,9036,3904,20640,3552,9052,3936,20656,3568,9068,3968
.long 20544,3584,9084,4032,20560,3600,9100,4064,20576,3616,9116,4096,20592,3632,9132,4128
.long 20672,3648,9148,4160,20688,3664,9164,4192,20704,3680,9180,4224,20720,3696,9196,4256
.long 256,3744,9212,3104,272,3760,9228,3168,288,3776,9244,3200,304,3792,9260,3232
.long 384,3808,9276,3264,400,3824,9292,3296,416,3840,9308,3328,432,3856,9324,3360
.long 320,3872,9340,3392,336,3888,9356,3456,352,3904,9372,3488,368,3920,9388,3520
.long 448,3936,9404,3552,464,3952,9420,3584,480,3968,9436,3616,496,3984,9452,3648
.long 20736,4032,9468,3680,20752,4048,9484,3744,20768,4064,9500,3776,20784,4080,9516,3808
.long 20864,4096,9532,3840,20880,4112,9548,3872,20896,4128,9564,3904,20912,4144,9580,3936
.long 20800,4160,9596,3968,20816,4176,9612,4032,20832,4192,9628,4064,20848,4208,9644,4096
.long 20928,4224,9660,4128,20944,4240,9676,4160,20960,4256,9692,4192,20976,4272,9708,4224
.long 7680,816,864,21504,7712,864,880,21520,7744,880,896,21536,7776,896,912,21552
.long 7808,912,928,21568,7840,928,944,21584,7872,944,960,21600,7904,960,976,21616
.long 7936,976,992,21632,7968,992,1008,21648,8000,1008,1024,21664,8032,1024,1040,21680
.long 8064,1040,1056,21696,8096,1056,1072,21712,8128,1072,1088,21728,8160,1088,1104,21744
.long 8192,1104,1152,21760,8224,1152,1168,21776,8256,1168,1184,21792,8288,1184,1200,21808
.long 8320,1200,1216,21824,8352,1216,1232,21840,8384,1232,1248,21856,8416,1248,1264,21872
.long 8448,1264,1280,21888,8480,1280,1296,21904,8512,1296,1312,21920,8544,1312,1328,21936
.long 8576,1328,1344,21952,8608,1344,1360,21968,8640,1360,1376,21984,8672,1376,1392,22000
.long 7696,1392,1440,3648,7728,1440,1456,3664,7760,1456,1472,3680,7792,1472,1488,3696
.long 7824,1488,1504,3712,7856,1504,1520,3728,7888,1520,1536,3744,7920,1536,1552,3760
.long 7952,1552,1568,3776,7984,1568,1584,3792,8016,1584,1600,3808,8048,1600,1616,3824
.long 8080,1616,1632,3840,8112,1632,1648,3856,8144,1648,1664,3872,8176,1664,1680,3888
.long 8208,1680,1728,3904,8240,1728,1744,3920,8272,1744,1760,3936,8304,1760,1776,3952
.long 8336,1776,1792,3968,8368,1792,1808,3984,8400,1808,1824,4000,8432,1824,1840,4016
.long 8464,1840,1856,4032,8496,1856,1872,4048,8528,1872,1888,4064,8560,1888,1904,4080
.long 8592,1904,1920,4080,8624,1920,1936,4080,8656,1936,1952,4080,8688,1952,1968,4080
.long 97976,28152,63064,160,94232,24408,59320,448,90488,20664,55576,736,86744,16920,51832,1024
.long 97968,28144,63056,1312,94224,24400,59312,1600,90480,20656,55568,1888,86736,16912,51824,2176
.long 97960,28136,63048,2464,94216,24392,59304,2752,90472,20648,55560,3040,86728,16904,51816,3328
.long 97952,28128,63040,3616,94208,24384,59296,3904,90464,20640,55552,4192,86720,16896,51808,4480
.long 97992,28168,63080,176,94248,24424,59336,464,90504,20680,55592,752,86760,16936,51848,1040
.long 97984,28160,63072,1328,94240,24416,59328,1616,90496,20672,55584,1904,86752,16928,51840,2192
.long 97976,28152,63064,2480,94232,24408,59320,2768,90488,20664,55576,3056,86744,16920,51832,3344
.long 97968,28144,63056,3632,94224,24400,59312,3920,90480,20656,55568,4208,86736,16912,51824,4496
.long 98008,28184,63096,192,94264,24440,59352,480,90520,20696,55608,768,86776,16952,51864,1056
.long 98000,28176,63088,1344,94256,24432,59344,1632,90512,20688,55600,1920,86768,16944,51856,2208
.long 97992,28168,63080,2496,94248,24424,59336,2784,90504,20680,55592,3072,86760,16936,51848,3360
.long 97984,28160,63072,3648,94240,24416,59328,3936,90496,20672,55584,4224,86752,16928,51840,4512
.long 98024,28200,63112,208,94280,24456,59368,496,90536,20712,55624,784,86792,16968,51880,1072
.long 98016,28192,63104,1360,94272,24448,59360,1648,90528,20704,55616,1936,86784,16960,51872,2224
.long 98008,28184,63096,2512,94264,24440,59352,2800,90520,20696,55608,3088,86776,16952,51864,3376
.long 98000,28176,63088,3664,94256,24432,59344,3952,90512,20688,55600,4240,86768,16944,51856,4528
.long 160,69984,69984,104768,448,70272,70272,105040,736,70560,70560,105312,1024,70848,70848,105584
.long 1312,71136,71136,105856,1600,71424,71424,106128,1888,71712,71712,106400,2176,72000,72000,106672
.long 2464,72288,72288,106944,2752,72576,72576,107216,3040,72864,72864,107488,3328,73152,73152,107760
.long 3616,73440,73440,108032,3904,73728,73728,108304,4192,74016,74016,108576,4480,74304,74304,108848
.long 176,70000,70000,109120,464,70288,70288,109392,752,70576,70576,109664,1040,70864,70864,109936
.long 1328,71152,71152,110208,1616,71440,71440,110480,1904,71728,71728,110752,2192,72016,72016,111024
.long 2480,72304,72304,111296,2768,72592,72592,111568,3056,72880,72880,111840,3344,73168,73168,112112
.long 3632,73456,73456,112384,3920,73744,73744,112656,4208,74032,74032,112928,4496,74320,74320,113200
.long 192,70016,70016,104784,480,70304,70304,105056,768,70592,70592,105328,1056,70880,70880,105600
.long 1344,71168,71168,105872,1632,71456,71456,106144,1920,71744,71744,106416,2208,72032,72032,106688
.long 2496,72320,72320,106960,2784,72608,72608,107232,3072,72896,72896,107504,3360,73184,73184,107776
.long 3648,73472,73472,108048,3936,73760,73760,108320,4224,74048,74048,108592,4512,74336,74336,108864
.long 208,70032,70032,109136,496,70320,70320,109408,784,70608,70608,109680,1072,70896,70896,109952
.long 1360,71184,71184,110224,1648,71472,71472,110496,1936,71760,71760,110768,2224,72048,72048,111040
.long 2512,72336,72336,111312,2800,72624,72624,111584,3088,72912,72912,111856,3376,73200,73200,112128
.long 3664,73488,73488,112400,3952,73776,73776,112672,4240,74064,74064,112944,4528,74352,74352,113216
.long 0,108000,107808,1966080,0,108016,107824,1966096,0,108032,107840,1966112,0,108048,107856,1966128
.long 0,108064,107872,1966144,0,108080,107888,1966160,0,108096,107904,1966176,0,108112,107920,1966192
.long 0,108128,107936,2048000,0,108144,107952,2048016,0,108160,107968,2048032,0,108176,107984,2048048
.long 0,108192,108000,2048064,0,108208,108016,2048080,0,108224,108032,2048096,0,108240,108048,2048112
.long 0,108272,108064,2129920,0,108288,108080,2129936,0,108304,108096,2129952,0,108320,108112,2129968
.long 0,108336,108128,2129984,0,108352,108144,2130000,0,108368,108160,2130016,0,108384,108176,2130032
.long 0,108400,108192,2211840,0,108416,108208,2211856,0,108432,108224,2211872,0,108448,108240,2211888
.long 0,108464,108256,2211904,0,108480,108272,2211920,0,108496,108288,2211936,0,108512,108304,2211952
.long 0,108544,108320,2293760,0,108560,108336,2293776,0,108576,108352,2293792,0,108592,108368,2293808
.long 0,108608,108384,2293824,0,108624,108400,2293840,0,108640,108416,2293856,0,108656,108432,2293872
.long 0,108672,108448,2375680,0,108688,108464,2375696,0,108704,108480,2375712,0,108720,108496,2375728
.long 0,108736,108512,2375744,0,108752,108528,2375760,0,108768,108544,2375776,0,108784,108560,2375792
.long 0,108816,108576,2457600,0,108832,108592,2457616,0,108848,108608,2457632,0,108864,108624,2457648
.long 0,108880,108640,2457664,0,108896,108656,2457680,0,108912,108672,2457696,0,108928,108688,2457712
.long 0,108944,108704,2539520,0,108960,108720,2539536,0,108976,108736,2539552,0,108992,108752,2539568
.long 0,109008,108768,2539584,0,109024,108784,2539600,0,109040,108800,2539616,0,109056,108816,2539632
.long 106208,106192,106176,106160,106064,106048,106032,106016,105936,105920,105904,105888,105792,105776,105760,105744
.long 105664,105648,105632,105616,105520,105504,105488,105472,105392,105376,105360,105344,105248,105232,105216,105200
.long 105120,105104,105088,105072,104976,104960,104944,104928,104848,104832,104816,104800,115680,115680,115680,115680
.long 111232,111200,111168,111136,110960,110928,110896,110864,110688,110656,110624,110592,110416,110384,110352,110320
.long 110144,110112,110080,110048,109872,109840,109808,109776,109600,109568,109536,109504,109328,109296,109264,109232
.long 115680,115680,115680,115680,111264,111216,111184,111152,110992,110944,110912,110880,110720,110672,110640,110608
.long 110448,110400,110368,110336,110176,110128,110096,110064,109904,109856,109824,109792,109632,109584,109552,109520
.long 109360,109312,109280,109248,115680,115680,115680,115680,113408,113376,113344,113312,113136,113104,113072,113040
.long 112864,112832,112800,112768,112592,112560,112528,112496,112320,112288,112256,112224,112048,112016,111984,111952
.long 111776,111744,111712,111680,111504,111472,111440,111408,115680,115680,115680,115680,113440,113392,113360,113328
.long 113168,113120,113088,113056,112896,112848,112816,112784,112624,112576,112544,112512,112352,112304,112272,112240
.long 112080,112032,112000,111968,111808,111760,111728,111696,111536,111488,111456,111424,115584,115552,115520,115488
.long 115312,115280,115248,115216,115040,115008,114976,114944,114768,114736,114704,114672,114496,114464,114432,114400
.long 114224,114192,114160,114128,113952,113920,113888,113856,113680,113648,113616,113584,115616,115568,115536,115504
.long 115344,115296,115264,115232,115072,115024,114992,114960,114800,114752,114720,114688,114528,114480,114448,114416
.long 114256,114208,114176,114144,113984,113936,113904,113872,113712,113664,113632,113600,113712,113664,113632,113600
.long 106144,106128,106112,106096,106000,105984,105968,105952,105872,105856,105840,105824,105728,105712,105696,105680
.long 105600,105584,105568,105552,105456,105440,105424,105408,105328,105312,105296,105280,105184,105168,105152,105136
.long 105056,105040,105024,105008,104912,104896,104880,104864,104784,104768,104752,104736,115680,115680,115680,111264
.long 111104,111072,111040,111008,110832,110800,110768,110736,110560,110528,110496,110464,110288,110256,110224,110192
.long 110016,109984,109952,109920,109744,109712,109680,109648,109472,109440,109408,109376,109200,109168,109136,109104
.long 115680,115680,115680,115680,111120,111088,111056,111024,110848,110816,110784,110752,110576,110544,110512,110480
.long 110304,110272,110240,110208,110032,110000,109968,109936,109760,109728,109696,109664,109488,109456,109424,109392
.long 109216,109184,109152,109120,115680,115680,115680,113440,113280,113248,113216,113184,113008,112976,112944,112912
.long 112736,112704,112672,112640,112464,112432,112400,112368,112192,112160,112128,112096,111920,111888,111856,111824
.long 111648,111616,111584,111552,111376,111344,111312,111280,115680,115680,115680,115680,113296,113264,113232,113200
.long 113024,112992,112960,112928,112752,112720,112688,112656,112480,112448,112416,112384,112208,112176,112144,112112
.long 111936,111904,111872,111840,111664,111632,111600,111568,111392,111360,111328,111296,115456,115424,115392,115360
.long 115184,115152,115120,115088,114912,114880,114848,114816,114640,114608,114576,114544,114368,114336,114304,114272
.long 114096,114064,114032,114000,113824,113792,113760,113728,113552,113520,113488,113456,115472,115440,115408,115376
.long 115200,115168,115136,115104,114928,114896,114864,114832,114656,114624,114592,114560,114384,114352,114320,114288
.long 114112,114080,114048,114016,113840,113808,113776,113744,113568,113536,113504,113472,113568,113536,113504,113472
.long 106064,106048,106032,87120,105936,105920,105904,87136,105792,105776,105760,87152,105664,105648,105632,87168
.long 105520,105504,105488,87184,105392,105376,105360,87200,105248,105232,105216,87216,105120,105104,105088,87232
.long 104976,104960,104944,87248,104848,104832,104816,87264,115680,115680,115680,87280,111232,111200,111168,87328
.long 110960,110928,110896,87344,110688,110656,110624,87360,110416,110384,110352,87376,110144,110112,110080,87392
.long 109872,109840,109808,87408,109600,109568,109536,87424,109328,109296,109264,87440,115680,115680,115680,87456
.long 111264,111216,111184,87504,110992,110944,110912,87520,110720,110672,110640,87536,110448,110400,110368,87552
.long 110176,110128,110096,87568,109904,109856,109824,87584,109632,109584,109552,87600,109360,109312,109280,87616
.long 115680,115680,115680,87632,113408,113376,113344,87680,113136,113104,113072,87696,112864,112832,112800,87712
.long 112592,112560,112528,87728,112320,112288,112256,87744,112048,112016,111984,87760,111776,111744,111712,87776
.long 111504,111472,111440,87792,115680,115680,115680,87808,113440,113392,113360,87856,113168,113120,113088,87872
.long 112896,112848,112816,87888,112624,112576,112544,87904,112352,112304,112272,87920,112080,112032,112000,87936
.long 111808,111760,111728,87952,111536,111488,111456,87968,115680,115680,115680,87984,115312,115280,115248,88048
.long 115040,115008,114976,88064,114768,114736,114704,88080,114496,114464,114432,88096,114224,114192,114160,88112
.long 113952,113920,113888,88128,113680,113648,113616,88144,115680,115680,115680,88160,115344,115296,115264,88224
.long 115072,115024,114992,88240,114800,114752,114720,88256,114528,114480,114448,88272,114256,114208,114176,88288
.long 113984,113936,113904,88304,113712,113664,113632,88320,115680,115680,115680,88336,115680,115680,115680,88336
.long 0,4320,9724,4320,16,4336,9740,4352,32,4352,9756,4384,48,4368,9772,4416
.long 128,4384,9788,4448,144,4400,9804,4480,160,4416,9820,4512,176,4432,9836,4544
.long 64,4448,9852,4608,80,4464,9868,4640,96,4480,9884,4672,112,4496,9900,4704
.long 192,4512,9916,4736,208,4528,9932,4768,224,4544,9948,4800,240,4560,9964,4832
.long 20480,4608,9980,4896,20496,4624,9996,4928,20512,4640,10012,4960,20528,4656,10028,4992
.long 20608,4672,10044,5024,20624,4688,10060,5056,20640,4704,10076,5088,20656,4720,10092,5120
.long 20544,4736,10108,5184,20560,4752,10124,5216,20576,4768,10140,5248,20592,4784,10156,5280
.long 20672,4800,10172,5312,20688,4816,10188,5344,20704,4832,10204,5376,20720,4848,10220,5408
.long 256,4896,10236,4256,272,4912,10252,4320,288,4928,10268,4352,304,4944,10284,4384
.long 384,4960,10300,4416,400,4976,10316,4448,416,4992,10332,4480,432,5008,10348,4512
.long 320,5024,10364,4544,336,5040,10380,4608,352,5056,10396,4640,368,5072,10412,4672
.long 448,5088,10428,4704,464,5104,10444,4736,480,5120,10460,4768,496,5136,10476,4800
.long 20736,5184,10492,4832,20752,5200,10508,4896,20768,5216,10524,4928,20784,5232,10540,4960
.long 20864,5248,10556,4992,20880,5264,10572,5024,20896,5280,10588,5056,20912,5296,10604,5088
.long 20800,5312,10620,5120,20816,5328,10636,5184,20832,5344,10652,5216,20848,5360,10668,5248
.long 20928,5376,10684,5280,20944,5392,10700,5312,20960,5408,10716,5344,20976,5424,10732,5376
.long 8704,1968,2016,22016,8736,2016,2032,22032,8768,2032,2048,22048,8800,2048,2064,22064
.long 8832,2064,2080,22080,8864,2080,2096,22096,8896,2096,2112,22112,8928,2112,2128,22128
.long 8960,2128,2144,22144,8992,2144,2160,22160,9024,2160,2176,22176,9056,2176,2192,22192
.long 9088,2192,2208,22208,9120,2208,2224,22224,9152,2224,2240,22240,9184,2240,2256,22256
.long 9216,2256,2304,22272,9248,2304,2320,22288,9280,2320,2336,22304,9312,2336,2352,22320
.long 9344,2352,2368,22336,9376,2368,2384,22352,9408,2384,2400,22368,9440,2400,2416,22384
.long 9472,2416,2432,22400,9504,2432,2448,22416,9536,2448,2464,22432,9568,2464,2480,22448
.long 9600,2480,2496,22464,9632,2496,2512,22480,9664,2512,2528,22496,9696,2528,2544,22512
.long 8720,2544,2592,3648,8752,2592,2608,3664,8784,2608,2624,3680,8816,2624,2640,3696
.long 8848,2640,2656,3712,8880,2656,2672,3728,8912,2672,2688,3744,8944,2688,2704,3760
.long 8976,2704,2720,3776,9008,2720,2736,3792,9040,2736,2752,3808,9072,2752,2768,3824
.long 9104,2768,2784,3840,9136,2784,2800,3856,9168,2800,2816,3872,9200,2816,2832,3888
.long 9232,2832,2880,3904,9264,2880,2896,3920,9296,2896,2912,3936,9328,2912,2928,3952
.long 9360,2928,2944,3968,9392,2944,2960,3984,9424,2960,2976,4000,9456,2976,2992,4016
.long 9488,2992,3008,4032,9520,3008,3024,4048,9552,3024,3040,4064,9584,3040,3056,4080
.long 9616,3056,3072,4080,9648,3072,3088,4080,9680,3088,3104,4080,9712,3104,3120,4080
.long 0,0,0,0,0,0,0,0,0,0,0,0,16256,0,0,0
.long 0,1065353216,1065369472,0,0,0,1065369472,16256,0,0,1065353216,1065369472,0,0,0,1065369472
.long 1065369472,0,0,0,1065369472,16256,0,0,1065353216,1065369472,0,0,0,1065369472,16256,0
.long 0,0,0,1065353216,0,0,0,0,0,0,0,0,0,0,0,0
.long 0,0,0,0,0,0,0,0,16256,0,0,0,1065369472,0,0,0
.long 0,1065369472,1065369472,16256,0,1065353216,1065369472,1065369472,0,0,1065369472,1065369472,0,0,1065353216,1065369472
.long 1065369472,16256,0,0,1065369472,1065369472,0,0,1065369472,1065369472,16256,0,1065353216,1065369472,1065369472,0
.long 0,0,0,1065369472,0,0,0,1065353216,0,0,0,0,0,0,0,0
.long 0,0,0,0,0,0,0,0,0,0,0,0,0,0,0,0
.long 0,0,0,0,0,0,0,0,0,0,0,0,0,0,0,0
.long 0,0,0,0,0,0,0,0,0,0,0,0,0,0,0,0
.long 0,0,0,0,0,0,0,0,0,0,0,0,0,0,0,0
.long 0,0,0,0,0,0,0,0,0,0,0,0,0,0,0,0
.long 0,0,0,0,0,0,0,0,0,0,0,0,0,0,0,0
.long 0,0,0,0,0,0,0,0,0,0,0,0,0,0,0,0
.long 0,0,0,0,0,0,0,0,0,0,0,0,0,0,0,0
.long 0,0,0,0,0,0,0,0,0,0,0,0,0,0,0,0
.long 0,0,0,0,0,0,0,0,0,0,0,0,16256,0,0,0
.long 0,0,0,0,0,0,0,0,0,0,0,0,0,0,0,0
.long 1065369472,0,0,0,1065369472,16256,0,0,1065353216,1065369472,0,0,0,1065369472,16256,0
.long 0,0,0,0,0,0,0,0,0,0,0,0,0,0,0,0
.long 0,0,0,0,0,0,0,0,16256,0,0,0,1065369472,0,0,0
.long 0,0,0,0,0,0,0,0,0,0,0,0,0,0,0,0
.long 1065369472,16256,0,0,1065369472,1065369472,0,0,1065369472,1065369472,16256,0,1065353216,1065369472,1065369472,0
.long 0,1065353216,1065369472,0,0,0,1065369472,16256,0,0,1065353216,1065369472,0,0,0,1065369472
.long 0,0,0,0,0,0,0,0,0,0,0,0,0,0,0,0
.long 0,0,0,1065353216,0,0,0,0,0,0,0,0,0,0,0,0
.long 0,0,0,0,0,0,0,0,0,0,0,0,0,0,0,0
.long 0,1065369472,1065369472,16256,0,1065353216,1065369472,1065369472,0,0,1065369472,1065369472,0,0,1065353216,1065369472
.long 0,0,0,0,0,0,0,0,0,0,0,0,0,0,0,0
.long 0,0,0,1065369472,0,0,0,1065353216,0,0,0,0,0,0,0,0
.long 0,0,0,0,0,0,0,0,0,0,0,0,0,0,0,0
.long 0,0,0,0,16256,0,0,0,1065369472,0,0,0,1065369472,16256,0,0
.long 1065353216,1065369472,1065369472,1065369472,0,1065369472,1065369472,1065369472,0,1065353216,1065369472,1065369472,0,0,1065369472,1065369472
.long 1065369472,1065369472,0,0,1065369472,1065369472,16256,0,1065369472,1065369472,1065369472,0,1065369472,1065369472,1065369472,16256
.long 0,0,1065353216,1065369472,0,0,0,1065369472,0,0,0,1065353216,0,0,0,0
.long 16256,0,0,0,1065369472,0,0,0,1065369472,16256,0,0,1065369472,1065369472,0,0
.long 1065369472,1065369472,1065369472,1065369472,1065353216,1065369472,1065369472,1065369472,0,1065369472,1065369472,1065369472,0,1065353216,1065369472,1065369472
.long 1065369472,1065369472,16256,0,1065369472,1065369472,1065369472,0,1065369472,1065369472,1065369472,16256,1065369472,1065369472,1065369472,1065369472
.long 0,0,1065369472,1065369472,0,0,1065353216,1065369472,0,0,0,1065369472,0,0,0,1065353216
.long 0,0,0,0,0,0,0,0,0,0,0,0,0,0,0,0
.long 0,0,0,0,0,0,0,0,0,0,0,0,0,0,0,0
.long 0,0,0,0,0,0,0,0,0,0,0,0,0,0,0,0
.long 0,0,0,0,0,0,0,0,0,0,0,0,0,0,0,0
.long 0,0,0,0,0,0,0,0,0,0,0,0,0,0,0,0
.long 0,0,0,0,0,0,0,0,0,0,0,0,0,0,0,0
.long 0,0,0,0,0,0,0,0,0,0,0,0,0,0,0,0
.long 0,0,0,0,0,0,0,0,0,0,0,0,0,0,0,0
.long 0,0,0,0,0,0,0,0,0,0,0,0,0,0,0,0
.long 0,0,0,0,16256,0,0,0,1065369472,0,0,0,1065369472,16256,0,0
.long 0,0,0,0,0,0,0,0,0,0,0,0,0,0,0,0
.long 1065369472,1065369472,0,0,1065369472,1065369472,16256,0,1065369472,1065369472,1065369472,0,1065369472,1065369472,1065369472,16256
.long 0,0,0,0,0,0,0,0,0,0,0,0,0,0,0,0
.long 16256,0,0,0,1065369472,0,0,0,1065369472,16256,0,0,1065369472,1065369472,0,0
.long 0,0,0,0,0,0,0,0,0,0,0,0,0,0,0,0
.long 1065369472,1065369472,16256,0,1065369472,1065369472,1065369472,0,1065369472,1065369472,1065369472,16256,1065369472,1065369472,1065369472,1065369472
.long 1065353216,1065369472,1065369472,1065369472,0,1065369472,1065369472,1065369472,0,1065353216,1065369472,1065369472,0,0,1065369472,1065369472
.long 0,0,0,0,0,0,0,0,0,0,0,0,0,0,0,0
.long 0,0,1065353216,1065369472,0,0,0,1065369472,0,0,0,1065353216,0,0,0,0
.long 0,0,0,0,0,0,0,0,0,0,0,0,0,0,0,0
.long 1065369472,1065369472,1065369472,1065369472,1065353216,1065369472,1065369472,1065369472,0,1065369472,1065369472,1065369472,0,1065353216,1065369472,1065369472
.long 0,0,0,0,0,0,0,0,0,0,0,0,0,0,0,0
.long 0,0,1065369472,1065369472,0,0,1065353216,1065369472,0,0,0,1065369472,0,0,0,1065353216
.long 0,0,0,0,0,0,0,0,0,0,0,0,0,0,0,0
```
